```python
import torch

def _softmax(x, axis=-1):
    return torch.softmax(x, dim=axis)
def _gelu(x):
    return torch.nn.functional.gelu(x, approximate="tanh")
def _silu(x):
    return torch.nn.functional.silu(x)
def _sigmoid(x):
    return torch.sigmoid(x)
def _layernorm(x, axis=-1, eps=1e-5):
    m = x.mean(dim=axis, keepdim=True)
    v = x.var(dim=axis, keepdim=True, unbiased=False)
    return (x - m) / torch.sqrt(v + eps)
def _scatter_add(tgt, idx, src, axis=0):
    return tgt.clone().index_add_(axis, idx, src)
def _segment_sum(src, seg, n):
    out = torch.zeros((n,) + src.shape[1:], dtype=src.dtype)
    return out.index_add_(0, seg, src)
def _pad(x, pw):
    flat = tuple(v for pair in reversed(pw) for v in pair)
    return torch.nn.functional.pad(x, flat)

kernel_name = 'concat_heads__gqa_block_cached__gqa_block_cached__near_ridge'

def setup_inputs():

    _w = (lambda a: (lambda t: t.to(torch.bfloat16) if t.is_floating_point() else t)(torch.as_tensor(a)))
    def _A_setup():
        B, Sq, D = 16, 80, 640
        Hq, Hkv, Sk, Dh = 32, 32, 80, 128
        assert Hq % Hkv == 0, (Hq, Hkv)
        return {
            "x": _w((lambda *s: torch.randn(*s, dtype=torch.bfloat16) * 0.8)(B, Sq, D)),
            "k_cache": _w((lambda *s: torch.randn(*s, dtype=torch.bfloat16) * 0.8)(B, Hkv, Sk, Dh)),
            "v_cache": _w((lambda *s: torch.randn(*s, dtype=torch.bfloat16) * 0.05)(B, Hkv, Sk, Dh)),
            "wq": _w((lambda *s: torch.randn(*s, dtype=torch.bfloat16) * 0.8)(D, Hq * Dh) * (D ** -0.5)),
            "wo": _w((lambda *s: torch.randn(*s, dtype=torch.bfloat16) * 0.05)(Hq * Dh, D) * ((Hq * Dh) ** -0.5)),
        }
    _A_in = _A_setup()

    def _B_setup():
        B, Sq, D = 16, 80, 640
        Hq, Hkv, Sk, Dh = 32, 32, 80, 128
        assert Hq % Hkv == 0, (Hq, Hkv)
        return {
            "x": _w((lambda *s: torch.randn(*s, dtype=torch.bfloat16) * 0.8)(B, Sq, D)),
            "k_cache": _w((lambda *s: torch.randn(*s, dtype=torch.bfloat16) * 0.8)(B, Hkv, Sk, Dh)),
            "v_cache": _w((lambda *s: torch.randn(*s, dtype=torch.bfloat16) * 0.05)(B, Hkv, Sk, Dh)),
            "wq": _w((lambda *s: torch.randn(*s, dtype=torch.bfloat16) * 0.8)(D, Hq * Dh) * (D ** -0.5)),
            "wo": _w((lambda *s: torch.randn(*s, dtype=torch.bfloat16) * 0.05)(Hq * Dh, D) * ((Hq * Dh) ** -0.5)),
        }
    _B_in = _B_setup()

    return {
        "A_x": _A_in["x"],
        "A_k_cache": _A_in["k_cache"],
        "A_v_cache": _A_in["v_cache"],
        "A_wq": _A_in["wq"],
        "A_wo": _A_in["wo"],
        "B_x": _B_in["x"],
        "B_k_cache": _B_in["k_cache"],
        "B_v_cache": _B_in["v_cache"],
        "B_wq": _B_in["wq"],
        "B_wo": _B_in["wo"],
    }

def reference(A_x, A_k_cache, A_v_cache, A_wq, A_wo, B_x, B_k_cache, B_v_cache, B_wq, B_wo):
    def _A_ref(x, k_cache, v_cache, wq, wo):
        B, Sq, D = x.shape
        Hq, Dh = 32, 128
        Hkv = k_cache.shape[1]
        rep = Hq // Hkv
        q = (lambda x, *d: x.permute(*d))((x @ wq).reshape(B, Sq, Hq, Dh), 0, 2, 1, 3)
        k = (lambda x, n, axis: torch.repeat_interleave(x, n, dim=axis))(k_cache, rep, axis=1)
        v = (lambda x, n, axis: torch.repeat_interleave(x, n, dim=axis))(v_cache, rep, axis=1)
        scores = torch.einsum("bhqd,bhkd->bhqk", q, k) * (Dh ** -0.5)
        p = _softmax(scores, axis=-1)
        o = torch.einsum("bhqk,bhkd->bhqd", p, v)
        return (lambda x, *d: x.permute(*d))(o, 0, 2, 1, 3).reshape(B, Sq, Hq * Dh) @ wo

    def _B_ref(x, k_cache, v_cache, wq, wo):
        B, Sq, D = x.shape
        Hq, Dh = 32, 128
        Hkv = k_cache.shape[1]
        rep = Hq // Hkv
        q = (lambda x, *d: x.permute(*d))((x @ wq).reshape(B, Sq, Hq, Dh), 0, 2, 1, 3)
        k = (lambda x, n, axis: torch.repeat_interleave(x, n, dim=axis))(k_cache, rep, axis=1)
        v = (lambda x, n, axis: torch.repeat_interleave(x, n, dim=axis))(v_cache, rep, axis=1)
        scores = torch.einsum("bhqd,bhkd->bhqk", q, k) * (Dh ** -0.5)
        p = _softmax(scores, axis=-1)
        o = torch.einsum("bhqk,bhkd->bhqd", p, v)
        return (lambda x, *d: x.permute(*d))(o, 0, 2, 1, 3).reshape(B, Sq, Hq * Dh) @ wo

    a = _A_ref(A_x, A_k_cache, A_v_cache, A_wq, A_wo)
    b = _B_ref(B_x, B_k_cache, B_v_cache, B_wq, B_wo)
    return torch.concatenate([a, b], axis=-1)
```

```asm
; @launch grid=(256,1,1) block=(256,1,1) lds=163840
.amdgcn_target "amdgcn-amd-amdhsa--gfx950"
.text
.globl concat_heads__gqa_block_cached__gqa_block_cached__near_ridge_kernel
.p2align 8
.type concat_heads__gqa_block_cached__gqa_block_cached__near_ridge_kernel,@function
concat_heads__gqa_block_cached__gqa_block_cached__near_ridge_kernel:
    s_cmp_ge_u32 s2, 256
    s_cbranch_scc1 L_end
    s_and_b32 s82, s2, 1
    s_bfe_u32 s81, s2, 0x20001
    s_mul_i32 s87, s82, 40
    s_add_u32 s92, s87, 32
    s_load_dwordx8 s[52:59], s[0:1], s87
    s_load_dwordx2 s[60:61], s[0:1], s92
    s_load_dwordx4 s[64:67], s[0:1], 80
    s_load_dwordx2 s[62:63], s[0:1], 96
    v_lshrrev_b32 v1, 6, v0
    v_and_b32 v0, 63, v0
    v_readfirstlane_b32 s3, v1
    s_getpc_b64 s[44:45]
L_pc:
    s_lshr_b32 s87, s2, 3
    s_lshl_b32 s87, s87, 2
    s_add_u32 s87, s87, s3
    s_lshl_b32 s87, s87, 9
    v_lshl_add_u32 v22, v0, 7, s87
    v_min_u32 v22, L_codeend-L_pc-4, v22
    v_mov_b32 v23, s45
    v_add_co_u32 v22, vcc, s44, v22
    s_mov_b64 exec, 15
    s_nop 0
    v_addc_co_u32 v23, vcc, 0, v23, vcc
    global_load_dword a255, v[22:23], off
    s_mov_b64 exec, -1
    s_lshr_b32 s80, s2, 4
    s_lshl_b32 s81, s81, 1
    s_bfe_u32 s87, s2, 0x10003
    s_add_u32 s81, s81, s87
    s_mul_i32 s87, s87, 5
    s_lshr_b32 s83, s81, 1
    s_add_u32 s87, s87, s83
    s_cmp_ge_u32 s80, 10
    s_cselect_b32 s100, 0, 0
    s_cselect_b32 s92, 10, 0
    s_sub_u32 s101, s80, s92
    s_add_u32 s83, s101, s87
    s_sub_u32 s92, s83, 10
    s_cselect_b32 s83, s83, s92
    s_and_b32 s87, s3, 1
    s_add_u32 s88, s83, s87
    s_sub_u32 s92, s88, 10
    s_cselect_b32 s88, s88, s92
    s_lshl_b32 s88, s88, 7
    s_lshl_b32 s83, s83, 19
    s_mul_i32 s89, s87, 10240
    s_lshr_b32 s87, s3, 1
    s_mul_i32 s92, s87, 5120
    s_add_u32 s89, s89, s92
    s_mul_i32 s94, s87, 51200
    v_lshrrev_b32 v16, 4, v0
    v_and_b32 v17, 15, v0
    v_lshrrev_b32 v18, 3, v0
    v_and_b32 v19, 7, v0
    v_and_b32 v20, 6, v18
    v_xor_b32 v20, v19, v20
    v_mul_u32_u24 v21, 1280, v18
    v_lshl_add_u32 v7, v20, 4, v21
    v_add_u32 v7, s94, v7
    v_lshlrev_b32 v21, 16, v16
    v_lshl_add_u32 v21, v17, 4, v21
    s_lshl_b32 s87, s100, 18
    s_xor_b32 s92, s87, 0x40000
    v_add_u32 v1, s87, v21
    v_add_u32 v3, s92, v21
    v_add_u32 v2, 0x8000, v1
    v_add_u32 v4, 0x8000, v3
    s_mul_i32 s87, s80, 102400
    s_and_b32 s47, s81, 1
    s_lshr_b32 s95, s81, 1
    s_lshl2_add_u32 s47, s47, s95
    s_lshl3_add_u32 s95, s3, s47
    s_lshl_b32 s92, s95, 8
    s_mov_b32 s6, 102400
    s_mov_b32 s7, 0x20000
    s_mov_b32 s10, 5210368
    s_mov_b32 s11, 0x20000
    s_mov_b32 s14, 5210368
    s_mov_b32 s15, 0x20000
    s_mov_b32 s18, 5210368
    s_mov_b32 s19, 0x20000
    s_mov_b32 s22, 5210368
    s_mov_b32 s23, 0x20000
    s_waitcnt lgkmcnt(0)
    s_add_u32 s4, s52, s87
    s_addc_u32 s5, s53, 0
    s_add_u32 m0, s89, 0
    s_add_u32 s94, s88, 0
    buffer_load_dwordx4 v7, s[4:7], s94 offen offset:0  lds
    s_add_u32 s8, s58, s92
    s_addc_u32 s9, s59, 0
    buffer_load_dwordx4 v[32:35], v1, s[8:11], s83 offen
    s_mov_b32 s84, 0x05040100
    s_mov_b32 s85, 0x07060302
    v_and_b32 v20, 6, v17
    v_xor_b32 v20, v16, v20
    v_lshlrev_b32 v21, 7, v17
    v_lshl_add_u32 v21, v20, 4, v21
    s_lshl_b32 s87, s100, 6
    v_xor_b32 v5, s87, v21
    v_xor_b32 v6, 64, v5
    s_lshl_b32 s78, s80, 5
    s_add_u32 s78, s78, s95
    s_mul_i32 s78, s78, 20480
    s_mul_i32 s86, s3, 15360
    s_add_u32 s86, s86, 102400
    s_add_u32 s24, s54, s78
    s_addc_u32 s25, s55, 0
    s_mov_b32 s26, 20480
    s_mov_b32 s27, 0x20000
    s_add_u32 s28, s56, s78
    s_addc_u32 s29, s57, 0
    s_mov_b32 s30, 20480
    s_mov_b32 s31, 0x20000
    s_mov_b32 s95, 0x6543210
    s_bitcmp1_b32 s2, 6
    s_cmov_b32 s95, 0x65434321
    s_mov_b32 s78, 0x10656543
    s_cmov_b32 s78, 0x21065432
    s_bitcmp1_b32 s2, 7
    s_cmov_b32 s95, s78
    s_bfe_u32 s78, s2, 0x30003
    s_lshl_b32 s78, s78, 2
    s_lshr_b32 s95, s95, s78
    s_and_b32 s95, s95, 15
    s_lshl_b32 s91, s3, 12
    v_lshrrev_b32 v12, 4, v0
    v_and_b32 v13, 15, v0
    v_xor_b32 v8, v13, v12
    v_lshlrev_b32 v8, 4, v8
    v_lshl_add_u32 v8, v12, 8, v8
    v_lshlrev_b32 v9, 1, v12
    v_xor_b32 v9, v13, v9
    v_lshlrev_b32 v9, 4, v9
    v_lshl_add_u32 v9, v12, 8, v9
    v_bfe_u32 v14, v0, 2, 1
    v_mul_u32_u24 v10, 2176, v14
    v_bfe_u32 v14, v0, 3, 1
    v_lshl_add_u32 v10, v14, 10, v10
    v_and_b32 v15, 3, v0
    v_mul_u32_u24 v14, 272, v15
    v_add3_u32 v10, v10, v14, s86
    v_lshl_add_u32 v10, v12, 6, v10
    v_bfe_u32 v14, v0, 4, 1
    v_mul_u32_u24 v11, 2176, v14
    v_lshrrev_b32 v14, 5, v0
    v_lshl_add_u32 v11, v14, 10, v11
    v_bfe_u32 v14, v0, 2, 2
    v_mul_u32_u24 v14, 288, v14
    v_add3_u32 v11, v11, v14, s86
    v_lshl_add_u32 v11, v15, 3, v11
    v_mov_b32 v13, 0x3f803f80
    v_accvgpr_write_b32 a232, v13
    v_accvgpr_write_b32 a233, v13
    v_accvgpr_write_b32 a234, v13
    v_accvgpr_write_b32 a235, v13
    v_accvgpr_write_b32 a236, -1
    v_accvgpr_write_b32 a237, -1
    v_accvgpr_write_b32 a238, -1
    v_accvgpr_write_b32 a239, -1
    v_lshlrev_b32 v14, 4, v0
    v_lshlrev_b32 v15, 3, v0
    s_lshl_b32 s79, s82, 4
    s_add_u32 s79, s79, s80
    s_lshl_b32 s78, s79, 3
    s_add_u32 s48, s66, s78
    s_addc_u32 s49, s67, 0
    s_mov_b32 s50, 4
    s_mov_b32 s51, 0x20000
    s_mul_i32 s78, s79, 774144
    s_add_u32 s36, s62, s78
    s_addc_u32 s37, s63, 0
    s_mov_b32 s38, 774144
    s_mov_b32 s39, 0x20000
    s_mul_i32 s78, s47, 163840
    s_add_u32 s32, s60, s78
    s_addc_u32 s33, s61, 0
    s_mov_b32 s34, 4096000
    s_mov_b32 s35, 0x20000
    s_mul_i32 s78, s80, 204800
    s_mul_i32 s79, s82, 1280
    s_add_u32 s78, s78, s79
    s_add_u32 s40, s64, s78
    s_addc_u32 s41, s65, 0
    s_mov_b32 s42, 203520
    s_mov_b32 s43, 0x20000
    s_add_u32 s98, s81, s101
    s_sub_u32 s78, s98, 10
    s_cselect_b32 s98, s98, s78
    s_add_u32 s90, s98, 1
    s_sub_u32 s78, s90, 10
    s_cselect_b32 s90, s90, s78
    s_lshl_b32 s90, s90, 7
    s_lshl_b32 s98, s98, 7
    s_lshr_b32 s97, s81, 2
    s_add_u32 s99, s97, s101
    s_add_u32 s99, s99, 8
    s_sub_u32 s78, s99, 10
    s_cselect_b32 s99, s99, s78
    s_lshl_b32 s99, s99, 7
    s_add_u32 s97, s97, 7
    s_mul_i32 s97, s97, 96768
    s_add_u32 s96, s81, 9
    s_sub_u32 s78, s96, 10
    s_cselect_b32 s96, s96, s78
    s_mul_i32 s96, s96, 96768
    s_mul_i32 s78, s3, 2688
    s_add_u32 s96, s96, s78
    s_add_u32 s97, s97, s78
    s_mul_i32 s93, s81, 96768
    s_add_u32 s93, s93, s78
    s_mov_b32 s100, s93
    s_mov_b32 s101, 881664
    s_mul_i32 s80, s3, 5120
    s_mov_b32 s82, 0x10543210
    s_bitcmp1_b32 s2, 6
    s_cmov_b32 s82, 0x54205432
    s_mov_b32 s78, 0x32105420
    s_cmov_b32 s78, 0x31543154
    s_bitcmp1_b32 s2, 7
    s_cmov_b32 s82, s78
    s_bfe_u32 s78, s2, 0x30003
    s_lshl_b32 s78, s78, 2
    s_lshr_b32 s82, s82, s78
    s_and_b32 s82, s82, 15
    s_mov_b32 s79, 200000
    s_mov_b32 s78, 0x3e0293ee
    s_add_u32 s94, s88, 9216
    buffer_load_dwordx4 v7, s[4:7], s94 offen offset:1024  lds
    s_add_u32 s94, s88, 18432
    buffer_load_dwordx4 v7, s[4:7], s94 offen offset:2048  lds
    s_add_u32 s94, s88, 27648
    buffer_load_dwordx4 v7, s[4:7], s94 offen offset:3072  lds
    s_add_u32 m0, s89, 4096
    s_add_u32 s94, s88, 40960
    buffer_load_dwordx4 v7, s[4:7], s94 offen offset:0  lds
    s_add_u32 s88, s88, 256
    s_sub_u32 s94, s88, 1280
    s_cselect_b32 s88, s88, s94
    s_add_u32 s12, s8, 8192
    s_addc_u32 s13, s9, 0
    buffer_load_dwordx4 v[36:39], v1, s[12:15], s83 offen
    s_add_u32 s16, s12, 8192
    s_addc_u32 s17, s13, 0
    buffer_load_dwordx4 v[40:43], v1, s[16:19], s83 offen
    s_add_u32 s20, s16, 8192
    s_addc_u32 s21, s17, 0
    buffer_load_dwordx4 v[44:47], v1, s[20:23], s83 offen
    buffer_load_dwordx4 v[48:51], v2, s[8:11], s83 offen
    buffer_load_dwordx4 v[52:55], v2, s[12:15], s83 offen
    buffer_load_dwordx4 v[56:59], v2, s[16:19], s83 offen
    buffer_load_dwordx4 v[60:63], v2, s[20:23], s83 offen
    v_lshrrev_b32 v13, 3, v0
    v_mul_u32_u24 v12, 10624, v13
    v_add_u32 v12, v12, v14
    v_lshl_add_u32 v13, v13, 24, v14
    s_add_u32 s92, s93, 86016
    s_sub_u32 s87, 3, s3
    s_lshl_b32 s87, s87, 28
    v_add_u32 v12, s87, v12
    v_add_u32 v13, s87, v13
    buffer_store_dwordx4 a[236:239], v12, s[36:39], s93 offen offset:2560 sc1
    buffer_store_dwordx4 a[236:239], v13, s[36:39], s92 offen offset:2560 sc1
    buffer_load_dwordx4 v[64:67], v3, s[8:11], s83 offen
    s_mov_b64 exec, 0
    s_cmp_eq_u32 s3, 0
    s_cbranch_scc1 L_pad1
    s_cmp_eq_u32 s3, 1
    s_cbranch_scc1 L_pad2
    s_cmp_eq_u32 s3, 2
    s_cbranch_scc1 L_pad3
    s_cmp_eq_u32 s3, 3
    s_cbranch_scc1 L_pad4
L_padback:
    s_mov_b64 exec, -1
    buffer_load_dwordx4 v[68:71], v3, s[12:15], s83 offen
    buffer_load_dwordx4 v[72:75], v3, s[16:19], s83 offen
    buffer_load_dwordx4 v[76:79], v3, s[20:23], s83 offen
    buffer_load_dwordx4 v[80:83], v4, s[8:11], s83 offen
    buffer_load_dwordx4 v[84:87], v4, s[12:15], s83 offen
    buffer_load_dwordx4 v[88:91], v4, s[16:19], s83 offen
    buffer_load_dwordx4 v[92:95], v4, s[20:23], s83 offen
    s_add_u32 s83, s83, 0x80000
    s_sub_u32 s87, s83, 5242880
    s_cselect_b32 s83, s83, s87
    buffer_load_dwordx4 v[96:99], v1, s[8:11], s83 offen
    buffer_load_dwordx4 v[100:103], v1, s[12:15], s83 offen
    s_branch L_main
.p2align 12
L_main:
    s_waitcnt vmcnt(19)
    s_barrier
    ds_read_b128 a[32:35], v5 offset:0
    ds_read_b128 a[36:39], v5 offset:2048
    ds_read_b128 a[40:43], v5 offset:4096
    ds_read_b128 a[44:47], v5 offset:6144
    ds_read_b128 a[48:51], v5 offset:8192
    s_waitcnt vmcnt(18)
    v_perm_b32 v16, v36, v32, s84
    s_waitcnt vmcnt(16)
    v_perm_b32 v17, v44, v40, s84
    s_waitcnt vmcnt(14)
    v_perm_b32 v18, v52, v48, s84
    s_waitcnt vmcnt(12)
    v_perm_b32 v19, v60, v56, s84
    v_perm_b32 v20, v36, v32, s85
    v_perm_b32 v21, v44, v40, s85
    v_perm_b32 v22, v52, v48, s85
    v_perm_b32 v23, v60, v56, s85
    s_waitcnt lgkmcnt(0)
    v_mfma_f32_16x16x32_bf16 v[128:131], v[16:19], a[32:35], 0
    v_perm_b32 v24, v37, v33, s84
    v_perm_b32 v25, v45, v41, s84
    v_mfma_f32_16x16x32_bf16 v[132:135], v[20:23], a[32:35], 0
    v_perm_b32 v26, v53, v49, s84
    v_perm_b32 v27, v61, v57, s84
    v_mfma_f32_16x16x32_bf16 v[164:167], v[20:23], a[36:39], 0
    v_perm_b32 v28, v37, v33, s85
    v_perm_b32 v29, v45, v41, s85
    v_mfma_f32_16x16x32_bf16 v[160:163], v[16:19], a[36:39], 0
    v_perm_b32 v30, v53, v49, s85
    v_perm_b32 v31, v61, v57, s85
    v_mfma_f32_16x16x32_bf16 v[192:195], v[16:19], a[40:43], 0
    v_mfma_f32_16x16x32_bf16 v[196:199], v[20:23], a[40:43], 0
    buffer_load_dwordx4 v[104:107], v1, s[16:19], s83 offen
    ds_read_b128 a[52:55], v6 offset:0
    v_mfma_f32_16x16x32_bf16 v[228:231], v[20:23], a[44:47], 0
    buffer_load_dwordx4 v[108:111], v1, s[20:23], s83 offen
    v_mfma_f32_16x16x32_bf16 v[224:227], v[16:19], a[44:47], 0
    buffer_load_dwordx4 v[112:115], v2, s[8:11], s83 offen
    ds_read_b128 a[56:59], v6 offset:2048
    v_mfma_f32_16x16x32_bf16 a[0:3], v[16:19], a[48:51], 0
    buffer_load_dwordx4 v[116:119], v2, s[12:15], s83 offen
    v_mfma_f32_16x16x32_bf16 a[4:7], v[20:23], a[48:51], 0
    v_mfma_f32_16x16x32_bf16 a[8:11], v[24:27], a[48:51], 0
    v_perm_b32 v16, v38, v34, s84
    v_perm_b32 v17, v46, v42, s84
    v_mfma_f32_16x16x32_bf16 a[12:15], v[28:31], a[48:51], 0
    v_perm_b32 v18, v54, v50, s84
    v_perm_b32 v19, v62, v58, s84
    v_mfma_f32_16x16x32_bf16 v[236:239], v[28:31], a[44:47], 0
    v_perm_b32 v20, v38, v34, s85
    v_perm_b32 v21, v46, v42, s85
    v_mfma_f32_16x16x32_bf16 v[232:235], v[24:27], a[44:47], 0
    v_perm_b32 v22, v54, v50, s85
    v_perm_b32 v23, v62, v58, s85
    v_mfma_f32_16x16x32_bf16 v[200:203], v[24:27], a[40:43], 0
    v_mfma_f32_16x16x32_bf16 v[204:207], v[28:31], a[40:43], 0
    buffer_load_dwordx4 v[120:123], v2, s[16:19], s83 offen
    ds_read_b128 a[60:63], v6 offset:4096
    v_mfma_f32_16x16x32_bf16 v[172:175], v[28:31], a[36:39], 0
    v_mfma_f32_16x16x32_bf16 v[168:171], v[24:27], a[36:39], 0
    buffer_load_dwordx4 v[124:127], v2, s[20:23], s83 offen
    ds_read_b128 a[64:67], v6 offset:6144
    v_mfma_f32_16x16x32_bf16 v[136:139], v[24:27], a[32:35], 0
    v_mfma_f32_16x16x32_bf16 v[140:143], v[28:31], a[32:35], 0
    v_mfma_f32_16x16x32_bf16 v[144:147], v[16:19], a[32:35], 0
    v_perm_b32 v24, v39, v35, s84
    v_perm_b32 v25, v47, v43, s84
    v_mfma_f32_16x16x32_bf16 v[148:151], v[20:23], a[32:35], 0
    v_perm_b32 v26, v55, v51, s84
    v_perm_b32 v27, v63, v59, s84
    v_mfma_f32_16x16x32_bf16 v[180:183], v[20:23], a[36:39], 0
    v_perm_b32 v28, v39, v35, s85
    v_perm_b32 v29, v47, v43, s85
    v_mfma_f32_16x16x32_bf16 v[176:179], v[16:19], a[36:39], 0
    v_perm_b32 v30, v55, v51, s85
    v_perm_b32 v31, v63, v59, s85
    v_mfma_f32_16x16x32_bf16 v[208:211], v[16:19], a[40:43], 0
    v_mfma_f32_16x16x32_bf16 v[212:215], v[20:23], a[40:43], 0
    buffer_load_dwordx4 v[32:35], v3, s[8:11], s83 offen
    ds_read_b128 a[68:71], v6 offset:8192
    v_mfma_f32_16x16x32_bf16 v[244:247], v[20:23], a[44:47], 0
    v_mfma_f32_16x16x32_bf16 v[240:243], v[16:19], a[44:47], 0
    buffer_load_dwordx4 v[36:39], v3, s[12:15], s83 offen
    v_mfma_f32_16x16x32_bf16 a[16:19], v[16:19], a[48:51], 0
    v_mfma_f32_16x16x32_bf16 a[20:23], v[20:23], a[48:51], 0
    v_mfma_f32_16x16x32_bf16 a[24:27], v[24:27], a[48:51], 0
    s_waitcnt vmcnt(10)
    v_perm_b32 v16, v71, v67, s84
    v_perm_b32 v17, v79, v75, s84
    v_mfma_f32_16x16x32_bf16 a[28:31], v[28:31], a[48:51], 0
    v_perm_b32 v18, v87, v83, s84
    v_perm_b32 v19, v95, v91, s84
    v_mfma_f32_16x16x32_bf16 v[252:255], v[28:31], a[44:47], 0
    v_perm_b32 v20, v71, v67, s85
    v_perm_b32 v21, v79, v75, s85
    v_mfma_f32_16x16x32_bf16 v[248:251], v[24:27], a[44:47], 0
    v_perm_b32 v22, v87, v83, s85
    v_perm_b32 v23, v95, v91, s85
    v_mfma_f32_16x16x32_bf16 v[216:219], v[24:27], a[40:43], 0
    v_mfma_f32_16x16x32_bf16 v[220:223], v[28:31], a[40:43], 0
    buffer_load_dwordx4 v[40:43], v3, s[16:19], s83 offen
    v_mfma_f32_16x16x32_bf16 v[188:191], v[28:31], a[36:39], 0
    v_mfma_f32_16x16x32_bf16 v[184:187], v[24:27], a[36:39], 0
    buffer_load_dwordx4 v[44:47], v3, s[20:23], s83 offen
    v_mfma_f32_16x16x32_bf16 v[152:155], v[24:27], a[32:35], 0
    v_mfma_f32_16x16x32_bf16 v[156:159], v[28:31], a[32:35], 0
    s_waitcnt lgkmcnt(0)
    v_mfma_f32_16x16x32_bf16 v[156:159], v[20:23], a[52:55], v[156:159]
    v_perm_b32 v24, v70, v66, s84
    v_perm_b32 v25, v78, v74, s84
    v_mfma_f32_16x16x32_bf16 v[152:155], v[16:19], a[52:55], v[152:155]
    v_perm_b32 v26, v86, v82, s84
    v_perm_b32 v27, v94, v90, s84
    v_mfma_f32_16x16x32_bf16 v[184:187], v[16:19], a[56:59], v[184:187]
    v_perm_b32 v28, v70, v66, s85
    v_perm_b32 v29, v78, v74, s85
    v_mfma_f32_16x16x32_bf16 v[188:191], v[20:23], a[56:59], v[188:191]
    v_perm_b32 v30, v86, v82, s85
    v_perm_b32 v31, v94, v90, s85
    v_mfma_f32_16x16x32_bf16 v[220:223], v[20:23], a[60:63], v[220:223]
    s_add_u32 m0, s89, 20480
    s_add_u32 s94, s88, 0
    v_mfma_f32_16x16x32_bf16 v[216:219], v[16:19], a[60:63], v[216:219]
    buffer_load_dwordx4 v7, s[4:7], s94 offen offset:0  lds
    ds_read_b128 a[32:35], v5 offset:10240
    v_mfma_f32_16x16x32_bf16 v[248:251], v[16:19], a[64:67], v[248:251]
    s_add_u32 s94, s88, 9216
    buffer_load_dwordx4 v7, s[4:7], s94 offen offset:1024  lds
    v_mfma_f32_16x16x32_bf16 v[252:255], v[20:23], a[64:67], v[252:255]
    s_add_u32 s94, s88, 18432
    ds_read_b128 a[36:39], v5 offset:12288
    v_mfma_f32_16x16x32_bf16 a[28:31], v[20:23], a[68:71], a[28:31]
    buffer_load_dwordx4 v7, s[4:7], s94 offen offset:2048  lds
    s_add_u32 s94, s88, 27648
    v_mfma_f32_16x16x32_bf16 a[24:27], v[16:19], a[68:71], a[24:27]
    buffer_load_dwordx4 v7, s[4:7], s94 offen offset:3072  lds
    s_add_u32 m0, s89, 24576
    v_mfma_f32_16x16x32_bf16 a[20:23], v[28:31], a[68:71], a[20:23]
    s_add_u32 s94, s88, 40960
    v_perm_b32 v16, v69, v65, s84
    v_perm_b32 v17, v77, v73, s84
    v_mfma_f32_16x16x32_bf16 a[16:19], v[24:27], a[68:71], a[16:19]
    v_perm_b32 v18, v85, v81, s84
    v_perm_b32 v19, v93, v89, s84
    v_mfma_f32_16x16x32_bf16 v[240:243], v[24:27], a[64:67], v[240:243]
    v_perm_b32 v20, v69, v65, s85
    v_perm_b32 v21, v77, v73, s85
    v_mfma_f32_16x16x32_bf16 v[244:247], v[28:31], a[64:67], v[244:247]
    v_perm_b32 v22, v85, v81, s85
    v_perm_b32 v23, v93, v89, s85
    v_mfma_f32_16x16x32_bf16 v[212:215], v[28:31], a[60:63], v[212:215]
    buffer_load_dwordx4 v7, s[4:7], s94 offen offset:0  lds
    s_add_u32 s88, s88, 256
    v_mfma_f32_16x16x32_bf16 v[208:211], v[24:27], a[60:63], v[208:211]
    s_sub_u32 s94, s88, 1280
    s_cselect_b32 s88, s88, s94
    ds_read_b128 a[40:43], v5 offset:14336
    v_mfma_f32_16x16x32_bf16 v[176:179], v[24:27], a[56:59], v[176:179]
    buffer_load_dwordx4 v[48:51], v4, s[8:11], s83 offen
    v_mfma_f32_16x16x32_bf16 v[180:183], v[28:31], a[56:59], v[180:183]
    buffer_load_dwordx4 v[52:55], v4, s[12:15], s83 offen
    ds_read_b128 a[44:47], v5 offset:16384
    v_mfma_f32_16x16x32_bf16 v[148:151], v[28:31], a[52:55], v[148:151]
    buffer_load_dwordx4 v[56:59], v4, s[16:19], s83 offen
    v_mfma_f32_16x16x32_bf16 v[144:147], v[24:27], a[52:55], v[144:147]
    buffer_load_dwordx4 v[60:63], v4, s[20:23], s83 offen
    s_add_u32 s83, s83, 0x80000
    v_mfma_f32_16x16x32_bf16 v[140:143], v[20:23], a[52:55], v[140:143]
    s_sub_u32 s87, s83, 5242880
    s_cselect_b32 s83, s83, s87
    v_perm_b32 v24, v68, v64, s84
    v_perm_b32 v25, v76, v72, s84
    v_mfma_f32_16x16x32_bf16 v[136:139], v[16:19], a[52:55], v[136:139]
    v_perm_b32 v26, v84, v80, s84
    v_perm_b32 v27, v92, v88, s84
    v_mfma_f32_16x16x32_bf16 v[168:171], v[16:19], a[56:59], v[168:171]
    v_perm_b32 v28, v68, v64, s85
    v_perm_b32 v29, v76, v72, s85
    v_mfma_f32_16x16x32_bf16 v[172:175], v[20:23], a[56:59], v[172:175]
    v_perm_b32 v30, v84, v80, s85
    v_perm_b32 v31, v92, v88, s85
    v_mfma_f32_16x16x32_bf16 v[204:207], v[20:23], a[60:63], v[204:207]
    v_mfma_f32_16x16x32_bf16 v[200:203], v[16:19], a[60:63], v[200:203]
    buffer_load_dwordx4 v[64:67], v1, s[8:11], s83 offen
    ds_read_b128 a[48:51], v5 offset:18432
    v_mfma_f32_16x16x32_bf16 v[232:235], v[16:19], a[64:67], v[232:235]
    v_mfma_f32_16x16x32_bf16 v[236:239], v[20:23], a[64:67], v[236:239]
    buffer_load_dwordx4 v[68:71], v1, s[12:15], s83 offen
    v_mfma_f32_16x16x32_bf16 a[12:15], v[20:23], a[68:71], a[12:15]
    v_mfma_f32_16x16x32_bf16 a[8:11], v[16:19], a[68:71], a[8:11]
    v_mfma_f32_16x16x32_bf16 a[4:7], v[28:31], a[68:71], a[4:7]
    s_waitcnt vmcnt(15)
    v_perm_b32 v16, v100, v96, s84
    v_perm_b32 v17, v108, v104, s84
    v_mfma_f32_16x16x32_bf16 a[0:3], v[24:27], a[68:71], a[0:3]
    v_perm_b32 v18, v116, v112, s84
    v_perm_b32 v19, v124, v120, s84
    v_mfma_f32_16x16x32_bf16 v[224:227], v[24:27], a[64:67], v[224:227]
    v_perm_b32 v20, v100, v96, s85
    v_perm_b32 v21, v108, v104, s85
    v_mfma_f32_16x16x32_bf16 v[228:231], v[28:31], a[64:67], v[228:231]
    v_perm_b32 v22, v116, v112, s85
    v_perm_b32 v23, v124, v120, s85
    v_mfma_f32_16x16x32_bf16 v[196:199], v[28:31], a[60:63], v[196:199]
    v_mfma_f32_16x16x32_bf16 v[192:195], v[24:27], a[60:63], v[192:195]
    buffer_load_dwordx4 v[72:75], v1, s[16:19], s83 offen
    s_cmp_eq_u32 s95, 0
    v_mfma_f32_16x16x32_bf16 v[160:163], v[24:27], a[56:59], v[160:163]
    s_cbranch_scc1 L_ool0
L_ret0:
    v_mfma_f32_16x16x32_bf16 v[164:167], v[28:31], a[56:59], v[164:167]
    buffer_load_dwordx4 v[76:79], v1, s[20:23], s83 offen
    v_mfma_f32_16x16x32_bf16 v[132:135], v[28:31], a[52:55], v[132:135]
    v_mfma_f32_16x16x32_bf16 v[128:131], v[24:27], a[52:55], v[128:131]
    s_waitcnt lgkmcnt(0)
    v_mfma_f32_16x16x32_bf16 v[128:131], v[16:19], a[32:35], v[128:131]
    v_perm_b32 v24, v101, v97, s84
    v_perm_b32 v25, v109, v105, s84
    v_mfma_f32_16x16x32_bf16 v[132:135], v[20:23], a[32:35], v[132:135]
    v_perm_b32 v26, v117, v113, s84
    v_perm_b32 v27, v125, v121, s84
    v_mfma_f32_16x16x32_bf16 v[164:167], v[20:23], a[36:39], v[164:167]
    v_perm_b32 v28, v101, v97, s85
    v_perm_b32 v29, v109, v105, s85
    v_mfma_f32_16x16x32_bf16 v[160:163], v[16:19], a[36:39], v[160:163]
    v_perm_b32 v30, v117, v113, s85
    v_perm_b32 v31, v125, v121, s85
    v_mfma_f32_16x16x32_bf16 v[192:195], v[16:19], a[40:43], v[192:195]
    v_mfma_f32_16x16x32_bf16 v[196:199], v[20:23], a[40:43], v[196:199]
    buffer_load_dwordx4 v[80:83], v2, s[8:11], s83 offen
    ds_read_b128 a[52:55], v6 offset:10240
    v_mfma_f32_16x16x32_bf16 v[228:231], v[20:23], a[44:47], v[228:231]
    v_mfma_f32_16x16x32_bf16 v[224:227], v[16:19], a[44:47], v[224:227]
    buffer_load_dwordx4 v[84:87], v2, s[12:15], s83 offen
    ds_read_b128 a[56:59], v6 offset:12288
    v_mfma_f32_16x16x32_bf16 a[0:3], v[16:19], a[48:51], a[0:3]
    v_mfma_f32_16x16x32_bf16 a[4:7], v[20:23], a[48:51], a[4:7]
    v_mfma_f32_16x16x32_bf16 a[8:11], v[24:27], a[48:51], a[8:11]
    v_perm_b32 v16, v102, v98, s84
    v_perm_b32 v17, v110, v106, s84
    v_mfma_f32_16x16x32_bf16 a[12:15], v[28:31], a[48:51], a[12:15]
    v_perm_b32 v18, v118, v114, s84
    v_perm_b32 v19, v126, v122, s84
    v_mfma_f32_16x16x32_bf16 v[236:239], v[28:31], a[44:47], v[236:239]
    v_perm_b32 v20, v102, v98, s85
    v_perm_b32 v21, v110, v106, s85
    v_mfma_f32_16x16x32_bf16 v[232:235], v[24:27], a[44:47], v[232:235]
    v_perm_b32 v22, v118, v114, s85
    v_perm_b32 v23, v126, v122, s85
    v_mfma_f32_16x16x32_bf16 v[200:203], v[24:27], a[40:43], v[200:203]
    v_mfma_f32_16x16x32_bf16 v[204:207], v[28:31], a[40:43], v[204:207]
    buffer_load_dwordx4 v[88:91], v2, s[16:19], s83 offen
    ds_read_b128 a[60:63], v6 offset:14336
    v_mfma_f32_16x16x32_bf16 v[172:175], v[28:31], a[36:39], v[172:175]
    v_mfma_f32_16x16x32_bf16 v[168:171], v[24:27], a[36:39], v[168:171]
    buffer_load_dwordx4 v[92:95], v2, s[20:23], s83 offen
    ds_read_b128 a[64:67], v6 offset:16384
    v_mfma_f32_16x16x32_bf16 v[136:139], v[24:27], a[32:35], v[136:139]
    v_mfma_f32_16x16x32_bf16 v[140:143], v[28:31], a[32:35], v[140:143]
    v_mfma_f32_16x16x32_bf16 v[144:147], v[16:19], a[32:35], v[144:147]
    v_perm_b32 v24, v103, v99, s84
    v_perm_b32 v25, v111, v107, s84
    v_mfma_f32_16x16x32_bf16 v[148:151], v[20:23], a[32:35], v[148:151]
    v_perm_b32 v26, v119, v115, s84
    v_perm_b32 v27, v127, v123, s84
    v_mfma_f32_16x16x32_bf16 v[180:183], v[20:23], a[36:39], v[180:183]
    v_perm_b32 v28, v103, v99, s85
    v_perm_b32 v29, v111, v107, s85
    v_mfma_f32_16x16x32_bf16 v[176:179], v[16:19], a[36:39], v[176:179]
    v_perm_b32 v30, v119, v115, s85
    v_perm_b32 v31, v127, v123, s85
    v_mfma_f32_16x16x32_bf16 v[208:211], v[16:19], a[40:43], v[208:211]
    v_mfma_f32_16x16x32_bf16 v[212:215], v[20:23], a[40:43], v[212:215]
    buffer_load_dwordx4 v[96:99], v3, s[8:11], s83 offen
    ds_read_b128 a[68:71], v6 offset:18432
    v_mfma_f32_16x16x32_bf16 v[244:247], v[20:23], a[44:47], v[244:247]
    v_mfma_f32_16x16x32_bf16 v[240:243], v[16:19], a[44:47], v[240:243]
    buffer_load_dwordx4 v[100:103], v3, s[12:15], s83 offen
    v_mfma_f32_16x16x32_bf16 a[16:19], v[16:19], a[48:51], a[16:19]
    v_mfma_f32_16x16x32_bf16 a[20:23], v[20:23], a[48:51], a[20:23]
    v_mfma_f32_16x16x32_bf16 a[24:27], v[24:27], a[48:51], a[24:27]
    s_waitcnt vmcnt(10)
    v_perm_b32 v16, v39, v35, s84
    v_perm_b32 v17, v47, v43, s84
    v_mfma_f32_16x16x32_bf16 a[28:31], v[28:31], a[48:51], a[28:31]
    v_perm_b32 v18, v55, v51, s84
    v_perm_b32 v19, v63, v59, s84
    v_mfma_f32_16x16x32_bf16 v[252:255], v[28:31], a[44:47], v[252:255]
    v_perm_b32 v20, v39, v35, s85
    v_perm_b32 v21, v47, v43, s85
    v_mfma_f32_16x16x32_bf16 v[248:251], v[24:27], a[44:47], v[248:251]
    v_perm_b32 v22, v55, v51, s85
    v_perm_b32 v23, v63, v59, s85
    v_mfma_f32_16x16x32_bf16 v[216:219], v[24:27], a[40:43], v[216:219]
    s_add_u32 m0, s89, 40960
    s_add_u32 s94, s88, 0
    v_mfma_f32_16x16x32_bf16 v[220:223], v[28:31], a[40:43], v[220:223]
    buffer_load_dwordx4 v7, s[4:7], s94 offen offset:0  lds
    s_add_u32 s94, s88, 9216
    v_mfma_f32_16x16x32_bf16 v[188:191], v[28:31], a[36:39], v[188:191]
    buffer_load_dwordx4 v7, s[4:7], s94 offen offset:1024  lds
    s_add_u32 s94, s88, 18432
    v_mfma_f32_16x16x32_bf16 v[184:187], v[24:27], a[36:39], v[184:187]
    buffer_load_dwordx4 v7, s[4:7], s94 offen offset:2048  lds
    s_add_u32 s94, s88, 27648
    v_mfma_f32_16x16x32_bf16 v[152:155], v[24:27], a[32:35], v[152:155]
    buffer_load_dwordx4 v7, s[4:7], s94 offen offset:3072  lds
    s_add_u32 m0, s89, 45056
    v_mfma_f32_16x16x32_bf16 v[156:159], v[28:31], a[32:35], v[156:159]
    s_waitcnt lgkmcnt(0)
    s_add_u32 s94, s88, 40960
    buffer_load_dwordx4 v7, s[4:7], s94 offen offset:0  lds
    v_mfma_f32_16x16x32_bf16 v[156:159], v[20:23], a[52:55], v[156:159]
    s_add_u32 s88, s88, 256
    v_perm_b32 v24, v38, v34, s84
    v_perm_b32 v25, v46, v42, s84
    v_mfma_f32_16x16x32_bf16 v[152:155], v[16:19], a[52:55], v[152:155]
    s_sub_u32 s94, s88, 1280
    s_cselect_b32 s88, s88, s94
    v_perm_b32 v26, v54, v50, s84
    v_perm_b32 v27, v62, v58, s84
    v_mfma_f32_16x16x32_bf16 v[184:187], v[16:19], a[56:59], v[184:187]
    v_perm_b32 v28, v38, v34, s85
    v_perm_b32 v29, v46, v42, s85
    v_mfma_f32_16x16x32_bf16 v[188:191], v[20:23], a[56:59], v[188:191]
    v_perm_b32 v30, v54, v50, s85
    v_perm_b32 v31, v62, v58, s85
    v_mfma_f32_16x16x32_bf16 v[220:223], v[20:23], a[60:63], v[220:223]
    s_barrier
    v_mfma_f32_16x16x32_bf16 v[216:219], v[16:19], a[60:63], v[216:219]
    buffer_load_dwordx4 v[104:107], v3, s[16:19], s83 offen
    ds_read_b128 a[32:35], v5 offset:20480
    v_mfma_f32_16x16x32_bf16 v[248:251], v[16:19], a[64:67], v[248:251]
    s_cmp_eq_u32 s95, 1
    v_mfma_f32_16x16x32_bf16 v[252:255], v[20:23], a[64:67], v[252:255]
    ds_read_b128 a[36:39], v5 offset:22528
    v_mfma_f32_16x16x32_bf16 a[28:31], v[20:23], a[68:71], a[28:31]
    s_cbranch_scc1 L_ool1
L_ret1:
    v_mfma_f32_16x16x32_bf16 a[24:27], v[16:19], a[68:71], a[24:27]
    buffer_load_dwordx4 v[108:111], v3, s[20:23], s83 offen
    buffer_load_dwordx4 v[112:115], v4, s[8:11], s83 offen
    v_mfma_f32_16x16x32_bf16 a[20:23], v[28:31], a[68:71], a[20:23]
    buffer_load_dwordx4 v[116:119], v4, s[12:15], s83 offen
    v_perm_b32 v16, v37, v33, s84
    v_perm_b32 v17, v45, v41, s84
    v_mfma_f32_16x16x32_bf16 a[16:19], v[24:27], a[68:71], a[16:19]
    v_perm_b32 v18, v53, v49, s84
    v_perm_b32 v19, v61, v57, s84
    v_mfma_f32_16x16x32_bf16 v[240:243], v[24:27], a[64:67], v[240:243]
    v_perm_b32 v20, v37, v33, s85
    v_perm_b32 v21, v45, v41, s85
    v_mfma_f32_16x16x32_bf16 v[244:247], v[28:31], a[64:67], v[244:247]
    v_perm_b32 v22, v53, v49, s85
    v_perm_b32 v23, v61, v57, s85
    v_mfma_f32_16x16x32_bf16 v[212:215], v[28:31], a[60:63], v[212:215]
    v_mfma_f32_16x16x32_bf16 v[208:211], v[24:27], a[60:63], v[208:211]
    buffer_load_dwordx4 v[120:123], v4, s[16:19], s83 offen
    ds_read_b128 a[40:43], v5 offset:24576
    v_mfma_f32_16x16x32_bf16 v[176:179], v[24:27], a[56:59], v[176:179]
    v_mfma_f32_16x16x32_bf16 v[180:183], v[28:31], a[56:59], v[180:183]
    buffer_load_dwordx4 v[124:127], v4, s[20:23], s83 offen
    ds_read_b128 a[44:47], v5 offset:26624
    v_mfma_f32_16x16x32_bf16 v[148:151], v[28:31], a[52:55], v[148:151]
    s_add_u32 s83, s83, 0x80000
    s_sub_u32 s87, s83, 5242880
    s_cselect_b32 s83, s83, s87
    v_mfma_f32_16x16x32_bf16 v[144:147], v[24:27], a[52:55], v[144:147]
    v_mfma_f32_16x16x32_bf16 v[140:143], v[20:23], a[52:55], v[140:143]
    v_perm_b32 v24, v36, v32, s84
    v_perm_b32 v25, v44, v40, s84
    v_mfma_f32_16x16x32_bf16 v[136:139], v[16:19], a[52:55], v[136:139]
    v_perm_b32 v26, v52, v48, s84
    v_perm_b32 v27, v60, v56, s84
    v_mfma_f32_16x16x32_bf16 v[168:171], v[16:19], a[56:59], v[168:171]
    v_perm_b32 v28, v36, v32, s85
    v_perm_b32 v29, v44, v40, s85
    v_mfma_f32_16x16x32_bf16 v[172:175], v[20:23], a[56:59], v[172:175]
    v_perm_b32 v30, v52, v48, s85
    v_perm_b32 v31, v60, v56, s85
    v_mfma_f32_16x16x32_bf16 v[204:207], v[20:23], a[60:63], v[204:207]
    v_mfma_f32_16x16x32_bf16 v[200:203], v[16:19], a[60:63], v[200:203]
    buffer_load_dwordx4 v[32:35], v1, s[8:11], s83 offen
    ds_read_b128 a[48:51], v5 offset:28672
    v_mfma_f32_16x16x32_bf16 v[232:235], v[16:19], a[64:67], v[232:235]
    v_mfma_f32_16x16x32_bf16 v[236:239], v[20:23], a[64:67], v[236:239]
    buffer_load_dwordx4 v[36:39], v1, s[12:15], s83 offen
    v_mfma_f32_16x16x32_bf16 a[12:15], v[20:23], a[68:71], a[12:15]
    v_mfma_f32_16x16x32_bf16 a[8:11], v[16:19], a[68:71], a[8:11]
    v_mfma_f32_16x16x32_bf16 a[4:7], v[28:31], a[68:71], a[4:7]
    s_waitcnt vmcnt(15)
    v_perm_b32 v16, v68, v64, s84
    v_perm_b32 v17, v76, v72, s84
    v_mfma_f32_16x16x32_bf16 a[0:3], v[24:27], a[68:71], a[0:3]
    v_perm_b32 v18, v84, v80, s84
    v_perm_b32 v19, v92, v88, s84
    v_mfma_f32_16x16x32_bf16 v[224:227], v[24:27], a[64:67], v[224:227]
    v_perm_b32 v20, v68, v64, s85
    v_perm_b32 v21, v76, v72, s85
    v_mfma_f32_16x16x32_bf16 v[228:231], v[28:31], a[64:67], v[228:231]
    v_perm_b32 v22, v84, v80, s85
    v_perm_b32 v23, v92, v88, s85
    v_mfma_f32_16x16x32_bf16 v[196:199], v[28:31], a[60:63], v[196:199]
    v_mfma_f32_16x16x32_bf16 v[192:195], v[24:27], a[60:63], v[192:195]
    buffer_load_dwordx4 v[40:43], v1, s[16:19], s83 offen
    s_cmp_eq_u32 s95, 2
    v_mfma_f32_16x16x32_bf16 v[160:163], v[24:27], a[56:59], v[160:163]
    s_cbranch_scc1 L_ool2
L_ret2:
    v_mfma_f32_16x16x32_bf16 v[164:167], v[28:31], a[56:59], v[164:167]
    buffer_load_dwordx4 v[44:47], v1, s[20:23], s83 offen
    v_mfma_f32_16x16x32_bf16 v[132:135], v[28:31], a[52:55], v[132:135]
    v_mfma_f32_16x16x32_bf16 v[128:131], v[24:27], a[52:55], v[128:131]
    s_waitcnt lgkmcnt(0)
    v_mfma_f32_16x16x32_bf16 v[128:131], v[16:19], a[32:35], v[128:131]
    v_perm_b32 v24, v69, v65, s84
    v_perm_b32 v25, v77, v73, s84
    v_mfma_f32_16x16x32_bf16 v[132:135], v[20:23], a[32:35], v[132:135]
    v_perm_b32 v26, v85, v81, s84
    v_perm_b32 v27, v93, v89, s84
    v_mfma_f32_16x16x32_bf16 v[164:167], v[20:23], a[36:39], v[164:167]
    v_perm_b32 v28, v69, v65, s85
    v_perm_b32 v29, v77, v73, s85
    v_mfma_f32_16x16x32_bf16 v[160:163], v[16:19], a[36:39], v[160:163]
    v_perm_b32 v30, v85, v81, s85
    v_perm_b32 v31, v93, v89, s85
    v_mfma_f32_16x16x32_bf16 v[192:195], v[16:19], a[40:43], v[192:195]
    v_mfma_f32_16x16x32_bf16 v[196:199], v[20:23], a[40:43], v[196:199]
    buffer_load_dwordx4 v[48:51], v2, s[8:11], s83 offen
    ds_read_b128 a[52:55], v6 offset:20480
    v_mfma_f32_16x16x32_bf16 v[228:231], v[20:23], a[44:47], v[228:231]
    v_mfma_f32_16x16x32_bf16 v[224:227], v[16:19], a[44:47], v[224:227]
    buffer_load_dwordx4 v[52:55], v2, s[12:15], s83 offen
    ds_read_b128 a[56:59], v6 offset:22528
    v_mfma_f32_16x16x32_bf16 a[0:3], v[16:19], a[48:51], a[0:3]
    v_mfma_f32_16x16x32_bf16 a[4:7], v[20:23], a[48:51], a[4:7]
    v_mfma_f32_16x16x32_bf16 a[8:11], v[24:27], a[48:51], a[8:11]
    v_perm_b32 v16, v70, v66, s84
    v_perm_b32 v17, v78, v74, s84
    v_mfma_f32_16x16x32_bf16 a[12:15], v[28:31], a[48:51], a[12:15]
    v_perm_b32 v18, v86, v82, s84
    v_perm_b32 v19, v94, v90, s84
    v_mfma_f32_16x16x32_bf16 v[236:239], v[28:31], a[44:47], v[236:239]
    v_perm_b32 v20, v70, v66, s85
    v_perm_b32 v21, v78, v74, s85
    v_mfma_f32_16x16x32_bf16 v[232:235], v[24:27], a[44:47], v[232:235]
    v_perm_b32 v22, v86, v82, s85
    v_perm_b32 v23, v94, v90, s85
    v_mfma_f32_16x16x32_bf16 v[200:203], v[24:27], a[40:43], v[200:203]
    v_mfma_f32_16x16x32_bf16 v[204:207], v[28:31], a[40:43], v[204:207]
    buffer_load_dwordx4 v[56:59], v2, s[16:19], s83 offen
    ds_read_b128 a[60:63], v6 offset:24576
    v_mfma_f32_16x16x32_bf16 v[172:175], v[28:31], a[36:39], v[172:175]
    v_mfma_f32_16x16x32_bf16 v[168:171], v[24:27], a[36:39], v[168:171]
    buffer_load_dwordx4 v[60:63], v2, s[20:23], s83 offen
    ds_read_b128 a[64:67], v6 offset:26624
    v_mfma_f32_16x16x32_bf16 v[136:139], v[24:27], a[32:35], v[136:139]
    s_add_u32 s94, s88, 0
    v_mfma_f32_16x16x32_bf16 v[140:143], v[28:31], a[32:35], v[140:143]
    s_add_u32 m0, s89, 61440
    s_nop 0
    buffer_load_dwordx4 v7, s[4:7], s94 offen offset:0  lds
    v_mfma_f32_16x16x32_bf16 v[144:147], v[16:19], a[32:35], v[144:147]
    v_perm_b32 v24, v71, v67, s84
    v_perm_b32 v25, v79, v75, s84
    v_mfma_f32_16x16x32_bf16 v[148:151], v[20:23], a[32:35], v[148:151]
    v_perm_b32 v26, v87, v83, s84
    v_perm_b32 v27, v95, v91, s84
    v_mfma_f32_16x16x32_bf16 v[180:183], v[20:23], a[36:39], v[180:183]
    v_perm_b32 v28, v71, v67, s85
    v_perm_b32 v29, v79, v75, s85
    v_mfma_f32_16x16x32_bf16 v[176:179], v[16:19], a[36:39], v[176:179]
    v_perm_b32 v30, v87, v83, s85
    v_perm_b32 v31, v95, v91, s85
    v_mfma_f32_16x16x32_bf16 v[208:211], v[16:19], a[40:43], v[208:211]
    v_mfma_f32_16x16x32_bf16 v[212:215], v[20:23], a[40:43], v[212:215]
    buffer_load_dwordx4 v[64:67], v3, s[8:11], s83 offen
    ds_read_b128 a[68:71], v6 offset:28672
    v_mfma_f32_16x16x32_bf16 v[244:247], v[20:23], a[44:47], v[244:247]
    v_mfma_f32_16x16x32_bf16 v[240:243], v[16:19], a[44:47], v[240:243]
    buffer_load_dwordx4 v[68:71], v3, s[12:15], s83 offen
    v_mfma_f32_16x16x32_bf16 a[16:19], v[16:19], a[48:51], a[16:19]
    v_mfma_f32_16x16x32_bf16 a[20:23], v[20:23], a[48:51], a[20:23]
    v_mfma_f32_16x16x32_bf16 a[24:27], v[24:27], a[48:51], a[24:27]
    s_waitcnt vmcnt(11)
    v_perm_b32 v16, v103, v99, s84
    v_perm_b32 v17, v111, v107, s84
    v_mfma_f32_16x16x32_bf16 a[28:31], v[28:31], a[48:51], a[28:31]
    v_perm_b32 v18, v119, v115, s84
    v_perm_b32 v19, v127, v123, s84
    v_mfma_f32_16x16x32_bf16 v[252:255], v[28:31], a[44:47], v[252:255]
    v_perm_b32 v20, v103, v99, s85
    v_perm_b32 v21, v111, v107, s85
    v_mfma_f32_16x16x32_bf16 v[248:251], v[24:27], a[44:47], v[248:251]
    v_perm_b32 v22, v119, v115, s85
    v_perm_b32 v23, v127, v123, s85
    v_mfma_f32_16x16x32_bf16 v[216:219], v[24:27], a[40:43], v[216:219]
    v_mfma_f32_16x16x32_bf16 v[220:223], v[28:31], a[40:43], v[220:223]
    buffer_load_dwordx4 v[72:75], v3, s[16:19], s83 offen
    s_cmp_eq_u32 s95, 3
    v_mfma_f32_16x16x32_bf16 v[188:191], v[28:31], a[36:39], v[188:191]
    s_cbranch_scc1 L_ool3
L_ret3:
    v_mfma_f32_16x16x32_bf16 v[184:187], v[24:27], a[36:39], v[184:187]
    buffer_load_dwordx4 v[76:79], v3, s[20:23], s83 offen
    v_mfma_f32_16x16x32_bf16 v[152:155], v[24:27], a[32:35], v[152:155]
    v_mfma_f32_16x16x32_bf16 v[156:159], v[28:31], a[32:35], v[156:159]
    s_waitcnt lgkmcnt(0)
    v_mfma_f32_16x16x32_bf16 v[156:159], v[20:23], a[52:55], v[156:159]
    v_perm_b32 v24, v102, v98, s84
    v_perm_b32 v25, v110, v106, s84
    v_mfma_f32_16x16x32_bf16 v[152:155], v[16:19], a[52:55], v[152:155]
    v_perm_b32 v26, v118, v114, s84
    v_perm_b32 v27, v126, v122, s84
    v_mfma_f32_16x16x32_bf16 v[184:187], v[16:19], a[56:59], v[184:187]
    v_perm_b32 v28, v102, v98, s85
    v_perm_b32 v29, v110, v106, s85
    v_mfma_f32_16x16x32_bf16 v[188:191], v[20:23], a[56:59], v[188:191]
    v_perm_b32 v30, v118, v114, s85
    v_perm_b32 v31, v126, v122, s85
    v_mfma_f32_16x16x32_bf16 v[220:223], v[20:23], a[60:63], v[220:223]
    v_mfma_f32_16x16x32_bf16 v[216:219], v[16:19], a[60:63], v[216:219]
    buffer_load_dwordx4 v[80:83], v4, s[8:11], s83 offen
    ds_read_b128 a[32:35], v5 offset:30720
    v_mfma_f32_16x16x32_bf16 v[248:251], v[16:19], a[64:67], v[248:251]
    v_mfma_f32_16x16x32_bf16 v[252:255], v[20:23], a[64:67], v[252:255]
    buffer_load_dwordx4 v[84:87], v4, s[12:15], s83 offen
    ds_read_b128 a[36:39], v5 offset:32768
    v_mfma_f32_16x16x32_bf16 a[28:31], v[20:23], a[68:71], a[28:31]
    v_mfma_f32_16x16x32_bf16 a[24:27], v[16:19], a[68:71], a[24:27]
    v_mfma_f32_16x16x32_bf16 a[20:23], v[28:31], a[68:71], a[20:23]
L_pad1:
    s_cbranch_execz L_pad5
    v_perm_b32 v16, v101, v97, s84
    v_perm_b32 v17, v109, v105, s84
    v_mfma_f32_16x16x32_bf16 a[16:19], v[24:27], a[68:71], a[16:19]
    v_perm_b32 v18, v117, v113, s84
    v_perm_b32 v19, v125, v121, s84
    v_mfma_f32_16x16x32_bf16 v[240:243], v[24:27], a[64:67], v[240:243]
    v_perm_b32 v20, v101, v97, s85
    v_perm_b32 v21, v109, v105, s85
    v_mfma_f32_16x16x32_bf16 v[244:247], v[28:31], a[64:67], v[244:247]
    v_perm_b32 v22, v117, v113, s85
    v_perm_b32 v23, v125, v121, s85
    v_mfma_f32_16x16x32_bf16 v[212:215], v[28:31], a[60:63], v[212:215]
    v_mfma_f32_16x16x32_bf16 v[208:211], v[24:27], a[60:63], v[208:211]
    buffer_load_dwordx4 v[88:91], v4, s[16:19], s83 offen
    ds_read_b128 a[40:43], v5 offset:34816
    v_mfma_f32_16x16x32_bf16 v[176:179], v[24:27], a[56:59], v[176:179]
    v_mfma_f32_16x16x32_bf16 v[180:183], v[28:31], a[56:59], v[180:183]
    buffer_load_dwordx4 v[92:95], v4, s[20:23], s83 offen
    ds_read_b128 a[44:47], v5 offset:36864
    v_mfma_f32_16x16x32_bf16 v[148:151], v[28:31], a[52:55], v[148:151]
    s_add_u32 s83, s83, 0x80000
    s_sub_u32 s87, s83, 5242880
    s_cselect_b32 s83, s83, s87
    v_mfma_f32_16x16x32_bf16 v[144:147], v[24:27], a[52:55], v[144:147]
    s_add_u32 s94, s88, 10240
    s_add_u32 m0, s89, 62464
    s_nop 0
    buffer_load_dwordx4 v7, s[4:7], s94 offen offset:0  lds
    v_mfma_f32_16x16x32_bf16 v[140:143], v[20:23], a[52:55], v[140:143]
    v_perm_b32 v24, v100, v96, s84
    v_perm_b32 v25, v108, v104, s84
    v_mfma_f32_16x16x32_bf16 v[136:139], v[16:19], a[52:55], v[136:139]
    v_perm_b32 v26, v116, v112, s84
    v_perm_b32 v27, v124, v120, s84
    v_mfma_f32_16x16x32_bf16 v[168:171], v[16:19], a[56:59], v[168:171]
    v_perm_b32 v28, v100, v96, s85
    v_perm_b32 v29, v108, v104, s85
    v_mfma_f32_16x16x32_bf16 v[172:175], v[20:23], a[56:59], v[172:175]
    v_perm_b32 v30, v116, v112, s85
    v_perm_b32 v31, v124, v120, s85
    v_mfma_f32_16x16x32_bf16 v[204:207], v[20:23], a[60:63], v[204:207]
    v_mfma_f32_16x16x32_bf16 v[200:203], v[16:19], a[60:63], v[200:203]
    buffer_load_dwordx4 v[96:99], v1, s[8:11], s83 offen
    ds_read_b128 a[48:51], v5 offset:38912
    v_mfma_f32_16x16x32_bf16 v[232:235], v[16:19], a[64:67], v[232:235]
    v_mfma_f32_16x16x32_bf16 v[236:239], v[20:23], a[64:67], v[236:239]
    buffer_load_dwordx4 v[100:103], v1, s[12:15], s83 offen
    v_mfma_f32_16x16x32_bf16 a[12:15], v[20:23], a[68:71], a[12:15]
    v_mfma_f32_16x16x32_bf16 a[8:11], v[16:19], a[68:71], a[8:11]
    v_mfma_f32_16x16x32_bf16 a[4:7], v[28:31], a[68:71], a[4:7]
    s_waitcnt vmcnt(12)
    v_perm_b32 v16, v36, v32, s84
    v_perm_b32 v17, v44, v40, s84
    v_mfma_f32_16x16x32_bf16 a[0:3], v[24:27], a[68:71], a[0:3]
    v_perm_b32 v18, v52, v48, s84
    v_perm_b32 v19, v60, v56, s84
    v_mfma_f32_16x16x32_bf16 v[224:227], v[24:27], a[64:67], v[224:227]
    v_perm_b32 v20, v36, v32, s85
    v_perm_b32 v21, v44, v40, s85
    v_mfma_f32_16x16x32_bf16 v[228:231], v[28:31], a[64:67], v[228:231]
    v_perm_b32 v22, v52, v48, s85
    v_perm_b32 v23, v60, v56, s85
    v_mfma_f32_16x16x32_bf16 v[196:199], v[28:31], a[60:63], v[196:199]
    v_mfma_f32_16x16x32_bf16 v[192:195], v[24:27], a[60:63], v[192:195]
    buffer_load_dwordx4 v[104:107], v1, s[16:19], s83 offen
    s_cmp_eq_u32 s95, 4
    v_mfma_f32_16x16x32_bf16 v[160:163], v[24:27], a[56:59], v[160:163]
    s_cbranch_scc1 L_ool4
L_ret4:
    v_mfma_f32_16x16x32_bf16 v[164:167], v[28:31], a[56:59], v[164:167]
    buffer_load_dwordx4 v[108:111], v1, s[20:23], s83 offen
    v_mfma_f32_16x16x32_bf16 v[132:135], v[28:31], a[52:55], v[132:135]
    v_mfma_f32_16x16x32_bf16 v[128:131], v[24:27], a[52:55], v[128:131]
    s_waitcnt lgkmcnt(0)
    v_mfma_f32_16x16x32_bf16 v[128:131], v[16:19], a[32:35], v[128:131]
    v_perm_b32 v24, v37, v33, s84
    v_perm_b32 v25, v45, v41, s84
    v_mfma_f32_16x16x32_bf16 v[132:135], v[20:23], a[32:35], v[132:135]
    v_perm_b32 v26, v53, v49, s84
    v_perm_b32 v27, v61, v57, s84
    v_mfma_f32_16x16x32_bf16 v[164:167], v[20:23], a[36:39], v[164:167]
    v_perm_b32 v28, v37, v33, s85
    v_perm_b32 v29, v45, v41, s85
    v_mfma_f32_16x16x32_bf16 v[160:163], v[16:19], a[36:39], v[160:163]
    v_perm_b32 v30, v53, v49, s85
    v_perm_b32 v31, v61, v57, s85
    v_mfma_f32_16x16x32_bf16 v[192:195], v[16:19], a[40:43], v[192:195]
    v_mfma_f32_16x16x32_bf16 v[196:199], v[20:23], a[40:43], v[196:199]
    buffer_load_dwordx4 v[112:115], v2, s[8:11], s83 offen
    ds_read_b128 a[52:55], v6 offset:30720
    v_mfma_f32_16x16x32_bf16 v[228:231], v[20:23], a[44:47], v[228:231]
    v_mfma_f32_16x16x32_bf16 v[224:227], v[16:19], a[44:47], v[224:227]
    buffer_load_dwordx4 v[116:119], v2, s[12:15], s83 offen
    ds_read_b128 a[56:59], v6 offset:32768
    v_mfma_f32_16x16x32_bf16 a[0:3], v[16:19], a[48:51], a[0:3]
    v_mfma_f32_16x16x32_bf16 a[4:7], v[20:23], a[48:51], a[4:7]
    v_mfma_f32_16x16x32_bf16 a[8:11], v[24:27], a[48:51], a[8:11]
    v_perm_b32 v16, v38, v34, s84
    v_perm_b32 v17, v46, v42, s84
    v_mfma_f32_16x16x32_bf16 a[12:15], v[28:31], a[48:51], a[12:15]
    v_perm_b32 v18, v54, v50, s84
    v_perm_b32 v19, v62, v58, s84
    v_mfma_f32_16x16x32_bf16 v[236:239], v[28:31], a[44:47], v[236:239]
    v_perm_b32 v20, v38, v34, s85
    v_perm_b32 v21, v46, v42, s85
    v_mfma_f32_16x16x32_bf16 v[232:235], v[24:27], a[44:47], v[232:235]
    v_perm_b32 v22, v54, v50, s85
    v_perm_b32 v23, v62, v58, s85
    v_mfma_f32_16x16x32_bf16 v[200:203], v[24:27], a[40:43], v[200:203]
    v_mfma_f32_16x16x32_bf16 v[204:207], v[28:31], a[40:43], v[204:207]
    buffer_load_dwordx4 v[120:123], v2, s[16:19], s83 offen
    ds_read_b128 a[60:63], v6 offset:34816
    v_mfma_f32_16x16x32_bf16 v[172:175], v[28:31], a[36:39], v[172:175]
    v_mfma_f32_16x16x32_bf16 v[168:171], v[24:27], a[36:39], v[168:171]
    buffer_load_dwordx4 v[124:127], v2, s[20:23], s83 offen
    ds_read_b128 a[64:67], v6 offset:36864
    v_mfma_f32_16x16x32_bf16 v[136:139], v[24:27], a[32:35], v[136:139]
    s_add_u32 s94, s88, 20480
    v_mfma_f32_16x16x32_bf16 v[140:143], v[28:31], a[32:35], v[140:143]
    s_add_u32 m0, s89, 63488
    s_nop 0
    buffer_load_dwordx4 v7, s[4:7], s94 offen offset:0  lds
    v_mfma_f32_16x16x32_bf16 v[144:147], v[16:19], a[32:35], v[144:147]
    v_perm_b32 v24, v39, v35, s84
    v_perm_b32 v25, v47, v43, s84
    v_mfma_f32_16x16x32_bf16 v[148:151], v[20:23], a[32:35], v[148:151]
    v_perm_b32 v26, v55, v51, s84
    v_perm_b32 v27, v63, v59, s84
    v_mfma_f32_16x16x32_bf16 v[180:183], v[20:23], a[36:39], v[180:183]
    v_perm_b32 v28, v39, v35, s85
    v_perm_b32 v29, v47, v43, s85
    v_mfma_f32_16x16x32_bf16 v[176:179], v[16:19], a[36:39], v[176:179]
    v_perm_b32 v30, v55, v51, s85
    v_perm_b32 v31, v63, v59, s85
    v_mfma_f32_16x16x32_bf16 v[208:211], v[16:19], a[40:43], v[208:211]
    v_mfma_f32_16x16x32_bf16 v[212:215], v[20:23], a[40:43], v[212:215]
    buffer_load_dwordx4 v[32:35], v3, s[8:11], s83 offen
    ds_read_b128 a[68:71], v6 offset:38912
    v_mfma_f32_16x16x32_bf16 v[244:247], v[20:23], a[44:47], v[244:247]
    v_mfma_f32_16x16x32_bf16 v[240:243], v[16:19], a[44:47], v[240:243]
    buffer_load_dwordx4 v[36:39], v3, s[12:15], s83 offen
    v_mfma_f32_16x16x32_bf16 a[16:19], v[16:19], a[48:51], a[16:19]
    v_mfma_f32_16x16x32_bf16 a[20:23], v[20:23], a[48:51], a[20:23]
    v_mfma_f32_16x16x32_bf16 a[24:27], v[24:27], a[48:51], a[24:27]
    s_waitcnt vmcnt(12)
    v_perm_b32 v16, v71, v67, s84
    v_perm_b32 v17, v79, v75, s84
    v_mfma_f32_16x16x32_bf16 a[28:31], v[28:31], a[48:51], a[28:31]
    v_perm_b32 v18, v87, v83, s84
    v_perm_b32 v19, v95, v91, s84
    v_mfma_f32_16x16x32_bf16 v[252:255], v[28:31], a[44:47], v[252:255]
    v_perm_b32 v20, v71, v67, s85
    v_perm_b32 v21, v79, v75, s85
    v_mfma_f32_16x16x32_bf16 v[248:251], v[24:27], a[44:47], v[248:251]
    v_perm_b32 v22, v87, v83, s85
    v_perm_b32 v23, v95, v91, s85
    v_mfma_f32_16x16x32_bf16 v[216:219], v[24:27], a[40:43], v[216:219]
    v_mfma_f32_16x16x32_bf16 v[220:223], v[28:31], a[40:43], v[220:223]
    buffer_load_dwordx4 v[40:43], v3, s[16:19], s83 offen
    s_cmp_eq_u32 s95, 5
    v_mfma_f32_16x16x32_bf16 v[188:191], v[28:31], a[36:39], v[188:191]
    s_cbranch_scc1 L_ool5
L_ret5:
    v_mfma_f32_16x16x32_bf16 v[184:187], v[24:27], a[36:39], v[184:187]
    buffer_load_dwordx4 v[44:47], v3, s[20:23], s83 offen
    v_mfma_f32_16x16x32_bf16 v[152:155], v[24:27], a[32:35], v[152:155]
    v_mfma_f32_16x16x32_bf16 v[156:159], v[28:31], a[32:35], v[156:159]
    s_waitcnt lgkmcnt(0)
    v_mfma_f32_16x16x32_bf16 v[156:159], v[20:23], a[52:55], v[156:159]
    v_perm_b32 v24, v70, v66, s84
    v_perm_b32 v25, v78, v74, s84
    v_mfma_f32_16x16x32_bf16 v[152:155], v[16:19], a[52:55], v[152:155]
    v_perm_b32 v26, v86, v82, s84
    v_perm_b32 v27, v94, v90, s84
    v_mfma_f32_16x16x32_bf16 v[184:187], v[16:19], a[56:59], v[184:187]
    v_perm_b32 v28, v70, v66, s85
    v_perm_b32 v29, v78, v74, s85
    v_mfma_f32_16x16x32_bf16 v[188:191], v[20:23], a[56:59], v[188:191]
    v_perm_b32 v30, v86, v82, s85
    v_perm_b32 v31, v94, v90, s85
    v_mfma_f32_16x16x32_bf16 v[220:223], v[20:23], a[60:63], v[220:223]
    s_barrier
    v_mfma_f32_16x16x32_bf16 v[216:219], v[16:19], a[60:63], v[216:219]
    buffer_load_dwordx4 v[48:51], v4, s[8:11], s83 offen
    ds_read_b128 a[32:35], v5 offset:40960
    v_mfma_f32_16x16x32_bf16 v[248:251], v[16:19], a[64:67], v[248:251]
    v_mfma_f32_16x16x32_bf16 v[252:255], v[20:23], a[64:67], v[252:255]
    buffer_load_dwordx4 v[52:55], v4, s[12:15], s83 offen
    ds_read_b128 a[36:39], v5 offset:43008
    v_mfma_f32_16x16x32_bf16 a[28:31], v[20:23], a[68:71], a[28:31]
    v_mfma_f32_16x16x32_bf16 a[24:27], v[16:19], a[68:71], a[24:27]
    v_mfma_f32_16x16x32_bf16 a[20:23], v[28:31], a[68:71], a[20:23]
    v_perm_b32 v16, v69, v65, s84
    v_perm_b32 v17, v77, v73, s84
    v_mfma_f32_16x16x32_bf16 a[16:19], v[24:27], a[68:71], a[16:19]
    v_perm_b32 v18, v85, v81, s84
    v_perm_b32 v19, v93, v89, s84
    v_mfma_f32_16x16x32_bf16 v[240:243], v[24:27], a[64:67], v[240:243]
    v_perm_b32 v20, v69, v65, s85
    v_perm_b32 v21, v77, v73, s85
    v_mfma_f32_16x16x32_bf16 v[244:247], v[28:31], a[64:67], v[244:247]
    v_perm_b32 v22, v85, v81, s85
    v_perm_b32 v23, v93, v89, s85
    v_mfma_f32_16x16x32_bf16 v[212:215], v[28:31], a[60:63], v[212:215]
    v_mfma_f32_16x16x32_bf16 v[208:211], v[24:27], a[60:63], v[208:211]
    buffer_load_dwordx4 v[56:59], v4, s[16:19], s83 offen
    ds_read_b128 a[40:43], v5 offset:45056
    v_mfma_f32_16x16x32_bf16 v[176:179], v[24:27], a[56:59], v[176:179]
    v_mfma_f32_16x16x32_bf16 v[180:183], v[28:31], a[56:59], v[180:183]
    buffer_load_dwordx4 v[60:63], v4, s[20:23], s83 offen
    ds_read_b128 a[44:47], v5 offset:47104
    v_mfma_f32_16x16x32_bf16 v[148:151], v[28:31], a[52:55], v[148:151]
    s_add_u32 s83, s83, 0x80000
    s_sub_u32 s87, s83, 5242880
    s_cselect_b32 s83, s83, s87
    v_mfma_f32_16x16x32_bf16 v[144:147], v[24:27], a[52:55], v[144:147]
    s_add_u32 s94, s88, 30720
    s_add_u32 m0, s89, 64512
    s_nop 0
    buffer_load_dwordx4 v7, s[4:7], s94 offen offset:0  lds
    v_mfma_f32_16x16x32_bf16 v[140:143], v[20:23], a[52:55], v[140:143]
    v_perm_b32 v24, v68, v64, s84
    v_perm_b32 v25, v76, v72, s84
    v_mfma_f32_16x16x32_bf16 v[136:139], v[16:19], a[52:55], v[136:139]
    v_perm_b32 v26, v84, v80, s84
    v_perm_b32 v27, v92, v88, s84
    v_mfma_f32_16x16x32_bf16 v[168:171], v[16:19], a[56:59], v[168:171]
    v_perm_b32 v28, v68, v64, s85
    v_perm_b32 v29, v76, v72, s85
    v_mfma_f32_16x16x32_bf16 v[172:175], v[20:23], a[56:59], v[172:175]
    v_perm_b32 v30, v84, v80, s85
    v_perm_b32 v31, v92, v88, s85
    v_mfma_f32_16x16x32_bf16 v[204:207], v[20:23], a[60:63], v[204:207]
    v_mfma_f32_16x16x32_bf16 v[200:203], v[16:19], a[60:63], v[200:203]
    buffer_load_dwordx4 v[64:67], v1, s[8:11], s83 offen
    ds_read_b128 a[48:51], v5 offset:49152
    v_mfma_f32_16x16x32_bf16 v[232:235], v[16:19], a[64:67], v[232:235]
    v_mfma_f32_16x16x32_bf16 v[236:239], v[20:23], a[64:67], v[236:239]
    buffer_load_dwordx4 v[68:71], v1, s[12:15], s83 offen
    v_mfma_f32_16x16x32_bf16 a[12:15], v[20:23], a[68:71], a[12:15]
    v_mfma_f32_16x16x32_bf16 a[8:11], v[16:19], a[68:71], a[8:11]
    v_mfma_f32_16x16x32_bf16 a[4:7], v[28:31], a[68:71], a[4:7]
    s_waitcnt vmcnt(12)
    v_perm_b32 v16, v100, v96, s84
    v_perm_b32 v17, v108, v104, s84
    v_mfma_f32_16x16x32_bf16 a[0:3], v[24:27], a[68:71], a[0:3]
    v_perm_b32 v18, v116, v112, s84
    v_perm_b32 v19, v124, v120, s84
    v_mfma_f32_16x16x32_bf16 v[224:227], v[24:27], a[64:67], v[224:227]
    v_perm_b32 v20, v100, v96, s85
    v_perm_b32 v21, v108, v104, s85
    v_mfma_f32_16x16x32_bf16 v[228:231], v[28:31], a[64:67], v[228:231]
    v_perm_b32 v22, v116, v112, s85
    v_perm_b32 v23, v124, v120, s85
    v_mfma_f32_16x16x32_bf16 v[196:199], v[28:31], a[60:63], v[196:199]
    v_mfma_f32_16x16x32_bf16 v[192:195], v[24:27], a[60:63], v[192:195]
    buffer_load_dwordx4 v[72:75], v1, s[16:19], s83 offen
    s_cmp_eq_u32 s95, 6
    v_mfma_f32_16x16x32_bf16 v[160:163], v[24:27], a[56:59], v[160:163]
    s_cbranch_scc1 L_ool6
L_ret6:
    v_mfma_f32_16x16x32_bf16 v[164:167], v[28:31], a[56:59], v[164:167]
    buffer_load_dwordx4 v[76:79], v1, s[20:23], s83 offen
    v_mfma_f32_16x16x32_bf16 v[132:135], v[28:31], a[52:55], v[132:135]
    v_mfma_f32_16x16x32_bf16 v[128:131], v[24:27], a[52:55], v[128:131]
    s_waitcnt lgkmcnt(0)
    v_mfma_f32_16x16x32_bf16 v[128:131], v[16:19], a[32:35], v[128:131]
    v_perm_b32 v24, v101, v97, s84
    v_perm_b32 v25, v109, v105, s84
    v_mfma_f32_16x16x32_bf16 v[132:135], v[20:23], a[32:35], v[132:135]
    v_perm_b32 v26, v117, v113, s84
    v_perm_b32 v27, v125, v121, s84
    v_mfma_f32_16x16x32_bf16 v[164:167], v[20:23], a[36:39], v[164:167]
    v_perm_b32 v28, v101, v97, s85
    v_perm_b32 v29, v109, v105, s85
    v_mfma_f32_16x16x32_bf16 v[160:163], v[16:19], a[36:39], v[160:163]
    v_perm_b32 v30, v117, v113, s85
    v_perm_b32 v31, v125, v121, s85
    v_mfma_f32_16x16x32_bf16 v[192:195], v[16:19], a[40:43], v[192:195]
    v_mfma_f32_16x16x32_bf16 v[196:199], v[20:23], a[40:43], v[196:199]
    buffer_load_dwordx4 v[80:83], v2, s[8:11], s83 offen
    ds_read_b128 a[52:55], v6 offset:40960
    v_mfma_f32_16x16x32_bf16 v[228:231], v[20:23], a[44:47], v[228:231]
    v_mfma_f32_16x16x32_bf16 v[224:227], v[16:19], a[44:47], v[224:227]
    buffer_load_dwordx4 v[84:87], v2, s[12:15], s83 offen
    ds_read_b128 a[56:59], v6 offset:43008
    v_mfma_f32_16x16x32_bf16 a[0:3], v[16:19], a[48:51], a[0:3]
    v_mfma_f32_16x16x32_bf16 a[4:7], v[20:23], a[48:51], a[4:7]
    v_mfma_f32_16x16x32_bf16 a[8:11], v[24:27], a[48:51], a[8:11]
    v_perm_b32 v16, v102, v98, s84
    v_perm_b32 v17, v110, v106, s84
    v_mfma_f32_16x16x32_bf16 a[12:15], v[28:31], a[48:51], a[12:15]
    v_perm_b32 v18, v118, v114, s84
    v_perm_b32 v19, v126, v122, s84
    v_mfma_f32_16x16x32_bf16 v[236:239], v[28:31], a[44:47], v[236:239]
    v_perm_b32 v20, v102, v98, s85
    v_perm_b32 v21, v110, v106, s85
    v_mfma_f32_16x16x32_bf16 v[232:235], v[24:27], a[44:47], v[232:235]
    v_perm_b32 v22, v118, v114, s85
    v_perm_b32 v23, v126, v122, s85
    v_mfma_f32_16x16x32_bf16 v[200:203], v[24:27], a[40:43], v[200:203]
    v_mfma_f32_16x16x32_bf16 v[204:207], v[28:31], a[40:43], v[204:207]
    buffer_load_dwordx4 v[88:91], v2, s[16:19], s83 offen
    ds_read_b128 a[60:63], v6 offset:45056
    v_mfma_f32_16x16x32_bf16 v[172:175], v[28:31], a[36:39], v[172:175]
    v_mfma_f32_16x16x32_bf16 v[168:171], v[24:27], a[36:39], v[168:171]
    buffer_load_dwordx4 v[92:95], v2, s[20:23], s83 offen
    ds_read_b128 a[64:67], v6 offset:47104
    v_mfma_f32_16x16x32_bf16 v[136:139], v[24:27], a[32:35], v[136:139]
    s_add_u32 s94, s88, 40960
    v_mfma_f32_16x16x32_bf16 v[140:143], v[28:31], a[32:35], v[140:143]
    s_add_u32 m0, s89, 65536
    s_nop 0
    buffer_load_dwordx4 v7, s[4:7], s94 offen offset:0  lds
    v_mfma_f32_16x16x32_bf16 v[144:147], v[16:19], a[32:35], v[144:147]
    s_add_u32 s88, s88, 256
    v_perm_b32 v24, v103, v99, s84
    v_perm_b32 v25, v111, v107, s84
    v_mfma_f32_16x16x32_bf16 v[148:151], v[20:23], a[32:35], v[148:151]
    v_perm_b32 v26, v119, v115, s84
    v_perm_b32 v27, v127, v123, s84
    v_mfma_f32_16x16x32_bf16 v[180:183], v[20:23], a[36:39], v[180:183]
    v_perm_b32 v28, v103, v99, s85
    v_perm_b32 v29, v111, v107, s85
    v_mfma_f32_16x16x32_bf16 v[176:179], v[16:19], a[36:39], v[176:179]
    v_perm_b32 v30, v119, v115, s85
    v_perm_b32 v31, v127, v123, s85
    v_mfma_f32_16x16x32_bf16 v[208:211], v[16:19], a[40:43], v[208:211]
    s_sub_u32 s94, s88, 1280
    s_cselect_b32 s88, s88, s94
    v_mfma_f32_16x16x32_bf16 v[212:215], v[20:23], a[40:43], v[212:215]
    buffer_load_dwordx4 v[96:99], v3, s[8:11], s83 offen
    ds_read_b128 a[68:71], v6 offset:49152
    v_mfma_f32_16x16x32_bf16 v[244:247], v[20:23], a[44:47], v[244:247]
    v_mfma_f32_16x16x32_bf16 v[240:243], v[16:19], a[44:47], v[240:243]
    buffer_load_dwordx4 v[100:103], v3, s[12:15], s83 offen
    v_mfma_f32_16x16x32_bf16 a[16:19], v[16:19], a[48:51], a[16:19]
    v_mfma_f32_16x16x32_bf16 a[20:23], v[20:23], a[48:51], a[20:23]
    v_mfma_f32_16x16x32_bf16 a[24:27], v[24:27], a[48:51], a[24:27]
    s_waitcnt vmcnt(12)
    v_perm_b32 v16, v39, v35, s84
    v_perm_b32 v17, v47, v43, s84
    v_mfma_f32_16x16x32_bf16 a[28:31], v[28:31], a[48:51], a[28:31]
    v_perm_b32 v18, v55, v51, s84
    v_perm_b32 v19, v63, v59, s84
    v_mfma_f32_16x16x32_bf16 v[252:255], v[28:31], a[44:47], v[252:255]
    v_perm_b32 v20, v39, v35, s85
    v_perm_b32 v21, v47, v43, s85
    v_mfma_f32_16x16x32_bf16 v[248:251], v[24:27], a[44:47], v[248:251]
    v_perm_b32 v22, v55, v51, s85
    v_perm_b32 v23, v63, v59, s85
    v_mfma_f32_16x16x32_bf16 v[216:219], v[24:27], a[40:43], v[216:219]
    s_waitcnt vmcnt(8)
    ds_read_b128 a[72:75], v10 offset:0
    v_mfma_f32_16x16x32_bf16 v[220:223], v[28:31], a[40:43], v[220:223]
    buffer_load_dwordx4 v[104:107], v3, s[16:19], s83 offen
    ds_read_b128 a[88:91], v10 offset:4224
    v_mfma_f32_16x16x32_bf16 v[188:191], v[28:31], a[36:39], v[188:191]
    ds_read_b128 a[104:107], v10 offset:8448
    v_xor_b32 v12, 16, v10
    v_mfma_f32_16x16x32_bf16 v[184:187], v[24:27], a[36:39], v[184:187]
    buffer_load_dwordx4 v[108:111], v3, s[20:23], s83 offen
    ds_read_b128 a[76:79], v12 offset:0
    v_mfma_f32_16x16x32_bf16 v[152:155], v[24:27], a[32:35], v[152:155]
    ds_read_b128 a[92:95], v12 offset:4224
    v_mfma_f32_16x16x32_bf16 v[156:159], v[28:31], a[32:35], v[156:159]
    s_waitcnt lgkmcnt(5)
    ds_read_b128 a[108:111], v12 offset:8448
    v_xor_b32 v12, 32, v10
    v_mfma_f32_16x16x32_bf16 v[156:159], v[20:23], a[52:55], v[156:159]
    v_perm_b32 v24, v38, v34, s84
    v_perm_b32 v25, v46, v42, s84
    v_mfma_f32_16x16x32_bf16 v[152:155], v[16:19], a[52:55], v[152:155]
    v_perm_b32 v26, v54, v50, s84
    v_perm_b32 v27, v62, v58, s84
    v_mfma_f32_16x16x32_bf16 v[184:187], v[16:19], a[56:59], v[184:187]
    v_perm_b32 v28, v38, v34, s85
    v_perm_b32 v29, v46, v42, s85
    v_mfma_f32_16x16x32_bf16 v[188:191], v[20:23], a[56:59], v[188:191]
    v_perm_b32 v30, v54, v50, s85
    v_perm_b32 v31, v62, v58, s85
    v_mfma_f32_16x16x32_bf16 v[220:223], v[20:23], a[60:63], v[220:223]
    ds_read_b128 a[80:83], v12 offset:0
    v_add_u32 v5, 51200, v5
    v_mfma_f32_16x16x32_bf16 v[216:219], v[16:19], a[60:63], v[216:219]
    buffer_load_dwordx4 v[112:115], v4, s[8:11], s83 offen
    ds_read_b128 a[32:35], v5 offset:0
    v_mfma_f32_16x16x32_bf16 v[248:251], v[16:19], a[64:67], v[248:251]
    ds_read_b128 a[96:99], v12 offset:4224
    v_mfma_f32_16x16x32_bf16 v[252:255], v[20:23], a[64:67], v[252:255]
    buffer_load_dwordx4 v[116:119], v4, s[12:15], s83 offen
    ds_read_b128 a[36:39], v5 offset:2048
    v_mfma_f32_16x16x32_bf16 a[28:31], v[20:23], a[68:71], a[28:31]
    ds_read_b128 a[112:115], v12 offset:8448
    v_xor_b32_e64 v12, 48, v10
    v_mfma_f32_16x16x32_bf16 a[24:27], v[16:19], a[68:71], a[24:27]
    ds_read_b128 a[84:87], v12 offset:0
    v_mfma_f32_16x16x32_bf16 a[20:23], v[28:31], a[68:71], a[20:23]
    v_perm_b32 v16, v37, v33, s84
    v_perm_b32 v17, v45, v41, s84
    v_mfma_f32_16x16x32_bf16 a[16:19], v[24:27], a[68:71], a[16:19]
    v_perm_b32 v18, v53, v49, s84
    v_perm_b32 v19, v61, v57, s84
    v_mfma_f32_16x16x32_bf16 v[240:243], v[24:27], a[64:67], v[240:243]
    v_perm_b32 v20, v37, v33, s85
    v_perm_b32 v21, v45, v41, s85
    v_mfma_f32_16x16x32_bf16 v[244:247], v[28:31], a[64:67], v[244:247]
    v_perm_b32 v22, v53, v49, s85
    v_perm_b32 v23, v61, v57, s85
    v_mfma_f32_16x16x32_bf16 v[212:215], v[28:31], a[60:63], v[212:215]
    ds_read_b128 a[100:103], v12 offset:4224
    v_mfma_f32_16x16x32_bf16 v[208:211], v[24:27], a[60:63], v[208:211]
    buffer_load_dwordx4 v[120:123], v4, s[16:19], s83 offen
    ds_read_b128 a[40:43], v5 offset:4096
    v_mfma_f32_16x16x32_bf16 v[176:179], v[24:27], a[56:59], v[176:179]
    ds_read_b128 a[116:119], v12 offset:8448
    v_mfma_f32_16x16x32_bf16 v[180:183], v[28:31], a[56:59], v[180:183]
    buffer_load_dwordx4 v[124:127], v4, s[20:23], s83 offen
    ds_read_b128 a[44:47], v5 offset:6144
    v_mfma_f32_16x16x32_bf16 v[148:151], v[28:31], a[52:55], v[148:151]
    s_add_u32 s83, s83, 0x80000
    s_sub_u32 s87, s83, 5242880
    s_cselect_b32 s83, s83, s87
    v_mfma_f32_16x16x32_bf16 v[144:147], v[24:27], a[52:55], v[144:147]
    s_add_u32 s94, s88, 0
    s_add_u32 m0, s89, 81920
    s_nop 0
    buffer_load_dwordx4 v7, s[4:7], s94 offen offset:0  lds
    v_mfma_f32_16x16x32_bf16 v[140:143], v[20:23], a[52:55], v[140:143]
    v_perm_b32 v24, v36, v32, s84
    v_perm_b32 v25, v44, v40, s84
    v_mfma_f32_16x16x32_bf16 v[136:139], v[16:19], a[52:55], v[136:139]
    v_perm_b32 v26, v52, v48, s84
    v_perm_b32 v27, v60, v56, s84
    v_mfma_f32_16x16x32_bf16 v[168:171], v[16:19], a[56:59], v[168:171]
    v_perm_b32 v28, v36, v32, s85
    v_perm_b32 v29, v44, v40, s85
    v_mfma_f32_16x16x32_bf16 v[172:175], v[20:23], a[56:59], v[172:175]
    v_perm_b32 v30, v52, v48, s85
    v_perm_b32 v31, v60, v56, s85
    v_mfma_f32_16x16x32_bf16 v[204:207], v[20:23], a[60:63], v[204:207]
    v_mfma_f32_16x16x32_bf16 v[200:203], v[16:19], a[60:63], v[200:203]
    buffer_load_dwordx4 v[32:35], v1, s[8:11], s83 offen
    ds_read_b128 a[48:51], v5 offset:8192
    v_mfma_f32_16x16x32_bf16 v[232:235], v[16:19], a[64:67], v[232:235]
    v_mfma_f32_16x16x32_bf16 v[236:239], v[20:23], a[64:67], v[236:239]
    buffer_load_dwordx4 v[36:39], v1, s[12:15], s83 offen
    v_mfma_f32_16x16x32_bf16 a[12:15], v[20:23], a[68:71], a[12:15]
    v_mfma_f32_16x16x32_bf16 a[8:11], v[16:19], a[68:71], a[8:11]
    v_mfma_f32_16x16x32_bf16 a[4:7], v[28:31], a[68:71], a[4:7]
    s_waitcnt vmcnt(12)
    v_perm_b32 v16, v68, v64, s84
    v_perm_b32 v17, v76, v72, s84
    v_mfma_f32_16x16x32_bf16 a[0:3], v[24:27], a[68:71], a[0:3]
    s_waitcnt lgkmcnt(2)
    v_perm_b32 v18, v84, v80, s84
    v_perm_b32 v19, v92, v88, s84
    v_mfma_f32_16x16x32_bf16 v[224:227], v[24:27], a[64:67], v[224:227]
    v_perm_b32 v20, v68, v64, s85
    v_perm_b32 v21, v76, v72, s85
    v_mfma_f32_16x16x32_bf16 v[228:231], v[28:31], a[64:67], v[228:231]
    v_perm_b32 v22, v84, v80, s85
    v_perm_b32 v23, v92, v88, s85
    v_mfma_f32_16x16x32_bf16 v[196:199], v[28:31], a[60:63], v[196:199]
    v_mfma_f32_16x16x32_bf16 v[192:195], v[24:27], a[60:63], v[192:195]
    buffer_load_dwordx4 v[40:43], v1, s[16:19], s83 offen
    s_cmp_eq_u32 s82, 0
    v_mfma_f32_16x16x32_bf16 v[160:163], v[24:27], a[56:59], v[160:163]
    s_cbranch_scc1 L_ool7
L_ret7:
    v_mfma_f32_16x16x32_bf16 v[164:167], v[28:31], a[56:59], v[164:167]
    buffer_load_dwordx4 v[44:47], v1, s[20:23], s83 offen
    v_mfma_f32_16x16x32_bf16 v[132:135], v[28:31], a[52:55], v[132:135]
    v_mfma_f32_16x16x32_bf16 v[128:131], v[24:27], a[52:55], v[128:131]
    s_waitcnt lgkmcnt(0)
    v_mfma_f32_16x16x32_bf16 v[128:131], v[16:19], a[32:35], v[128:131]
    v_perm_b32 v24, v69, v65, s84
    v_perm_b32 v25, v77, v73, s84
    v_mfma_f32_16x16x32_bf16 v[132:135], v[20:23], a[32:35], v[132:135]
    v_perm_b32 v26, v85, v81, s84
    v_perm_b32 v27, v93, v89, s84
    v_mfma_f32_16x16x32_bf16 v[164:167], v[20:23], a[36:39], v[164:167]
    v_perm_b32 v28, v69, v65, s85
    v_perm_b32 v29, v77, v73, s85
    v_mfma_f32_16x16x32_bf16 v[160:163], v[16:19], a[36:39], v[160:163]
    v_perm_b32 v30, v85, v81, s85
    v_perm_b32 v31, v93, v89, s85
    v_mfma_f32_16x16x32_bf16 v[192:195], v[16:19], a[40:43], v[192:195]
    v_add_u32 v6, 51200, v6
    v_mfma_f32_16x16x32_bf16 v[196:199], v[20:23], a[40:43], v[196:199]
    buffer_load_dwordx4 v[48:51], v2, s[8:11], s83 offen
    ds_read_b128 a[52:55], v6 offset:0
    v_mfma_f32_16x16x32_bf16 v[228:231], v[20:23], a[44:47], v[228:231]
    v_mfma_f32_16x16x32_bf16 v[224:227], v[16:19], a[44:47], v[224:227]
    buffer_load_dwordx4 v[52:55], v2, s[12:15], s83 offen
    ds_read_b128 a[56:59], v6 offset:2048
    v_mfma_f32_16x16x32_bf16 a[0:3], v[16:19], a[48:51], a[0:3]
    v_mfma_f32_16x16x32_bf16 a[4:7], v[20:23], a[48:51], a[4:7]
    v_mfma_f32_16x16x32_bf16 a[8:11], v[24:27], a[48:51], a[8:11]
    v_perm_b32 v16, v70, v66, s84
    v_perm_b32 v17, v78, v74, s84
    v_mfma_f32_16x16x32_bf16 a[12:15], v[28:31], a[48:51], a[12:15]
    v_perm_b32 v18, v86, v82, s84
    v_perm_b32 v19, v94, v90, s84
    v_mfma_f32_16x16x32_bf16 v[236:239], v[28:31], a[44:47], v[236:239]
    v_perm_b32 v20, v70, v66, s85
    v_perm_b32 v21, v78, v74, s85
    v_mfma_f32_16x16x32_bf16 v[232:235], v[24:27], a[44:47], v[232:235]
    v_perm_b32 v22, v86, v82, s85
    v_perm_b32 v23, v94, v90, s85
    v_mfma_f32_16x16x32_bf16 v[200:203], v[24:27], a[40:43], v[200:203]
    v_mfma_f32_16x16x32_bf16 v[204:207], v[28:31], a[40:43], v[204:207]
    buffer_load_dwordx4 v[56:59], v2, s[16:19], s83 offen
    ds_read_b128 a[60:63], v6 offset:4096
    v_mfma_f32_16x16x32_bf16 v[172:175], v[28:31], a[36:39], v[172:175]
    v_mfma_f32_16x16x32_bf16 v[168:171], v[24:27], a[36:39], v[168:171]
    buffer_load_dwordx4 v[60:63], v2, s[20:23], s83 offen
    ds_read_b128 a[64:67], v6 offset:6144
    v_mfma_f32_16x16x32_bf16 v[136:139], v[24:27], a[32:35], v[136:139]
    s_add_u32 s94, s88, 10240
    v_mfma_f32_16x16x32_bf16 v[140:143], v[28:31], a[32:35], v[140:143]
    s_add_u32 m0, s89, 82944
    s_nop 0
    buffer_load_dwordx4 v7, s[4:7], s94 offen offset:0  lds
    v_mfma_f32_16x16x32_bf16 v[144:147], v[16:19], a[32:35], v[144:147]
    v_perm_b32 v24, v71, v67, s84
    v_perm_b32 v25, v79, v75, s84
    v_mfma_f32_16x16x32_bf16 v[148:151], v[20:23], a[32:35], v[148:151]
    v_perm_b32 v26, v87, v83, s84
    v_perm_b32 v27, v95, v91, s84
    v_mfma_f32_16x16x32_bf16 v[180:183], v[20:23], a[36:39], v[180:183]
    v_perm_b32 v28, v71, v67, s85
    v_perm_b32 v29, v79, v75, s85
L_pad2:
    s_cbranch_execz L_pad6
    v_mfma_f32_16x16x32_bf16 v[176:179], v[16:19], a[36:39], v[176:179]
    v_perm_b32 v30, v87, v83, s85
    v_perm_b32 v31, v95, v91, s85
    v_mfma_f32_16x16x32_bf16 v[208:211], v[16:19], a[40:43], v[208:211]
    v_mfma_f32_16x16x32_bf16 v[212:215], v[20:23], a[40:43], v[212:215]
    buffer_load_dwordx4 v[64:67], v3, s[8:11], s83 offen
    ds_read_b128 a[68:71], v6 offset:8192
    v_mfma_f32_16x16x32_bf16 v[244:247], v[20:23], a[44:47], v[244:247]
    v_mfma_f32_16x16x32_bf16 v[240:243], v[16:19], a[44:47], v[240:243]
    buffer_load_dwordx4 v[68:71], v3, s[12:15], s83 offen
    v_mfma_f32_16x16x32_bf16 a[16:19], v[16:19], a[48:51], a[16:19]
    v_mfma_f32_16x16x32_bf16 a[20:23], v[20:23], a[48:51], a[20:23]
    v_mfma_f32_16x16x32_bf16 a[24:27], v[24:27], a[48:51], a[24:27]
    s_waitcnt vmcnt(12)
    v_perm_b32 v16, v103, v99, s84
    v_perm_b32 v17, v111, v107, s84
    v_mfma_f32_16x16x32_bf16 a[28:31], v[28:31], a[48:51], a[28:31]
    v_perm_b32 v18, v119, v115, s84
    v_perm_b32 v19, v127, v123, s84
    v_mfma_f32_16x16x32_bf16 v[252:255], v[28:31], a[44:47], v[252:255]
    v_perm_b32 v20, v103, v99, s85
    v_perm_b32 v21, v111, v107, s85
    v_mfma_f32_16x16x32_bf16 v[248:251], v[24:27], a[44:47], v[248:251]
    v_perm_b32 v22, v119, v115, s85
    v_perm_b32 v23, v127, v123, s85
    v_mfma_f32_16x16x32_bf16 v[216:219], v[24:27], a[40:43], v[216:219]
    v_mfma_f32_16x16x32_bf16 v[220:223], v[28:31], a[40:43], v[220:223]
    buffer_load_dwordx4 v[72:75], v3, s[16:19], s83 offen
    s_cmp_eq_u32 s82, 1
    v_mfma_f32_16x16x32_bf16 v[188:191], v[28:31], a[36:39], v[188:191]
    s_cbranch_scc1 L_ool8
L_ret8:
    v_mfma_f32_16x16x32_bf16 v[184:187], v[24:27], a[36:39], v[184:187]
    buffer_load_dwordx4 v[76:79], v3, s[20:23], s83 offen
    v_mfma_f32_16x16x32_bf16 v[152:155], v[24:27], a[32:35], v[152:155]
    v_mfma_f32_16x16x32_bf16 v[156:159], v[28:31], a[32:35], v[156:159]
    s_waitcnt lgkmcnt(0)
    v_mfma_f32_16x16x32_bf16 v[156:159], v[20:23], a[52:55], v[156:159]
    v_perm_b32 v24, v102, v98, s84
    v_perm_b32 v25, v110, v106, s84
    v_mfma_f32_16x16x32_bf16 v[152:155], v[16:19], a[52:55], v[152:155]
    v_perm_b32 v26, v118, v114, s84
    v_perm_b32 v27, v126, v122, s84
    v_mfma_f32_16x16x32_bf16 v[184:187], v[16:19], a[56:59], v[184:187]
    v_perm_b32 v28, v102, v98, s85
    v_perm_b32 v29, v110, v106, s85
    v_mfma_f32_16x16x32_bf16 v[188:191], v[20:23], a[56:59], v[188:191]
    v_perm_b32 v30, v118, v114, s85
    v_perm_b32 v31, v126, v122, s85
    v_mfma_f32_16x16x32_bf16 v[220:223], v[20:23], a[60:63], v[220:223]
    s_barrier
    v_mfma_f32_16x16x32_bf16 v[216:219], v[16:19], a[60:63], v[216:219]
    buffer_load_dwordx4 v[80:83], v4, s[8:11], s83 offen
    ds_read_b128 a[32:35], v5 offset:10240
    v_mfma_f32_16x16x32_bf16 v[248:251], v[16:19], a[64:67], v[248:251]
    v_mfma_f32_16x16x32_bf16 v[252:255], v[20:23], a[64:67], v[252:255]
    buffer_load_dwordx4 v[84:87], v4, s[12:15], s83 offen
    ds_read_b128 a[36:39], v5 offset:12288
    v_mfma_f32_16x16x32_bf16 a[28:31], v[20:23], a[68:71], a[28:31]
    v_mfma_f32_16x16x32_bf16 a[24:27], v[16:19], a[68:71], a[24:27]
    v_mfma_f32_16x16x32_bf16 a[20:23], v[28:31], a[68:71], a[20:23]
    v_perm_b32 v16, v101, v97, s84
    v_perm_b32 v17, v109, v105, s84
    v_mfma_f32_16x16x32_bf16 a[16:19], v[24:27], a[68:71], a[16:19]
    v_perm_b32 v18, v117, v113, s84
    v_perm_b32 v19, v125, v121, s84
    v_mfma_f32_16x16x32_bf16 v[240:243], v[24:27], a[64:67], v[240:243]
    v_perm_b32 v20, v101, v97, s85
    v_perm_b32 v21, v109, v105, s85
    v_mfma_f32_16x16x32_bf16 v[244:247], v[28:31], a[64:67], v[244:247]
    v_perm_b32 v22, v117, v113, s85
    v_perm_b32 v23, v125, v121, s85
    v_mfma_f32_16x16x32_bf16 v[212:215], v[28:31], a[60:63], v[212:215]
    v_mfma_f32_16x16x32_bf16 v[208:211], v[24:27], a[60:63], v[208:211]
    buffer_load_dwordx4 v[88:91], v4, s[16:19], s83 offen
    ds_read_b128 a[40:43], v5 offset:14336
    v_mfma_f32_16x16x32_bf16 v[176:179], v[24:27], a[56:59], v[176:179]
    v_mfma_f32_16x16x32_bf16 v[180:183], v[28:31], a[56:59], v[180:183]
    buffer_load_dwordx4 v[92:95], v4, s[20:23], s83 offen
    ds_read_b128 a[44:47], v5 offset:16384
    v_mfma_f32_16x16x32_bf16 v[148:151], v[28:31], a[52:55], v[148:151]
    s_add_u32 s83, s83, 0x80000
    s_sub_u32 s87, s83, 5242880
    s_cselect_b32 s83, s83, s87
    v_mfma_f32_16x16x32_bf16 v[144:147], v[24:27], a[52:55], v[144:147]
    s_add_u32 s94, s88, 20480
    s_add_u32 m0, s89, 83968
    s_nop 0
    buffer_load_dwordx4 v7, s[4:7], s94 offen offset:0  lds
    v_mfma_f32_16x16x32_bf16 v[140:143], v[20:23], a[52:55], v[140:143]
    v_perm_b32 v24, v100, v96, s84
    v_perm_b32 v25, v108, v104, s84
    v_mfma_f32_16x16x32_bf16 v[136:139], v[16:19], a[52:55], v[136:139]
    v_perm_b32 v26, v116, v112, s84
    v_perm_b32 v27, v124, v120, s84
    v_mfma_f32_16x16x32_bf16 v[168:171], v[16:19], a[56:59], v[168:171]
    v_perm_b32 v28, v100, v96, s85
    v_perm_b32 v29, v108, v104, s85
    v_mfma_f32_16x16x32_bf16 v[172:175], v[20:23], a[56:59], v[172:175]
    v_perm_b32 v30, v116, v112, s85
    v_perm_b32 v31, v124, v120, s85
    v_mfma_f32_16x16x32_bf16 v[204:207], v[20:23], a[60:63], v[204:207]
    v_mfma_f32_16x16x32_bf16 v[200:203], v[16:19], a[60:63], v[200:203]
    buffer_load_dwordx4 v[96:99], v1, s[8:11], s83 offen
    ds_read_b128 a[48:51], v5 offset:18432
    v_mfma_f32_16x16x32_bf16 v[232:235], v[16:19], a[64:67], v[232:235]
    v_mfma_f32_16x16x32_bf16 v[236:239], v[20:23], a[64:67], v[236:239]
    buffer_load_dwordx4 v[100:103], v1, s[12:15], s83 offen
    v_mfma_f32_16x16x32_bf16 a[12:15], v[20:23], a[68:71], a[12:15]
    v_mfma_f32_16x16x32_bf16 a[8:11], v[16:19], a[68:71], a[8:11]
    v_mfma_f32_16x16x32_bf16 a[4:7], v[28:31], a[68:71], a[4:7]
    s_waitcnt vmcnt(12)
    v_perm_b32 v16, v36, v32, s84
    v_perm_b32 v17, v44, v40, s84
    v_mfma_f32_16x16x32_bf16 a[0:3], v[24:27], a[68:71], a[0:3]
    v_perm_b32 v18, v52, v48, s84
    v_perm_b32 v19, v60, v56, s84
    v_mfma_f32_16x16x32_bf16 v[224:227], v[24:27], a[64:67], v[224:227]
    v_perm_b32 v20, v36, v32, s85
    v_perm_b32 v21, v44, v40, s85
    v_mfma_f32_16x16x32_bf16 v[228:231], v[28:31], a[64:67], v[228:231]
    v_perm_b32 v22, v52, v48, s85
    v_perm_b32 v23, v60, v56, s85
    v_mfma_f32_16x16x32_bf16 v[196:199], v[28:31], a[60:63], v[196:199]
    v_mfma_f32_16x16x32_bf16 v[192:195], v[24:27], a[60:63], v[192:195]
    buffer_load_dwordx4 v[104:107], v1, s[16:19], s83 offen
    s_cmp_eq_u32 s82, 2
    v_mfma_f32_16x16x32_bf16 v[160:163], v[24:27], a[56:59], v[160:163]
    s_cbranch_scc1 L_ool9
L_ret9:
    v_mfma_f32_16x16x32_bf16 v[164:167], v[28:31], a[56:59], v[164:167]
    buffer_load_dwordx4 v[108:111], v1, s[20:23], s83 offen
    v_mfma_f32_16x16x32_bf16 v[132:135], v[28:31], a[52:55], v[132:135]
    v_mfma_f32_16x16x32_bf16 v[128:131], v[24:27], a[52:55], v[128:131]
    s_waitcnt lgkmcnt(0)
    v_mfma_f32_16x16x32_bf16 v[128:131], v[16:19], a[32:35], v[128:131]
    v_perm_b32 v24, v37, v33, s84
    v_perm_b32 v25, v45, v41, s84
    v_mfma_f32_16x16x32_bf16 v[132:135], v[20:23], a[32:35], v[132:135]
    v_perm_b32 v26, v53, v49, s84
    v_perm_b32 v27, v61, v57, s84
    v_mfma_f32_16x16x32_bf16 v[164:167], v[20:23], a[36:39], v[164:167]
    v_perm_b32 v28, v37, v33, s85
    v_perm_b32 v29, v45, v41, s85
    v_mfma_f32_16x16x32_bf16 v[160:163], v[16:19], a[36:39], v[160:163]
    v_perm_b32 v30, v53, v49, s85
    v_perm_b32 v31, v61, v57, s85
    v_mfma_f32_16x16x32_bf16 v[192:195], v[16:19], a[40:43], v[192:195]
    v_mfma_f32_16x16x32_bf16 v[196:199], v[20:23], a[40:43], v[196:199]
    buffer_load_dwordx4 v[112:115], v2, s[8:11], s83 offen
    ds_read_b128 a[52:55], v6 offset:10240
    v_mfma_f32_16x16x32_bf16 v[228:231], v[20:23], a[44:47], v[228:231]
    v_mfma_f32_16x16x32_bf16 v[224:227], v[16:19], a[44:47], v[224:227]
    buffer_load_dwordx4 v[116:119], v2, s[12:15], s83 offen
    ds_read_b128 a[56:59], v6 offset:12288
    v_mfma_f32_16x16x32_bf16 a[0:3], v[16:19], a[48:51], a[0:3]
    v_mfma_f32_16x16x32_bf16 a[4:7], v[20:23], a[48:51], a[4:7]
    v_mfma_f32_16x16x32_bf16 a[8:11], v[24:27], a[48:51], a[8:11]
    v_perm_b32 v16, v38, v34, s84
    v_perm_b32 v17, v46, v42, s84
    v_mfma_f32_16x16x32_bf16 a[12:15], v[28:31], a[48:51], a[12:15]
    v_perm_b32 v18, v54, v50, s84
    v_perm_b32 v19, v62, v58, s84
    v_mfma_f32_16x16x32_bf16 v[236:239], v[28:31], a[44:47], v[236:239]
    v_perm_b32 v20, v38, v34, s85
    v_perm_b32 v21, v46, v42, s85
    v_mfma_f32_16x16x32_bf16 v[232:235], v[24:27], a[44:47], v[232:235]
    v_perm_b32 v22, v54, v50, s85
    v_perm_b32 v23, v62, v58, s85
    v_mfma_f32_16x16x32_bf16 v[200:203], v[24:27], a[40:43], v[200:203]
    v_mfma_f32_16x16x32_bf16 v[204:207], v[28:31], a[40:43], v[204:207]
    buffer_load_dwordx4 v[120:123], v2, s[16:19], s83 offen
    ds_read_b128 a[60:63], v6 offset:14336
    v_mfma_f32_16x16x32_bf16 v[172:175], v[28:31], a[36:39], v[172:175]
    v_mfma_f32_16x16x32_bf16 v[168:171], v[24:27], a[36:39], v[168:171]
    buffer_load_dwordx4 v[124:127], v2, s[20:23], s83 offen
    ds_read_b128 a[64:67], v6 offset:16384
    v_mfma_f32_16x16x32_bf16 v[136:139], v[24:27], a[32:35], v[136:139]
    s_add_u32 s94, s88, 30720
    v_mfma_f32_16x16x32_bf16 v[140:143], v[28:31], a[32:35], v[140:143]
    s_add_u32 m0, s89, 84992
    s_nop 0
    buffer_load_dwordx4 v7, s[4:7], s94 offen offset:0  lds
    v_mfma_f32_16x16x32_bf16 v[144:147], v[16:19], a[32:35], v[144:147]
    v_perm_b32 v24, v39, v35, s84
    v_perm_b32 v25, v47, v43, s84
    v_mfma_f32_16x16x32_bf16 v[148:151], v[20:23], a[32:35], v[148:151]
    v_perm_b32 v26, v55, v51, s84
    v_perm_b32 v27, v63, v59, s84
    v_mfma_f32_16x16x32_bf16 v[180:183], v[20:23], a[36:39], v[180:183]
    v_perm_b32 v28, v39, v35, s85
    v_perm_b32 v29, v47, v43, s85
    v_mfma_f32_16x16x32_bf16 v[176:179], v[16:19], a[36:39], v[176:179]
    v_perm_b32 v30, v55, v51, s85
    v_perm_b32 v31, v63, v59, s85
    v_mfma_f32_16x16x32_bf16 v[208:211], v[16:19], a[40:43], v[208:211]
    v_mfma_f32_16x16x32_bf16 v[212:215], v[20:23], a[40:43], v[212:215]
    buffer_load_dwordx4 v[32:35], v3, s[8:11], s83 offen
    ds_read_b128 a[68:71], v6 offset:18432
    v_mfma_f32_16x16x32_bf16 v[244:247], v[20:23], a[44:47], v[244:247]
    v_mfma_f32_16x16x32_bf16 v[240:243], v[16:19], a[44:47], v[240:243]
    buffer_load_dwordx4 v[36:39], v3, s[12:15], s83 offen
    v_mfma_f32_16x16x32_bf16 a[16:19], v[16:19], a[48:51], a[16:19]
    v_mfma_f32_16x16x32_bf16 a[20:23], v[20:23], a[48:51], a[20:23]
    v_mfma_f32_16x16x32_bf16 a[24:27], v[24:27], a[48:51], a[24:27]
    s_waitcnt vmcnt(12)
    v_perm_b32 v16, v71, v67, s84
    v_perm_b32 v17, v79, v75, s84
    v_mfma_f32_16x16x32_bf16 a[28:31], v[28:31], a[48:51], a[28:31]
    v_perm_b32 v18, v87, v83, s84
    v_perm_b32 v19, v95, v91, s84
    v_mfma_f32_16x16x32_bf16 v[252:255], v[28:31], a[44:47], v[252:255]
    v_perm_b32 v20, v71, v67, s85
    v_perm_b32 v21, v79, v75, s85
    v_mfma_f32_16x16x32_bf16 v[248:251], v[24:27], a[44:47], v[248:251]
    v_perm_b32 v22, v87, v83, s85
    v_perm_b32 v23, v95, v91, s85
    v_mfma_f32_16x16x32_bf16 v[216:219], v[24:27], a[40:43], v[216:219]
    v_mfma_f32_16x16x32_bf16 v[220:223], v[28:31], a[40:43], v[220:223]
    buffer_load_dwordx4 v[40:43], v3, s[16:19], s83 offen
    s_cmp_eq_u32 s82, 3
    v_mfma_f32_16x16x32_bf16 v[188:191], v[28:31], a[36:39], v[188:191]
    s_cbranch_scc1 L_ool10
L_ret10:
    v_mfma_f32_16x16x32_bf16 v[184:187], v[24:27], a[36:39], v[184:187]
    buffer_load_dwordx4 v[44:47], v3, s[20:23], s83 offen
    v_mfma_f32_16x16x32_bf16 v[152:155], v[24:27], a[32:35], v[152:155]
    v_mfma_f32_16x16x32_bf16 v[156:159], v[28:31], a[32:35], v[156:159]
    s_waitcnt lgkmcnt(0)
    v_mfma_f32_16x16x32_bf16 v[156:159], v[20:23], a[52:55], v[156:159]
    v_perm_b32 v24, v70, v66, s84
    v_perm_b32 v25, v78, v74, s84
    v_mfma_f32_16x16x32_bf16 v[152:155], v[16:19], a[52:55], v[152:155]
    v_perm_b32 v26, v86, v82, s84
    v_perm_b32 v27, v94, v90, s84
    v_mfma_f32_16x16x32_bf16 v[184:187], v[16:19], a[56:59], v[184:187]
    v_perm_b32 v28, v70, v66, s85
    v_perm_b32 v29, v78, v74, s85
    v_mfma_f32_16x16x32_bf16 v[188:191], v[20:23], a[56:59], v[188:191]
    v_perm_b32 v30, v86, v82, s85
    v_perm_b32 v31, v94, v90, s85
    v_mfma_f32_16x16x32_bf16 v[220:223], v[20:23], a[60:63], v[220:223]
    v_mfma_f32_16x16x32_bf16 v[216:219], v[16:19], a[60:63], v[216:219]
    buffer_load_dwordx4 v[48:51], v4, s[8:11], s83 offen
    ds_read_b128 a[32:35], v5 offset:20480
    v_mfma_f32_16x16x32_bf16 v[248:251], v[16:19], a[64:67], v[248:251]
    v_mfma_f32_16x16x32_bf16 v[252:255], v[20:23], a[64:67], v[252:255]
    buffer_load_dwordx4 v[52:55], v4, s[12:15], s83 offen
    ds_read_b128 a[36:39], v5 offset:22528
    v_mfma_f32_16x16x32_bf16 a[28:31], v[20:23], a[68:71], a[28:31]
    v_mfma_f32_16x16x32_bf16 a[24:27], v[16:19], a[68:71], a[24:27]
    v_mfma_f32_16x16x32_bf16 a[20:23], v[28:31], a[68:71], a[20:23]
    v_perm_b32 v16, v69, v65, s84
    v_perm_b32 v17, v77, v73, s84
    v_mfma_f32_16x16x32_bf16 a[16:19], v[24:27], a[68:71], a[16:19]
    v_perm_b32 v18, v85, v81, s84
    v_perm_b32 v19, v93, v89, s84
    v_mfma_f32_16x16x32_bf16 v[240:243], v[24:27], a[64:67], v[240:243]
    v_perm_b32 v20, v69, v65, s85
    v_perm_b32 v21, v77, v73, s85
    v_mfma_f32_16x16x32_bf16 v[244:247], v[28:31], a[64:67], v[244:247]
    v_perm_b32 v22, v85, v81, s85
    v_perm_b32 v23, v93, v89, s85
    v_mfma_f32_16x16x32_bf16 v[212:215], v[28:31], a[60:63], v[212:215]
    v_mfma_f32_16x16x32_bf16 v[208:211], v[24:27], a[60:63], v[208:211]
    buffer_load_dwordx4 v[56:59], v4, s[16:19], s83 offen
    ds_read_b128 a[40:43], v5 offset:24576
    v_mfma_f32_16x16x32_bf16 v[176:179], v[24:27], a[56:59], v[176:179]
    v_mfma_f32_16x16x32_bf16 v[180:183], v[28:31], a[56:59], v[180:183]
    buffer_load_dwordx4 v[60:63], v4, s[20:23], s83 offen
    ds_read_b128 a[44:47], v5 offset:26624
    v_mfma_f32_16x16x32_bf16 v[148:151], v[28:31], a[52:55], v[148:151]
    s_add_u32 s83, s83, 0x80000
    s_sub_u32 s87, s83, 5242880
    s_cselect_b32 s83, s83, s87
    v_mfma_f32_16x16x32_bf16 v[144:147], v[24:27], a[52:55], v[144:147]
    s_add_u32 s94, s88, 40960
    s_add_u32 m0, s89, 86016
    s_nop 0
    buffer_load_dwordx4 v7, s[4:7], s94 offen offset:0  lds
    v_mfma_f32_16x16x32_bf16 v[140:143], v[20:23], a[52:55], v[140:143]
    v_perm_b32 v24, v68, v64, s84
    v_perm_b32 v25, v76, v72, s84
    v_mfma_f32_16x16x32_bf16 v[136:139], v[16:19], a[52:55], v[136:139]
    v_perm_b32 v26, v84, v80, s84
    v_perm_b32 v27, v92, v88, s84
    v_mfma_f32_16x16x32_bf16 v[168:171], v[16:19], a[56:59], v[168:171]
    v_perm_b32 v28, v68, v64, s85
    v_perm_b32 v29, v76, v72, s85
    v_mfma_f32_16x16x32_bf16 v[172:175], v[20:23], a[56:59], v[172:175]
    v_perm_b32 v30, v84, v80, s85
    v_perm_b32 v31, v92, v88, s85
    v_mfma_f32_16x16x32_bf16 v[204:207], v[20:23], a[60:63], v[204:207]
    v_mfma_f32_16x16x32_bf16 v[200:203], v[16:19], a[60:63], v[200:203]
    buffer_load_dwordx4 v[64:67], v1, s[8:11], s83 offen
    ds_read_b128 a[48:51], v5 offset:28672
    v_mfma_f32_16x16x32_bf16 v[232:235], v[16:19], a[64:67], v[232:235]
    v_mfma_f32_16x16x32_bf16 v[236:239], v[20:23], a[64:67], v[236:239]
    buffer_load_dwordx4 v[68:71], v1, s[12:15], s83 offen
    v_mfma_f32_16x16x32_bf16 a[12:15], v[20:23], a[68:71], a[12:15]
    v_mfma_f32_16x16x32_bf16 a[8:11], v[16:19], a[68:71], a[8:11]
    v_mfma_f32_16x16x32_bf16 a[4:7], v[28:31], a[68:71], a[4:7]
    s_waitcnt vmcnt(12)
    v_perm_b32 v16, v100, v96, s84
    v_perm_b32 v17, v108, v104, s84
    v_mfma_f32_16x16x32_bf16 a[0:3], v[24:27], a[68:71], a[0:3]
    v_perm_b32 v18, v116, v112, s84
    v_perm_b32 v19, v124, v120, s84
    v_mfma_f32_16x16x32_bf16 v[224:227], v[24:27], a[64:67], v[224:227]
    v_perm_b32 v20, v100, v96, s85
    v_perm_b32 v21, v108, v104, s85
    v_mfma_f32_16x16x32_bf16 v[228:231], v[28:31], a[64:67], v[228:231]
    v_perm_b32 v22, v116, v112, s85
    v_perm_b32 v23, v124, v120, s85
    v_mfma_f32_16x16x32_bf16 v[196:199], v[28:31], a[60:63], v[196:199]
    v_mfma_f32_16x16x32_bf16 v[192:195], v[24:27], a[60:63], v[192:195]
    buffer_load_dwordx4 v[72:75], v1, s[16:19], s83 offen
    s_cmp_eq_u32 s82, 4
    v_mfma_f32_16x16x32_bf16 v[160:163], v[24:27], a[56:59], v[160:163]
    s_cbranch_scc1 L_ool11
L_ret11:
    v_mfma_f32_16x16x32_bf16 v[164:167], v[28:31], a[56:59], v[164:167]
    buffer_load_dwordx4 v[76:79], v1, s[20:23], s83 offen
    v_mfma_f32_16x16x32_bf16 v[132:135], v[28:31], a[52:55], v[132:135]
    v_mfma_f32_16x16x32_bf16 v[128:131], v[24:27], a[52:55], v[128:131]
    s_waitcnt lgkmcnt(0)
    v_mfma_f32_16x16x32_bf16 v[128:131], v[16:19], a[32:35], v[128:131]
    v_perm_b32 v24, v101, v97, s84
    v_perm_b32 v25, v109, v105, s84
    v_mfma_f32_16x16x32_bf16 v[132:135], v[20:23], a[32:35], v[132:135]
    v_perm_b32 v26, v117, v113, s84
    v_perm_b32 v27, v125, v121, s84
    v_mfma_f32_16x16x32_bf16 v[164:167], v[20:23], a[36:39], v[164:167]
    v_perm_b32 v28, v101, v97, s85
    v_perm_b32 v29, v109, v105, s85
    v_mfma_f32_16x16x32_bf16 v[160:163], v[16:19], a[36:39], v[160:163]
    v_perm_b32 v30, v117, v113, s85
    v_perm_b32 v31, v125, v121, s85
    v_mfma_f32_16x16x32_bf16 v[192:195], v[16:19], a[40:43], v[192:195]
    v_mfma_f32_16x16x32_bf16 v[196:199], v[20:23], a[40:43], v[196:199]
    buffer_load_dwordx4 v[80:83], v2, s[8:11], s83 offen
    ds_read_b128 a[52:55], v6 offset:20480
    v_mfma_f32_16x16x32_bf16 v[228:231], v[20:23], a[44:47], v[228:231]
    v_mfma_f32_16x16x32_bf16 v[224:227], v[16:19], a[44:47], v[224:227]
    buffer_load_dwordx4 v[84:87], v2, s[12:15], s83 offen
    ds_read_b128 a[56:59], v6 offset:22528
    v_mfma_f32_16x16x32_bf16 a[0:3], v[16:19], a[48:51], a[0:3]
    v_mfma_f32_16x16x32_bf16 a[4:7], v[20:23], a[48:51], a[4:7]
    v_mfma_f32_16x16x32_bf16 a[8:11], v[24:27], a[48:51], a[8:11]
    v_perm_b32 v16, v102, v98, s84
    v_perm_b32 v17, v110, v106, s84
    v_mfma_f32_16x16x32_bf16 a[12:15], v[28:31], a[48:51], a[12:15]
    v_perm_b32 v18, v118, v114, s84
    v_perm_b32 v19, v126, v122, s84
    v_mfma_f32_16x16x32_bf16 v[236:239], v[28:31], a[44:47], v[236:239]
    v_perm_b32 v20, v102, v98, s85
    v_perm_b32 v21, v110, v106, s85
    v_mfma_f32_16x16x32_bf16 v[232:235], v[24:27], a[44:47], v[232:235]
    v_perm_b32 v22, v118, v114, s85
    v_perm_b32 v23, v126, v122, s85
    v_mfma_f32_16x16x32_bf16 v[200:203], v[24:27], a[40:43], v[200:203]
    v_mfma_f32_16x16x32_bf16 v[204:207], v[28:31], a[40:43], v[204:207]
    buffer_load_dwordx4 v[88:91], v2, s[16:19], s83 offen
    ds_read_b128 a[60:63], v6 offset:24576
    v_mfma_f32_16x16x32_bf16 v[172:175], v[28:31], a[36:39], v[172:175]
    v_mfma_f32_16x16x32_bf16 v[168:171], v[24:27], a[36:39], v[168:171]
    buffer_load_dwordx4 v[92:95], v2, s[20:23], s83 offen
    ds_read_b128 a[64:67], v6 offset:26624
    v_mfma_f32_16x16x32_bf16 v[136:139], v[24:27], a[32:35], v[136:139]
    v_mfma_f32_16x16x32_bf16 v[140:143], v[28:31], a[32:35], v[140:143]
    v_mfma_f32_16x16x32_bf16 v[144:147], v[16:19], a[32:35], v[144:147]
    v_perm_b32 v24, v103, v99, s84
    v_perm_b32 v25, v111, v107, s84
    v_mfma_f32_16x16x32_bf16 v[148:151], v[20:23], a[32:35], v[148:151]
    v_perm_b32 v26, v119, v115, s84
    v_perm_b32 v27, v127, v123, s84
    v_mfma_f32_16x16x32_bf16 v[180:183], v[20:23], a[36:39], v[180:183]
    v_perm_b32 v28, v103, v99, s85
    v_perm_b32 v29, v111, v107, s85
    v_mfma_f32_16x16x32_bf16 v[176:179], v[16:19], a[36:39], v[176:179]
    v_perm_b32 v30, v119, v115, s85
    v_perm_b32 v31, v127, v123, s85
    v_mfma_f32_16x16x32_bf16 v[208:211], v[16:19], a[40:43], v[208:211]
    v_mfma_f32_16x16x32_bf16 v[212:215], v[20:23], a[40:43], v[212:215]
    buffer_load_dwordx4 v[96:99], v3, s[8:11], s83 offen
    ds_read_b128 a[68:71], v6 offset:28672
    v_mfma_f32_16x16x32_bf16 v[244:247], v[20:23], a[44:47], v[244:247]
    v_mfma_f32_16x16x32_bf16 v[240:243], v[16:19], a[44:47], v[240:243]
    buffer_load_dwordx4 v[100:103], v3, s[12:15], s83 offen
    v_mfma_f32_16x16x32_bf16 a[16:19], v[16:19], a[48:51], a[16:19]
    v_mfma_f32_16x16x32_bf16 a[20:23], v[20:23], a[48:51], a[20:23]
    v_mfma_f32_16x16x32_bf16 a[24:27], v[24:27], a[48:51], a[24:27]
    s_waitcnt vmcnt(11)
    v_perm_b32 v16, v39, v35, s84
    v_perm_b32 v17, v47, v43, s84
    v_mfma_f32_16x16x32_bf16 a[28:31], v[28:31], a[48:51], a[28:31]
    v_perm_b32 v18, v55, v51, s84
    v_perm_b32 v19, v63, v59, s84
    v_mfma_f32_16x16x32_bf16 v[252:255], v[28:31], a[44:47], v[252:255]
    v_perm_b32 v20, v39, v35, s85
    v_perm_b32 v21, v47, v43, s85
    v_mfma_f32_16x16x32_bf16 v[248:251], v[24:27], a[44:47], v[248:251]
    v_perm_b32 v22, v55, v51, s85
    v_perm_b32 v23, v63, v59, s85
    v_mfma_f32_16x16x32_bf16 v[216:219], v[24:27], a[40:43], v[216:219]
    v_mfma_f32_16x16x32_bf16 v[220:223], v[28:31], a[40:43], v[220:223]
    buffer_load_dwordx4 v[104:107], v3, s[16:19], s83 offen
    s_cmp_eq_u32 s82, 5
    v_mfma_f32_16x16x32_bf16 v[188:191], v[28:31], a[36:39], v[188:191]
    s_cbranch_scc1 L_ool12
L_ret12:
    v_mfma_f32_16x16x32_bf16 v[184:187], v[24:27], a[36:39], v[184:187]
    buffer_load_dwordx4 v[108:111], v3, s[20:23], s83 offen
    v_mfma_f32_16x16x32_bf16 v[152:155], v[24:27], a[32:35], v[152:155]
    v_mfma_f32_16x16x32_bf16 v[156:159], v[28:31], a[32:35], v[156:159]
    s_waitcnt lgkmcnt(0)
    v_mfma_f32_16x16x32_bf16 v[156:159], v[20:23], a[52:55], v[156:159]
    v_perm_b32 v24, v38, v34, s84
    v_perm_b32 v25, v46, v42, s84
    v_mfma_f32_16x16x32_bf16 v[152:155], v[16:19], a[52:55], v[152:155]
    v_perm_b32 v26, v54, v50, s84
    v_perm_b32 v27, v62, v58, s84
    v_mfma_f32_16x16x32_bf16 v[184:187], v[16:19], a[56:59], v[184:187]
    v_perm_b32 v28, v38, v34, s85
    v_perm_b32 v29, v46, v42, s85
    v_mfma_f32_16x16x32_bf16 v[188:191], v[20:23], a[56:59], v[188:191]
    v_perm_b32 v30, v54, v50, s85
    v_perm_b32 v31, v62, v58, s85
    v_mfma_f32_16x16x32_bf16 v[220:223], v[20:23], a[60:63], v[220:223]
    s_waitcnt vmcnt(12)
    s_barrier
    v_mfma_f32_16x16x32_bf16 v[216:219], v[16:19], a[60:63], v[216:219]
    buffer_load_dwordx4 v[112:115], v4, s[8:11], s83 offen
    ds_read_b128 a[32:35], v5 offset:30720
    v_mfma_f32_16x16x32_bf16 v[248:251], v[16:19], a[64:67], v[248:251]
    v_mfma_f32_16x16x32_bf16 v[252:255], v[20:23], a[64:67], v[252:255]
    buffer_load_dwordx4 v[116:119], v4, s[12:15], s83 offen
    ds_read_b128 a[36:39], v5 offset:32768
    v_mfma_f32_16x16x32_bf16 a[28:31], v[20:23], a[68:71], a[28:31]
    v_mfma_f32_16x16x32_bf16 a[24:27], v[16:19], a[68:71], a[24:27]
    v_mfma_f32_16x16x32_bf16 a[20:23], v[28:31], a[68:71], a[20:23]
    v_perm_b32 v16, v37, v33, s84
    v_perm_b32 v17, v45, v41, s84
    v_mfma_f32_16x16x32_bf16 a[16:19], v[24:27], a[68:71], a[16:19]
    v_perm_b32 v18, v53, v49, s84
    v_perm_b32 v19, v61, v57, s84
    v_mfma_f32_16x16x32_bf16 v[240:243], v[24:27], a[64:67], v[240:243]
    v_perm_b32 v20, v37, v33, s85
    v_perm_b32 v21, v45, v41, s85
    v_mfma_f32_16x16x32_bf16 v[244:247], v[28:31], a[64:67], v[244:247]
    v_perm_b32 v22, v53, v49, s85
    v_perm_b32 v23, v61, v57, s85
    v_mfma_f32_16x16x32_bf16 v[212:215], v[28:31], a[60:63], v[212:215]
    v_mfma_f32_16x16x32_bf16 v[208:211], v[24:27], a[60:63], v[208:211]
    buffer_load_dwordx4 v[120:123], v4, s[16:19], s83 offen
    ds_read_b128 a[40:43], v5 offset:34816
    v_mfma_f32_16x16x32_bf16 v[176:179], v[24:27], a[56:59], v[176:179]
    v_mfma_f32_16x16x32_bf16 v[180:183], v[28:31], a[56:59], v[180:183]
    buffer_load_dwordx4 v[124:127], v4, s[20:23], s83 offen
    ds_read_b128 a[44:47], v5 offset:36864
    v_mfma_f32_16x16x32_bf16 v[148:151], v[28:31], a[52:55], v[148:151]
    s_add_u32 s83, s83, 0x80000
    s_sub_u32 s87, s83, 5242880
    s_cselect_b32 s83, s83, s87
    v_mfma_f32_16x16x32_bf16 v[144:147], v[24:27], a[52:55], v[144:147]
    v_mfma_f32_16x16x32_bf16 v[140:143], v[20:23], a[52:55], v[140:143]
    v_perm_b32 v24, v36, v32, s84
    v_perm_b32 v25, v44, v40, s84
    v_mfma_f32_16x16x32_bf16 v[136:139], v[16:19], a[52:55], v[136:139]
    v_perm_b32 v26, v52, v48, s84
    v_perm_b32 v27, v60, v56, s84
    v_mfma_f32_16x16x32_bf16 v[168:171], v[16:19], a[56:59], v[168:171]
    v_perm_b32 v28, v36, v32, s85
    v_perm_b32 v29, v44, v40, s85
    v_mfma_f32_16x16x32_bf16 v[172:175], v[20:23], a[56:59], v[172:175]
    v_perm_b32 v30, v52, v48, s85
    v_perm_b32 v31, v60, v56, s85
    v_mfma_f32_16x16x32_bf16 v[204:207], v[20:23], a[60:63], v[204:207]
    v_mfma_f32_16x16x32_bf16 v[200:203], v[16:19], a[60:63], v[200:203]
    buffer_load_dwordx4 v[32:35], v1, s[8:11], s83 offen
    ds_read_b128 a[48:51], v5 offset:38912
    v_mfma_f32_16x16x32_bf16 v[232:235], v[16:19], a[64:67], v[232:235]
    v_mfma_f32_16x16x32_bf16 v[236:239], v[20:23], a[64:67], v[236:239]
    buffer_load_dwordx4 v[36:39], v1, s[12:15], s83 offen
    v_mfma_f32_16x16x32_bf16 a[12:15], v[20:23], a[68:71], a[12:15]
    v_mfma_f32_16x16x32_bf16 a[8:11], v[16:19], a[68:71], a[8:11]
    v_mfma_f32_16x16x32_bf16 a[4:7], v[28:31], a[68:71], a[4:7]
    s_waitcnt vmcnt(10)
    v_perm_b32 v16, v68, v64, s84
    v_perm_b32 v17, v76, v72, s84
    v_mfma_f32_16x16x32_bf16 a[0:3], v[24:27], a[68:71], a[0:3]
    v_perm_b32 v18, v84, v80, s84
    v_perm_b32 v19, v92, v88, s84
    v_mfma_f32_16x16x32_bf16 v[224:227], v[24:27], a[64:67], v[224:227]
    v_perm_b32 v20, v68, v64, s85
    v_perm_b32 v21, v76, v72, s85
    v_mfma_f32_16x16x32_bf16 v[228:231], v[28:31], a[64:67], v[228:231]
    v_perm_b32 v22, v84, v80, s85
    v_perm_b32 v23, v92, v88, s85
    v_mfma_f32_16x16x32_bf16 v[196:199], v[28:31], a[60:63], v[196:199]
    s_waitcnt vmcnt(7)
    ds_read_b128 a[120:123], v10 offset:0
    v_mfma_f32_16x16x32_bf16 v[192:195], v[24:27], a[60:63], v[192:195]
    buffer_load_dwordx4 v[40:43], v1, s[16:19], s83 offen
    ds_read_b128 a[136:139], v10 offset:4224
    v_mfma_f32_16x16x32_bf16 v[160:163], v[24:27], a[56:59], v[160:163]
    v_xor_b32 v12, 16, v10
    v_mfma_f32_16x16x32_bf16 v[164:167], v[28:31], a[56:59], v[164:167]
    buffer_load_dwordx4 v[44:47], v1, s[20:23], s83 offen
    ds_read_b128 a[124:127], v12 offset:0
    v_mfma_f32_16x16x32_bf16 v[132:135], v[28:31], a[52:55], v[132:135]
    ds_read_b128 a[140:143], v12 offset:4224
    v_xor_b32_e64 v12, 32, v10
    v_mfma_f32_16x16x32_bf16 v[128:131], v[24:27], a[52:55], v[128:131]
    s_waitcnt lgkmcnt(4)
    ds_read_b128 a[128:131], v12 offset:0
    v_mfma_f32_16x16x32_bf16 v[128:131], v[16:19], a[32:35], v[128:131]
    v_perm_b32 v24, v69, v65, s84
    v_perm_b32 v25, v77, v73, s84
    v_mfma_f32_16x16x32_bf16 v[132:135], v[20:23], a[32:35], v[132:135]
    v_perm_b32 v26, v85, v81, s84
    v_perm_b32 v27, v93, v89, s84
    v_mfma_f32_16x16x32_bf16 v[164:167], v[20:23], a[36:39], v[164:167]
    v_perm_b32 v28, v69, v65, s85
    v_perm_b32 v29, v77, v73, s85
    v_mfma_f32_16x16x32_bf16 v[160:163], v[16:19], a[36:39], v[160:163]
    v_perm_b32 v30, v85, v81, s85
    v_perm_b32 v31, v93, v89, s85
    v_mfma_f32_16x16x32_bf16 v[192:195], v[16:19], a[40:43], v[192:195]
    ds_read_b128 a[144:147], v12 offset:4224
    v_xor_b32 v12, 48, v10
    v_mfma_f32_16x16x32_bf16 v[196:199], v[20:23], a[40:43], v[196:199]
    buffer_load_dwordx4 v[48:51], v2, s[8:11], s83 offen
L_pad3:
    s_cbranch_execz L_pad7
    ds_read_b128 a[52:55], v6 offset:30720
    v_mfma_f32_16x16x32_bf16 v[228:231], v[20:23], a[44:47], v[228:231]
    ds_read_b128 a[132:135], v12 offset:0
    v_mfma_f32_16x16x32_bf16 v[224:227], v[16:19], a[44:47], v[224:227]
    buffer_load_dwordx4 v[52:55], v2, s[12:15], s83 offen
    ds_read_b128 a[56:59], v6 offset:32768
    v_mfma_f32_16x16x32_bf16 a[0:3], v[16:19], a[48:51], a[0:3]
    ds_read_b128 a[148:151], v12 offset:4224
    v_mfma_f32_16x16x32_bf16 a[4:7], v[20:23], a[48:51], a[4:7]
    ds_read_b64_tr_b16 a[152:153], v11 offset:8448
    v_mfma_f32_16x16x32_bf16 a[8:11], v[24:27], a[48:51], a[8:11]
    v_perm_b32 v16, v70, v66, s84
    v_perm_b32 v17, v78, v74, s84
    v_mfma_f32_16x16x32_bf16 a[12:15], v[28:31], a[48:51], a[12:15]
    v_perm_b32 v18, v86, v82, s84
    v_perm_b32 v19, v94, v90, s84
    v_mfma_f32_16x16x32_bf16 v[236:239], v[28:31], a[44:47], v[236:239]
    v_perm_b32 v20, v70, v66, s85
    v_perm_b32 v21, v78, v74, s85
    v_mfma_f32_16x16x32_bf16 v[232:235], v[24:27], a[44:47], v[232:235]
    v_perm_b32 v22, v86, v82, s85
    v_perm_b32 v23, v94, v90, s85
    v_mfma_f32_16x16x32_bf16 v[200:203], v[24:27], a[40:43], v[200:203]
    ds_read_b64_tr_b16 a[168:169], v11 offset:8576
    v_xor_b32 v13, 32, v11
    v_mfma_f32_16x16x32_bf16 v[204:207], v[28:31], a[40:43], v[204:207]
    buffer_load_dwordx4 v[56:59], v2, s[16:19], s83 offen
    ds_read_b128 a[60:63], v6 offset:34816
    v_mfma_f32_16x16x32_bf16 v[172:175], v[28:31], a[36:39], v[172:175]
    ds_read_b64_tr_b16 a[156:157], v13 offset:8448
    v_mfma_f32_16x16x32_bf16 v[168:171], v[24:27], a[36:39], v[168:171]
    buffer_load_dwordx4 v[60:63], v2, s[20:23], s83 offen
    ds_read_b128 a[64:67], v6 offset:36864
    v_mfma_f32_16x16x32_bf16 v[136:139], v[24:27], a[32:35], v[136:139]
    ds_read_b64_tr_b16 a[172:173], v13 offset:8576
    v_xor_b32_e64 v13, 64, v11
    v_mfma_f32_16x16x32_bf16 v[140:143], v[28:31], a[32:35], v[140:143]
    ds_read_b64_tr_b16 a[160:161], v13 offset:8448
    v_mfma_f32_16x16x32_bf16 v[144:147], v[16:19], a[32:35], v[144:147]
    v_perm_b32 v24, v71, v67, s84
    v_perm_b32 v25, v79, v75, s84
    v_mfma_f32_16x16x32_bf16 v[148:151], v[20:23], a[32:35], v[148:151]
    v_perm_b32 v26, v87, v83, s84
    v_perm_b32 v27, v95, v91, s84
    v_mfma_f32_16x16x32_bf16 v[180:183], v[20:23], a[36:39], v[180:183]
    v_perm_b32 v28, v71, v67, s85
    v_perm_b32 v29, v79, v75, s85
    v_mfma_f32_16x16x32_bf16 v[176:179], v[16:19], a[36:39], v[176:179]
    v_perm_b32 v30, v87, v83, s85
    v_perm_b32 v31, v95, v91, s85
    v_mfma_f32_16x16x32_bf16 v[208:211], v[16:19], a[40:43], v[208:211]
    ds_read_b64_tr_b16 a[176:177], v13 offset:8576
    v_xor_b32 v13, 96, v11
    v_mfma_f32_16x16x32_bf16 v[212:215], v[20:23], a[40:43], v[212:215]
    buffer_load_dwordx4 v[64:67], v3, s[8:11], s83 offen
    ds_read_b128 a[68:71], v6 offset:38912
    v_mfma_f32_16x16x32_bf16 v[244:247], v[20:23], a[44:47], v[244:247]
    ds_read_b64_tr_b16 a[164:165], v13 offset:8448
    v_mfma_f32_16x16x32_bf16 v[240:243], v[16:19], a[44:47], v[240:243]
    buffer_load_dwordx4 v[68:71], v3, s[12:15], s83 offen
    ds_read_b64_tr_b16 a[180:181], v13 offset:8576
    v_mfma_f32_16x16x32_bf16 a[16:19], v[16:19], a[48:51], a[16:19]
    v_mfma_f32_16x16x32_bf16 a[20:23], v[20:23], a[48:51], a[20:23]
    v_mfma_f32_16x16x32_bf16 a[24:27], v[24:27], a[48:51], a[24:27]
    s_waitcnt vmcnt(10)
    v_perm_b32 v16, v103, v99, s84
    v_perm_b32 v17, v111, v107, s84
    v_mfma_f32_16x16x32_bf16 a[28:31], v[28:31], a[48:51], a[28:31]
    v_perm_b32 v18, v119, v115, s84
    v_perm_b32 v19, v127, v123, s84
    v_mfma_f32_16x16x32_bf16 v[252:255], v[28:31], a[44:47], v[252:255]
    v_perm_b32 v20, v103, v99, s85
    v_perm_b32 v21, v111, v107, s85
    v_mfma_f32_16x16x32_bf16 v[248:251], v[24:27], a[44:47], v[248:251]
    v_perm_b32 v22, v119, v115, s85
    v_perm_b32 v23, v127, v123, s85
    v_mfma_f32_16x16x32_bf16 v[216:219], v[24:27], a[40:43], v[216:219]
    v_mfma_f32_16x16x32_bf16 v[220:223], v[28:31], a[40:43], v[220:223]
    buffer_load_dwordx4 v[72:75], v3, s[16:19], s83 offen
    v_mfma_f32_16x16x32_bf16 v[188:191], v[28:31], a[36:39], v[188:191]
    v_mfma_f32_16x16x32_bf16 v[184:187], v[24:27], a[36:39], v[184:187]
    buffer_load_dwordx4 v[76:79], v3, s[20:23], s83 offen
    v_mfma_f32_16x16x32_bf16 v[152:155], v[24:27], a[32:35], v[152:155]
    v_mfma_f32_16x16x32_bf16 v[156:159], v[28:31], a[32:35], v[156:159]
    s_waitcnt lgkmcnt(2)
    v_mfma_f32_16x16x32_bf16 v[156:159], v[20:23], a[52:55], v[156:159]
    v_perm_b32 v24, v102, v98, s84
    v_perm_b32 v25, v110, v106, s84
    v_mfma_f32_16x16x32_bf16 v[152:155], v[16:19], a[52:55], v[152:155]
    v_perm_b32 v26, v118, v114, s84
    v_perm_b32 v27, v126, v122, s84
    v_mfma_f32_16x16x32_bf16 v[184:187], v[16:19], a[56:59], v[184:187]
    v_perm_b32 v28, v102, v98, s85
    v_perm_b32 v29, v110, v106, s85
    v_mfma_f32_16x16x32_bf16 v[188:191], v[20:23], a[56:59], v[188:191]
    v_perm_b32 v30, v118, v114, s85
    v_perm_b32 v31, v126, v122, s85
    v_mfma_f32_16x16x32_bf16 v[220:223], v[20:23], a[60:63], v[220:223]
    v_mfma_f32_16x16x32_bf16 v[216:219], v[16:19], a[60:63], v[216:219]
    buffer_load_dwordx4 v[80:83], v4, s[8:11], s83 offen
    ds_read_b128 a[32:35], v5 offset:40960
    v_mfma_f32_16x16x32_bf16 v[248:251], v[16:19], a[64:67], v[248:251]
    v_mfma_f32_16x16x32_bf16 v[252:255], v[20:23], a[64:67], v[252:255]
    buffer_load_dwordx4 v[84:87], v4, s[12:15], s83 offen
    ds_read_b128 a[36:39], v5 offset:43008
    v_mfma_f32_16x16x32_bf16 a[28:31], v[20:23], a[68:71], a[28:31]
    v_mfma_f32_16x16x32_bf16 a[24:27], v[16:19], a[68:71], a[24:27]
    v_mfma_f32_16x16x32_bf16 a[20:23], v[28:31], a[68:71], a[20:23]
    v_perm_b32 v16, v101, v97, s84
    v_perm_b32 v17, v109, v105, s84
    v_mfma_f32_16x16x32_bf16 a[16:19], v[24:27], a[68:71], a[16:19]
    v_perm_b32 v18, v117, v113, s84
    v_perm_b32 v19, v125, v121, s84
    v_mfma_f32_16x16x32_bf16 v[240:243], v[24:27], a[64:67], v[240:243]
    v_perm_b32 v20, v101, v97, s85
    v_perm_b32 v21, v109, v105, s85
    v_mfma_f32_16x16x32_bf16 v[244:247], v[28:31], a[64:67], v[244:247]
    v_perm_b32 v22, v117, v113, s85
    v_perm_b32 v23, v125, v121, s85
    v_mfma_f32_16x16x32_bf16 v[212:215], v[28:31], a[60:63], v[212:215]
    v_mfma_f32_16x16x32_bf16 v[208:211], v[24:27], a[60:63], v[208:211]
    buffer_load_dwordx4 v[88:91], v4, s[16:19], s83 offen
    ds_read_b128 a[40:43], v5 offset:45056
    v_mfma_f32_16x16x32_bf16 v[176:179], v[24:27], a[56:59], v[176:179]
    v_mfma_f32_16x16x32_bf16 v[180:183], v[28:31], a[56:59], v[180:183]
    buffer_load_dwordx4 v[92:95], v4, s[20:23], s83 offen
    ds_read_b128 a[44:47], v5 offset:47104
    v_mfma_f32_16x16x32_bf16 v[148:151], v[28:31], a[52:55], v[148:151]
    v_lshrrev_b32 v2, 3, v0
    v_and_b32 v3, 7, v0
    v_mfma_f32_16x16x32_bf16 v[144:147], v[24:27], a[52:55], v[144:147]
    v_lshrrev_b32 v4, 4, v0
    v_lshlrev_b32 v4, 1, v4
    v_mfma_f32_16x16x32_bf16 v[140:143], v[20:23], a[52:55], v[140:143]
    v_perm_b32 v24, v100, v96, s84
    v_perm_b32 v25, v108, v104, s84
    v_mfma_f32_16x16x32_bf16 v[136:139], v[16:19], a[52:55], v[136:139]
    v_perm_b32 v26, v116, v112, s84
    v_perm_b32 v27, v124, v120, s84
    v_mfma_f32_16x16x32_bf16 v[168:171], v[16:19], a[56:59], v[168:171]
    v_perm_b32 v28, v100, v96, s85
    v_perm_b32 v29, v108, v104, s85
    v_mfma_f32_16x16x32_bf16 v[172:175], v[20:23], a[56:59], v[172:175]
    v_perm_b32 v30, v116, v112, s85
    v_perm_b32 v31, v124, v120, s85
    v_mfma_f32_16x16x32_bf16 v[204:207], v[20:23], a[60:63], v[204:207]
    s_add_u32 m0, s86, 0
    s_mov_b32 s92, 4096
    v_mfma_f32_16x16x32_bf16 v[200:203], v[16:19], a[60:63], v[200:203]
    buffer_load_dwordx4 v9, s[28:31], s92 offen offset:0 nt lds
    ds_read_b128 a[48:51], v5 offset:49152
    v_mfma_f32_16x16x32_bf16 v[232:235], v[16:19], a[64:67], v[232:235]
    v_xor_b32 v3, v3, v4
    v_mul_u32_u24 v4, 1280, v2
    v_mfma_f32_16x16x32_bf16 v[236:239], v[20:23], a[64:67], v[236:239]
    v_lshl_add_u32 v1, v3, 4, v4
    s_mul_i32 s83, s3, 40960
    v_mfma_f32_16x16x32_bf16 a[12:15], v[20:23], a[68:71], a[12:15]
    v_add_u32 v1, s83, v1
    v_and_b32 v2, 3, v2
    v_mfma_f32_16x16x32_bf16 a[8:11], v[16:19], a[68:71], a[8:11]
    buffer_load_dwordx4 v9, s[28:31], s92 offen offset:1024 nt lds
    v_xor_b32_e64 v2, s3, v2
    v_mfma_f32_16x16x32_bf16 a[4:7], v[28:31], a[68:71], a[4:7]
    s_waitcnt vmcnt(10)
    v_perm_b32 v16, v36, v32, s84
    v_perm_b32 v17, v44, v40, s84
    v_mfma_f32_16x16x32_bf16 a[0:3], v[24:27], a[68:71], a[0:3]
    v_perm_b32 v18, v52, v48, s84
    v_perm_b32 v19, v60, v56, s84
    v_mfma_f32_16x16x32_bf16 v[224:227], v[24:27], a[64:67], v[224:227]
    v_perm_b32 v20, v36, v32, s85
    v_perm_b32 v21, v44, v40, s85
    v_mfma_f32_16x16x32_bf16 v[228:231], v[28:31], a[64:67], v[228:231]
    v_perm_b32 v22, v52, v48, s85
    v_perm_b32 v23, v60, v56, s85
    v_mfma_f32_16x16x32_bf16 v[196:199], v[28:31], a[60:63], v[196:199]
    s_add_u32 m0, s86, 128
    s_nop 0
    buffer_load_dwordx4 v9, s[28:31], s92 offen offset:2048 nt lds
    v_mfma_f32_16x16x32_bf16 v[192:195], v[24:27], a[60:63], v[192:195]
    v_lshrrev_b32 v3, 2, v0
    v_lshlrev_b32 v3, 7, v3
    v_mfma_f32_16x16x32_bf16 v[160:163], v[24:27], a[56:59], v[160:163]
    v_lshl_add_u32 v3, v2, 5, v3
    v_and_b32_e64 v2, 3, v0
    v_mfma_f32_16x16x32_bf16 v[164:167], v[28:31], a[56:59], v[164:167]
    v_lshl_add_u32 v7, v2, 3, v3
    v_add_u32 v2, 9216, v1
    v_mfma_f32_16x16x32_bf16 v[132:135], v[28:31], a[52:55], v[132:135]
    v_add_u32 v3, 18432, v1
    v_add_u32 v4, 27648, v1
    v_mfma_f32_16x16x32_bf16 v[128:131], v[24:27], a[52:55], v[128:131]
    s_waitcnt lgkmcnt(0)
    buffer_load_dwordx4 v9, s[28:31], s92 offen offset:3072 nt lds
    v_mfma_f32_16x16x32_bf16 v[128:131], v[16:19], a[32:35], v[128:131]
    s_mul_i32 s89, s3, 20480
    v_perm_b32 v24, v37, v33, s84
    v_perm_b32 v25, v45, v41, s84
    v_mfma_f32_16x16x32_bf16 v[132:135], v[20:23], a[32:35], v[132:135]
    s_add_u32 s89, s89, 81920
    v_perm_b32 v26, v53, v49, s84
    v_perm_b32 v27, v61, v57, s84
    v_mfma_f32_16x16x32_bf16 v[164:167], v[20:23], a[36:39], v[164:167]
    v_perm_b32 v28, v37, v33, s85
    v_perm_b32 v29, v45, v41, s85
    v_mfma_f32_16x16x32_bf16 v[160:163], v[16:19], a[36:39], v[160:163]
    v_perm_b32 v30, v53, v49, s85
    v_perm_b32 v31, v61, v57, s85
    v_mfma_f32_16x16x32_bf16 v[192:195], v[16:19], a[40:43], v[192:195]
    s_add_u32 m0, s86, 4224
    s_mov_b32 s92, 8192
    v_mfma_f32_16x16x32_bf16 v[196:199], v[20:23], a[40:43], v[196:199]
    buffer_load_dwordx4 v9, s[28:31], s92 offen offset:0 nt lds
    ds_read_b128 a[52:55], v6 offset:40960
    v_mfma_f32_16x16x32_bf16 v[228:231], v[20:23], a[44:47], v[228:231]
    v_mfma_f32_16x16x32_bf16 v[224:227], v[16:19], a[44:47], v[224:227]
    ds_read_b128 a[56:59], v6 offset:43008
    v_mfma_f32_16x16x32_bf16 a[0:3], v[16:19], a[48:51], a[0:3]
    v_mfma_f32_16x16x32_bf16 a[4:7], v[20:23], a[48:51], a[4:7]
    buffer_load_dwordx4 v9, s[28:31], s92 offen offset:1024 nt lds
    v_mfma_f32_16x16x32_bf16 a[8:11], v[24:27], a[48:51], a[8:11]
    v_perm_b32 v16, v38, v34, s84
    v_perm_b32 v17, v46, v42, s84
    v_mfma_f32_16x16x32_bf16 a[12:15], v[28:31], a[48:51], a[12:15]
    v_perm_b32 v18, v54, v50, s84
    v_perm_b32 v19, v62, v58, s84
    v_mfma_f32_16x16x32_bf16 v[236:239], v[28:31], a[44:47], v[236:239]
    v_perm_b32 v20, v38, v34, s85
    v_perm_b32 v21, v46, v42, s85
    v_mfma_f32_16x16x32_bf16 v[232:235], v[24:27], a[44:47], v[232:235]
    v_perm_b32 v22, v54, v50, s85
    v_perm_b32 v23, v62, v58, s85
    v_mfma_f32_16x16x32_bf16 v[200:203], v[24:27], a[40:43], v[200:203]
    s_add_u32 m0, s86, 4352
    v_accvgpr_read_b32 v96, a0
    v_accvgpr_read_b32 v97, a1
    v_mfma_f32_16x16x32_bf16 v[204:207], v[28:31], a[40:43], v[204:207]
    ds_read_b128 a[60:63], v6 offset:45056
    v_accvgpr_read_b32 v98, a2
    v_accvgpr_read_b32 v99, a3
    v_mfma_f32_16x16x32_bf16 v[172:175], v[28:31], a[36:39], v[172:175]
    v_accvgpr_read_b32 v100, a4
    v_accvgpr_read_b32 v101, a5
    v_mfma_f32_16x16x32_bf16 v[168:171], v[24:27], a[36:39], v[168:171]
    ds_read_b128 a[64:67], v6 offset:47104
    v_accvgpr_read_b32 v102, a6
    v_accvgpr_read_b32 v103, a7
    v_mfma_f32_16x16x32_bf16 v[136:139], v[24:27], a[32:35], v[136:139]
    buffer_load_dwordx4 v9, s[28:31], s92 offen offset:2048 nt lds
    v_mfma_f32_16x16x32_bf16 v[140:143], v[28:31], a[32:35], v[140:143]
    buffer_load_dwordx4 v9, s[28:31], s92 offen offset:3072 nt lds
    v_mfma_f32_16x16x32_bf16 v[144:147], v[16:19], a[32:35], v[144:147]
    v_perm_b32 v24, v39, v35, s84
    v_perm_b32 v25, v47, v43, s84
    v_mfma_f32_16x16x32_bf16 v[148:151], v[20:23], a[32:35], v[148:151]
    v_perm_b32 v26, v55, v51, s84
    v_perm_b32 v27, v63, v59, s84
    v_mfma_f32_16x16x32_bf16 v[180:183], v[20:23], a[36:39], v[180:183]
    v_perm_b32 v28, v39, v35, s85
    v_perm_b32 v29, v47, v43, s85
    v_mfma_f32_16x16x32_bf16 v[176:179], v[16:19], a[36:39], v[176:179]
    v_perm_b32 v30, v55, v51, s85
    v_perm_b32 v31, v63, v59, s85
    v_mfma_f32_16x16x32_bf16 v[208:211], v[16:19], a[40:43], v[208:211]
    v_accvgpr_read_b32 v104, a8
    v_accvgpr_read_b32 v105, a9
    v_mfma_f32_16x16x32_bf16 v[212:215], v[20:23], a[40:43], v[212:215]
    ds_read_b128 a[68:71], v6 offset:49152
    v_accvgpr_read_b32 v106, a10
    v_accvgpr_read_b32 v107, a11
    v_mfma_f32_16x16x32_bf16 v[244:247], v[20:23], a[44:47], v[244:247]
    v_accvgpr_read_b32 v108, a12
    v_accvgpr_read_b32 v109, a13
    v_mfma_f32_16x16x32_bf16 v[240:243], v[16:19], a[44:47], v[240:243]
    v_accvgpr_read_b32 v110, a14
    v_accvgpr_read_b32 v111, a15
    v_mfma_f32_16x16x32_bf16 a[16:19], v[16:19], a[48:51], a[16:19]
    v_add_u32 v12, s91, v14
    v_mov_b32_e64 v13, 1
    v_mfma_f32_16x16x32_bf16 a[20:23], v[20:23], a[48:51], a[20:23]
    buffer_atomic_add v13, v12, s[48:51], 0 offen sc1
    v_mfma_f32_16x16x32_bf16 a[24:27], v[24:27], a[48:51], a[24:27]
    s_waitcnt vmcnt(9)
    v_perm_b32 v32, v68, v64, s84
    v_perm_b32 v33, v76, v72, s84
    v_mfma_f32_16x16x32_bf16 a[28:31], v[28:31], a[48:51], a[28:31]
    v_perm_b32 v34, v84, v80, s84
    v_perm_b32 v35, v92, v88, s84
    v_mfma_f32_16x16x32_bf16 v[252:255], v[28:31], a[44:47], v[252:255]
    v_perm_b32 v36, v68, v64, s85
    v_perm_b32 v37, v76, v72, s85
    v_mfma_f32_16x16x32_bf16 v[248:251], v[24:27], a[44:47], v[248:251]
    v_perm_b32 v38, v84, v80, s85
    v_perm_b32 v39, v92, v88, s85
    v_mfma_f32_16x16x32_bf16 v[216:219], v[24:27], a[40:43], v[216:219]
    v_perm_b32 v40, v69, v65, s84
    v_perm_b32 v41, v77, v73, s84
    v_mfma_f32_16x16x32_bf16 v[220:223], v[28:31], a[40:43], v[220:223]
    v_perm_b32 v42, v85, v81, s84
    v_perm_b32 v43, v93, v89, s84
    v_mfma_f32_16x16x32_bf16 v[188:191], v[28:31], a[36:39], v[188:191]
    v_perm_b32 v44, v69, v65, s85
    v_perm_b32 v45, v77, v73, s85
    v_mfma_f32_16x16x32_bf16 v[184:187], v[24:27], a[36:39], v[184:187]
    v_perm_b32 v46, v85, v81, s85
    v_perm_b32 v47, v93, v89, s85
    v_mfma_f32_16x16x32_bf16 v[152:155], v[24:27], a[32:35], v[152:155]
    v_mfma_f32_16x16x32_bf16 v[156:159], v[28:31], a[32:35], v[156:159]
    s_waitcnt lgkmcnt(0)
    s_barrier
L_att:
    v_mfma_f32_16x16x32_bf16 v[140:143], v[44:47], a[52:55], v[140:143]
    v_perm_b32 v60, v71, v67, s85
    v_perm_b32 v53, v78, v74, s85
    v_mfma_f32_16x16x32_bf16 v[136:139], v[40:43], a[52:55], v[136:139]
    s_mov_b32 s92, 12288
    v_perm_b32 v63, v95, v91, s85
    v_add_u32 v5, s89, v14
    v_mfma_f32_16x16x32_bf16 v[132:135], v[36:39], a[52:55], v[132:135]
    s_add_u32 m0, s86, 8448
    v_perm_b32 v61, v79, v75, s85
    v_perm_b32 v62, v87, v83, s85
    v_mfma_f32_16x16x32_bf16 v[108:111], v[44:47], a[68:71], v[108:111]
    s_nop 0
    buffer_load_dwordx4 v9, s[28:31], s92 offen offset:0 nt lds
    v_mfma_f32_16x16x32_bf16 v[156:159], v[60:63], a[52:55], v[156:159]
    v_perm_b32 v54, v86, v82, s85
    v_perm_b32 v55, v94, v90, s85
    v_mfma_f32_16x16x32_bf16 v[160:163], v[32:35], a[56:59], v[160:163]
    v_perm_b32 v56, v71, v67, s84
    v_perm_b32 v50, v86, v82, s84
    v_mfma_f32_16x16x32_bf16 v[164:167], v[36:39], a[56:59], v[164:167]
    v_perm_b32 v59, v95, v91, s84
    v_perm_b32 v49, v78, v74, s84
    v_mfma_f32_16x16x32_bf16 v[128:131], v[32:35], a[52:55], v[128:131]
    v_perm_b32 v58, v87, v83, s84
    v_perm_b32 v52, v70, v66, s85
    v_mfma_f32_16x16x32_bf16 a[28:31], v[60:63], a[68:71], a[28:31]
    s_nop 0
    v_perm_b32 v51, v94, v90, s84
    v_subrev_u32_e64 v12, s86, v11
    v_mfma_f32_16x16x32_bf16 v[148:151], v[52:55], a[52:55], v[148:151]
    s_nop 0
    v_add_u32 v12, s80, v12
    v_add_u32 v12, 81920, v12
    v_mfma_f32_16x16x32_bf16 v[104:107], v[40:43], a[68:71], v[104:107]
    v_perm_b32 v57, v79, v75, s84
    v_cvt_pk_bf16_f32 v80, v160, v164
    v_mfma_f32_16x16x32_bf16 v[192:195], v[32:35], a[60:63], v[192:195]
    v_accvgpr_read_b32 v127, a31
    v_perm_b32 v48, v70, v66, s84
    v_mfma_f32_16x16x32_bf16 v[152:155], v[56:59], a[52:55], v[152:155]
    s_nop 0
    v_cvt_pk_bf16_f32 v64, v128, v132
    v_cvt_pk_bf16_f32 v17, v104, v108
    v_mfma_f32_16x16x32_bf16 v[144:147], v[48:51], a[52:55], v[144:147]
    v_cvt_pk_bf16_f32 v21, v105, v109
    v_cvt_pk_bf16_f32 v29, v107, v111
    v_mfma_f32_16x16x32_bf16 a[16:19], v[48:51], a[68:71], a[16:19]
    s_nop 0
    buffer_load_dwordx4 v9, s[28:31], s92 offen offset:1024 nt lds
    v_mfma_f32_16x16x32_bf16 a[24:27], v[56:59], a[68:71], a[24:27]
    s_add_u32 m0, s86, 8576
    v_xor_b32_e64 v13, 32, v11
    v_accvgpr_read_b32 v124, a28
    v_mfma_f32_16x16x32_bf16 a[20:23], v[52:55], a[68:71], a[20:23]
    s_nop 0
    v_accvgpr_read_b32 v114, a18
    v_accvgpr_read_b32 v115, a19
    v_mfma_f32_16x16x32_bf16 v[196:199], v[36:39], a[60:63], v[196:199]
    v_accvgpr_read_b32 v121, a25
    v_accvgpr_read_b32 v122, a26
    v_mfma_f32_16x16x32_bf16 v[100:103], v[36:39], a[68:71], v[100:103]
    s_nop 0
    v_accvgpr_read_b32 v116, a20
    v_accvgpr_read_b32 v118, a22
    v_mfma_f32_16x16x32_bf16 v[168:171], v[40:43], a[56:59], v[168:171]
    v_accvgpr_read_b32 v119, a23
    v_cvt_pk_bf16_f32 v30, v115, v119
    v_mfma_f32_16x16x32_bf16 v[176:179], v[48:51], a[56:59], v[176:179]
    v_accvgpr_read_b32 v120, a24
    v_cvt_pk_bf16_f32 v19, v120, v124
    v_mfma_f32_16x16x32_bf16 v[172:175], v[44:47], a[56:59], v[172:175]
    v_accvgpr_read_b32 v113, a17
    v_accvgpr_read_b32 v112, a16
    v_mfma_f32_16x16x32_bf16 v[184:187], v[56:59], a[56:59], v[184:187]
    v_cvt_pk_bf16_f32 v18, v112, v116
    v_accvgpr_read_b32 v117, a21
    v_mfma_f32_16x16x32_bf16 v[96:99], v[32:35], a[68:71], v[96:99]
    s_nop 0
    v_cvt_pk_bf16_f32 v22, v113, v117
    v_cvt_pk_bf16_f32 v89, v170, v174
    v_mfma_f32_16x16x32_bf16 v[180:183], v[52:55], a[56:59], v[180:183]
    v_cvt_pk_bf16_f32 v92, v163, v167
    v_accvgpr_read_b32 v125, a29
    v_mfma_f32_16x16x32_bf16 v[188:191], v[60:63], a[56:59], v[188:191]
    s_nop 0
    v_cvt_pk_bf16_f32 v23, v121, v125
    v_cvt_pk_bf16_f32 v20, v97, v101
    v_mfma_f32_16x16x32_bf16 v[200:203], v[40:43], a[60:63], v[200:203]
    s_nop 0
    v_cvt_pk_bf16_f32 v16, v96, v100
    v_cvt_pk_bf16_f32 v24, v98, v102
    v_mfma_f32_16x16x32_bf16 v[204:207], v[44:47], a[60:63], v[204:207]
    buffer_load_dwordx4 v9, s[28:31], s92 offen offset:2048 nt lds
    v_mfma_f32_16x16x32_bf16 v[208:211], v[48:51], a[60:63], v[208:211]
    v_cvt_pk_bf16_f32 v91, v186, v190
    v_cvt_pk_bf16_f32 v25, v106, v110
    v_mfma_f32_16x16x32_bf16 v[108:111], a[120:123], v[16:19], 0
    v_cvt_pk_bf16_f32 v90, v178, v182
    v_accvgpr_read_b32 v123, a27
    v_mfma_f32_16x16x32_bf16 v[108:111], a[124:127], v[20:23], v[108:111]
    v_cvt_pk_bf16_f32 v95, v187, v191
    v_cvt_pk_bf16_f32 v88, v162, v166
    v_mfma_f32_16x16x32_bf16 v[104:107], a[104:107], v[16:19], 0
    v_cvt_pk_bf16_f32 v78, v147, v151
    v_cvt_pk_bf16_f32 v31, v123, v127
    v_mfma_f32_16x16x32_bf16 v[104:107], a[108:111], v[20:23], v[104:107]
    v_cvt_pk_bf16_f32 v28, v99, v103
    v_cvt_pk_bf16_f32 v93, v171, v175
    v_mfma_f32_16x16x32_bf16 v[100:103], a[88:91], v[16:19], 0
    v_cvt_pk_bf16_f32 v65, v136, v140
    v_accvgpr_read_b32 v126, a30
    v_mfma_f32_16x16x32_bf16 v[100:103], a[92:95], v[20:23], v[100:103]
    v_cvt_pk_bf16_f32 v86, v177, v181
    v_cvt_pk_bf16_f32 v87, v185, v189
    v_mfma_f32_16x16x32_bf16 v[96:99], a[72:75], v[16:19], 0
    v_cvt_pk_bf16_f32 v83, v184, v188
    v_cvt_pk_bf16_f32 v26, v114, v118
    v_mfma_f32_16x16x32_bf16 v[96:99], a[76:79], v[20:23], v[96:99]
    v_cvt_pk_bf16_f32 v27, v122, v126
    v_cvt_pk_bf16_f32 v82, v176, v180
    v_mfma_f32_16x16x32_bf16 v[112:115], a[136:139], v[16:19], 0
    v_cvt_pk_bf16_f32 v81, v168, v172
    v_cvt_pk_bf16_f32 v68, v129, v133
    v_mfma_f32_16x16x32_bf16 v[112:115], a[140:143], v[20:23], v[112:115]
    v_cvt_pk_bf16_f32 v79, v155, v159
    v_cvt_pk_bf16_f32 v85, v169, v173
    v_mfma_f32_16x16x32_bf16 v[96:99], a[80:83], v[24:27], v[96:99]
    v_cvt_pk_bf16_f32 v66, v144, v148
    v_cvt_pk_bf16_f32 v74, v146, v150
    v_mfma_f32_16x16x32_bf16 v[108:111], a[128:131], v[24:27], v[108:111]
    v_cvt_pk_bf16_f32 v67, v152, v156
    v_cvt_pk_bf16_f32 v77, v139, v143
    v_mfma_f32_16x16x32_bf16 v[108:111], a[132:135], v[28:31], v[108:111]
    buffer_load_dwordx4 v9, s[28:31], s92 offen offset:3072 nt lds
    v_mfma_f32_16x16x32_bf16 v[104:107], a[112:115], v[24:27], v[104:107]
    s_add_u32 m0, s80, 81920
    s_mov_b32 s92, 16384
    v_cvt_pk_bf16_f32 v69, v137, v141
    v_mfma_f32_16x16x32_bf16 v[104:107], a[116:119], v[28:31], v[104:107]
    v_cvt_pk_bf16_f32 v84, v161, v165
    v_cvt_pk_bf16_f32 v71, v153, v157
    v_mfma_f32_16x16x32_bf16 v[96:99], a[84:87], v[28:31], v[96:99]
    v_cvt_pk_bf16_f32 v75, v154, v158
    v_cvt_pk_bf16_f32 v94, v179, v183
    v_mfma_f32_16x16x32_bf16 v[100:103], a[96:99], v[24:27], v[100:103]
    v_cvt_pk_bf16_f32 v72, v130, v134
    v_cvt_pk_bf16_f32 v70, v145, v149
    v_mfma_f32_16x16x32_bf16 v[100:103], a[100:103], v[28:31], v[100:103]
    s_nop 0
    v_cvt_pk_bf16_f32 v73, v138, v142
    v_max3_f32 v116, v96, v97, v98
    v_mfma_f32_16x16x32_bf16 v[112:115], a[144:147], v[24:27], v[112:115]
    v_max3_f32 v116, v116, v104, v105
    v_max3_f32 v116, v116, v108, v109
    v_mfma_f32_16x16x32_bf16 v[112:115], a[148:151], v[28:31], v[112:115]
    s_nop 0
    v_max3_f32 v117, v99, v100, v101
    v_max3_f32 v117, v117, v102, v103
    v_mfma_f32_16x16x32_bf16 v[144:147], a[136:139], v[64:67], 0
    v_max3_f32 v117, v117, v106, v107
    v_max3_f32 v117, v117, v110, v111
    v_mfma_f32_16x16x32_bf16 v[144:147], a[140:143], v[68:71], v[144:147]
    s_nop 0
    v_max3_f32 v117, v117, v114, v115
    v_max3_f32 v116, v116, v112, v113
    v_mfma_f32_16x16x32_bf16 v[144:147], a[144:147], v[72:75], v[144:147]
    v_max_f32 v116, v116, v117
    v_mov_b32 v117, v116
    v_mfma_f32_16x16x32_bf16 v[168:171], a[104:107], v[80:83], 0
    s_nop 0
    v_permlane32_swap_b32 v116, v117
    v_mfma_f32_16x16x32_bf16 v[172:175], a[120:123], v[80:83], 0
    v_max_f32 v116, v116, v117
    v_mov_b32 v117, v116
    v_mfma_f32_16x16x32_bf16 v[224:227], v[32:35], a[64:67], v[224:227]
    s_nop 0
    v_permlane16_swap_b32 v116, v117
    v_mfma_f32_16x16x32_bf16 v[176:179], a[136:139], v[80:83], 0
    buffer_load_dwordx4 v9, s[28:31], s92 offen offset:0 nt lds
    v_mfma_f32_16x16x32_bf16 v[136:139], a[104:107], v[64:67], 0
    v_max_f32 v116, v116, v117
    v_mul_f32 v116, s78, v116
    v_cvt_pk_bf16_f32 v32, v192, v196
    v_cvt_pk_bf16_f32 v33, v200, v204
    v_cvt_pk_bf16_f32 v76, v131, v135
    v_pk_fma_f32 v[96:97], v[96:97], s[78:79], v[116:117] op_sel_hi:[1,0,0] neg_lo:[0,0,1] neg_hi:[0,0,1]
    v_pk_fma_f32 v[98:99], v[98:99], s[78:79], v[116:117] op_sel_hi:[1,0,0] neg_lo:[0,0,1] neg_hi:[0,0,1]
    v_pk_fma_f32 v[104:105], v[104:105], s[78:79], v[116:117] op_sel_hi:[1,0,0] neg_lo:[0,0,1] neg_hi:[0,0,1]
    v_pk_fma_f32 v[100:101], v[100:101], s[78:79], v[116:117] op_sel_hi:[1,0,0] neg_lo:[0,0,1] neg_hi:[0,0,1]
    v_pk_fma_f32 v[106:107], v[106:107], s[78:79], v[116:117] op_sel_hi:[1,0,0] neg_lo:[0,0,1] neg_hi:[0,0,1]
    v_pk_fma_f32 v[110:111], v[110:111], s[78:79], v[116:117] op_sel_hi:[1,0,0] neg_lo:[0,0,1] neg_hi:[0,0,1]
    v_pk_fma_f32 v[108:109], v[108:109], s[78:79], v[116:117] op_sel_hi:[1,0,0] neg_lo:[0,0,1] neg_hi:[0,0,1]
    v_pk_fma_f32 v[102:103], v[102:103], s[78:79], v[116:117] op_sel_hi:[1,0,0] neg_lo:[0,0,1] neg_hi:[0,0,1]
    v_exp_f32_e64 v105, v105
    v_pk_fma_f32 v[114:115], v[114:115], s[78:79], v[116:117] op_sel_hi:[1,0,0] neg_lo:[0,0,1] neg_hi:[0,0,1]
    v_exp_f32 v114, v114
    v_exp_f32 v109, v109
    v_pk_fma_f32 v[112:113], v[112:113], s[78:79], v[116:117] op_sel_hi:[1,0,0] neg_lo:[0,0,1] neg_hi:[0,0,1]
    v_mfma_f32_16x16x32_bf16 v[144:147], a[148:151], v[76:79], v[144:147]
    v_exp_f32_e64 v113, v113
    v_mfma_f32_16x16x32_bf16 v[136:139], a[108:111], v[68:71], v[136:139]
    v_exp_f32_e64 v112, v112
    v_mfma_f32_16x16x32_bf16 v[136:139], a[112:115], v[72:75], v[136:139]
    v_exp_f32_e64 v111, v111
    v_mfma_f32_16x16x32_bf16 v[136:139], a[116:119], v[76:79], v[136:139]
    v_exp_f32_e64 v96, v96
    v_mfma_f32_16x16x32_bf16 v[128:131], a[72:75], v[64:67], 0
    v_exp_f32_e64 v98, v98
    v_mfma_f32_16x16x32_bf16 v[128:131], a[76:79], v[68:71], v[128:131]
    v_exp_f32_e64 v106, v106
    v_mfma_f32_16x16x32_bf16 v[128:131], a[80:83], v[72:75], v[128:131]
    v_exp_f32_e64 v99, v99
    v_mfma_f32_16x16x32_bf16 v[128:131], a[84:87], v[76:79], v[128:131]
    buffer_load_dwordx4 v9, s[28:31], s92 offen offset:1024 nt lds
    v_mfma_f32_16x16x32_bf16 v[228:231], v[36:39], a[64:67], v[228:231]
    s_add_u32 m0, s80, 82048
    v_cvt_pk_bf16_f32 v36, v193, v197
    v_cvt_pk_bf16_f32 v24, v112, v113
    v_mfma_f32_16x16x32_bf16 v[252:255], v[60:63], a[64:67], v[252:255]
    s_nop 0
    v_exp_f32 v110, v110
    v_mfma_f32_16x16x32_bf16 v[212:215], v[52:55], a[60:63], v[212:215]
    v_max3_f32 v148, v128, v129, v130
    v_max3_f32 v148, v148, v136, v137
L_pad4:
    s_cbranch_execz L_pad8
    v_mfma_f32_16x16x32_bf16 v[220:223], v[60:63], a[60:63], v[220:223]
    v_exp_f32 v97, v97
    v_mfma_f32_16x16x32_bf16 v[140:143], a[120:123], v[64:67], 0
    s_nop 0
    v_exp_f32 v103, v103
    v_mfma_f32_16x16x32_bf16 v[140:143], a[124:127], v[68:71], v[140:143]
    v_exp_f32_e64 v107, v107
    v_mfma_f32_16x16x32_bf16 v[140:143], a[128:131], v[72:75], v[140:143]
    v_exp_f32_e64 v104, v104
    v_mfma_f32_16x16x32_bf16 v[140:143], a[132:135], v[76:79], v[140:143]
    v_exp_f32_e64 v100, v100
    v_mfma_f32_16x16x32_bf16 v[248:251], v[56:59], a[64:67], v[248:251]
    v_exp_f32_e64 v101, v101
    v_mfma_f32_16x16x32_bf16 v[172:175], a[124:127], v[84:87], v[172:175]
    s_nop 0
    v_cvt_pk_bf16_f32 v34, v208, v212
    v_cvt_pk_bf16_f32 v16, v96, v97
    v_mfma_f32_16x16x32_bf16 v[172:175], a[128:131], v[88:91], v[172:175]
    s_nop 0
    v_max3_f32 v148, v148, v140, v141
    v_max3_f32 v148, v148, v144, v145
    v_mfma_f32_16x16x32_bf16 v[172:175], a[132:135], v[92:95], v[172:175]
    v_exp_f32_e64 v108, v108
    v_mfma_f32_16x16x32_bf16 v[132:135], a[88:91], v[64:67], 0
    v_exp_f32_e64 v102, v102
    v_mfma_f32_16x16x32_bf16 v[132:135], a[92:95], v[68:71], v[132:135]
    buffer_load_dwordx4 v9, s[28:31], s92 offen offset:2048 nt lds
    v_mfma_f32_16x16x32_bf16 v[132:135], a[96:99], v[72:75], v[132:135]
    v_cvt_pk_bf16_f32 v37, v201, v205
    v_cvt_pk_bf16_f32 v18, v100, v101
    v_mfma_f32_16x16x32_bf16 v[132:135], a[100:103], v[76:79], v[132:135]
    v_exp_f32_e64 v115, v115
    v_mfma_f32_16x16x32_bf16 v[244:247], v[52:55], a[64:67], v[244:247]
    v_cvt_pk_bf16_f32 v55, v249, v253
    v_cvt_pk_bf16_f32 v25, v114, v115
    v_mfma_f32_16x16x32_bf16 v[236:239], v[44:47], a[64:67], v[236:239]
    s_nop 0
    v_cvt_pk_bf16_f32 v45, v203, v207
    v_cvt_pk_bf16_f32 v46, v211, v215
    v_mfma_f32_16x16x32_bf16 v[232:235], v[40:43], a[64:67], v[232:235]
    v_max3_f32 v149, v131, v132, v133
    v_max3_f32 v149, v149, v134, v135
    v_mfma_f32_16x16x32_bf16 v[240:243], v[48:51], a[64:67], v[240:243]
    v_max3_f32 v149, v149, v138, v139
    v_max3_f32 v149, v149, v142, v143
    v_mfma_f32_16x16x32_bf16 v[216:219], v[56:59], a[60:63], v[216:219]
    s_nop 0
    v_max3_f32 v149, v149, v146, v147
    v_max_f32_e64 v148, v148, v149
    v_mfma_f32_16x16x32_bf16 v[176:179], a[140:143], v[84:87], v[176:179]
    s_nop 0
    v_mov_b32 v149, v148
    v_cvt_pk_bf16_f32 v56, v226, v230
    v_mfma_f32_16x16x32_bf16 v[176:179], a[144:147], v[88:91], v[176:179]
    v_permlane32_swap_b32 v148, v149
    v_mfma_f32_16x16x32_bf16 v[176:179], a[148:151], v[92:95], v[176:179]
    v_max_f32 v148, v148, v149
    v_mov_b32_e64 v149, v148
    v_mfma_f32_16x16x32_bf16 v[168:171], a[108:111], v[84:87], v[168:171]
    s_waitcnt vmcnt(12)
    ds_read_b64_tr_b16 a[174:175], v13 offset:128
    v_cvt_pk_bf16_f32 v47, v219, v223
    v_mfma_f32_16x16x32_bf16 v[168:171], a[112:115], v[88:91], v[168:171]
    ds_read_b64_tr_b16 a[170:171], v11 offset:128
    v_cvt_pk_bf16_f32 v57, v234, v238
    v_mfma_f32_16x16x32_bf16 v[168:171], a[116:119], v[92:95], v[168:171]
    buffer_load_dwordx4 v9, s[28:31], s92 offen offset:3072 nt lds
    v_mfma_f32_16x16x32_bf16 v[164:167], a[88:91], v[80:83], 0
    s_add_u32 m0, s91, 0
    ds_read_b64_tr_b16 a[158:159], v13 offset:0
    s_add_u32 s92, s90, 0
    v_mfma_f32_16x16x32_bf16 v[160:163], a[72:75], v[80:83], 0
    ds_read_b64_tr_b16 a[154:155], v11 offset:0
    v_cvt_pk_bf16_f32 v35, v216, v220
    v_mfma_f32_16x16x32_bf16 v[160:163], a[76:79], v[84:87], v[160:163]
    v_permlane16_swap_b32 v148, v149
    v_mfma_f32_16x16x32_bf16 v[164:167], a[92:95], v[84:87], v[164:167]
    v_max_f32 v148, v148, v149
    v_mul_f32 v148, s78, v148
    v_cvt_pk_bf16_f32 v41, v202, v206
    v_xor_b32_e64 v13, 64, v11
    v_cvt_pk_bf16_f32 v48, v224, v228
    v_pk_fma_f32 v[130:131], v[130:131], s[78:79], v[148:149] op_sel_hi:[1,0,0] neg_lo:[0,0,1] neg_hi:[0,0,1]
    v_pk_fma_f32 v[132:133], v[132:133], s[78:79], v[148:149] op_sel_hi:[1,0,0] neg_lo:[0,0,1] neg_hi:[0,0,1]
    v_exp_f32_e64 v133, v133
    v_pk_fma_f32 v[140:141], v[140:141], s[78:79], v[148:149] op_sel_hi:[1,0,0] neg_lo:[0,0,1] neg_hi:[0,0,1]
    v_exp_f32_e64 v132, v132
    v_pk_fma_f32 v[134:135], v[134:135], s[78:79], v[148:149] op_sel_hi:[1,0,0] neg_lo:[0,0,1] neg_hi:[0,0,1]
    v_pk_fma_f32 v[142:143], v[142:143], s[78:79], v[148:149] op_sel_hi:[1,0,0] neg_lo:[0,0,1] neg_hi:[0,0,1]
    v_exp_f32_e64 v131, v131
    v_pk_fma_f32 v[128:129], v[128:129], s[78:79], v[148:149] op_sel_hi:[1,0,0] neg_lo:[0,0,1] neg_hi:[0,0,1]
    v_exp_f32_e64 v142, v142
    v_pk_fma_f32 v[146:147], v[146:147], s[78:79], v[148:149] op_sel_hi:[1,0,0] neg_lo:[0,0,1] neg_hi:[0,0,1]
    v_exp_f32 v146, v146
    v_exp_f32 v143, v143
    v_pk_fma_f32 v[136:137], v[136:137], s[78:79], v[148:149] op_sel_hi:[1,0,0] neg_lo:[0,0,1] neg_hi:[0,0,1]
    v_exp_f32_e64 v141, v141
    v_pk_fma_f32 v[144:145], v[144:145], s[78:79], v[148:149] op_sel_hi:[1,0,0] neg_lo:[0,0,1] neg_hi:[0,0,1]
    v_exp_f32 v140, v140
    v_exp_f32 v135, v135
    v_exp_f32 v137, v137
    v_exp_f32 v136, v136
    v_exp_f32 v144, v144
    v_exp_f32 v145, v145
    v_exp_f32 v147, v147
    v_exp_f32 v130, v130
    v_exp_f32_e64 v134, v134
    v_pk_fma_f32 v[138:139], v[138:139], s[78:79], v[148:149] op_sel_hi:[1,0,0] neg_lo:[0,0,1] neg_hi:[0,0,1]
    v_mfma_f32_16x16x32_bf16 v[200:203], a[104:107], v[32:35], 0
    ds_read_b64_tr_b16 a[178:179], v13 offset:128
    v_cvt_pk_bf16_f32 v70, v140, v141
    v_mfma_f32_16x16x32_bf16 v[204:207], a[120:123], v[32:35], 0
    ds_read_b64_tr_b16 a[162:163], v13 offset:0
    v_cvt_pk_bf16_f32 v68, v136, v137
    v_mfma_f32_16x16x32_bf16 v[164:167], a[96:99], v[88:91], v[164:167]
    v_exp_f32_e64 v138, v138
    v_mfma_f32_16x16x32_bf16 v[164:167], a[100:103], v[92:95], v[164:167]
    v_exp_f32_e64 v129, v129
    v_mfma_f32_16x16x32_bf16 v[160:163], a[80:83], v[88:91], v[160:163]
    v_exp_f32_e64 v139, v139
    v_mfma_f32_16x16x32_bf16 v[160:163], a[84:87], v[92:95], v[160:163]
    v_exp_f32_e64 v128, v128
    v_xor_b32 v13, 96, v11
    v_cvt_pk_bf16_f32 v64, v128, v129
    v_cvt_pk_bf16_f32 v69, v138, v139
    v_cvt_pk_bf16_f32 v71, v142, v143
    v_cvt_pk_bf16_f32 v73, v146, v147
    v_cvt_pk_bf16_f32 v72, v144, v145
    v_cvt_pk_bf16_f32 v65, v130, v131
    v_max3_f32 v180, v160, v161, v162
    v_cvt_pk_bf16_f32 v40, v194, v198
    v_cvt_pk_bf16_f32 v66, v132, v133
    v_cvt_pk_bf16_f32 v67, v134, v135
    v_cvt_pk_bf16_f32 v42, v210, v214
    v_cvt_pk_bf16_f32 v49, v232, v236
    s_waitcnt lgkmcnt(2)
    v_mfma_f32_16x16x32_bf16 v[128:131], a[152:155], v[64:67], 0
    ds_read_b64_tr_b16 a[182:183], v13 offset:128
    v_cvt_pk_bf16_f32 v50, v240, v244
    v_mfma_f32_16x16x32_bf16 v[76:79], a[232:235], v[64:67], 0
    ds_read_b64_tr_b16 a[166:167], v13 offset:0
    v_xor_b32 v13, 32, v11
    v_mfma_f32_16x16x32_bf16 v[132:135], a[156:159], v[64:67], 0
    v_cvt_pk_bf16_f32 v51, v248, v252
    v_cvt_pk_bf16_f32 v39, v217, v221
    s_waitcnt lgkmcnt(3)
    v_mfma_f32_16x16x32_bf16 v[152:155], a[176:179], v[64:67], 0
    v_max3_f32 v180, v180, v168, v169
    v_max3_f32 v180, v180, v172, v173
    v_mfma_f32_16x16x32_bf16 v[144:147], a[168:171], v[64:67], 0
    v_max3_f32 v180, v180, v176, v177
    v_cvt_pk_bf16_f32 v43, v218, v222
    s_waitcnt lgkmcnt(2)
    v_mfma_f32_16x16x32_bf16 v[136:139], a[160:163], v[64:67], 0
    v_cvt_pk_bf16_f32 v52, v225, v229
    v_cvt_pk_bf16_f32 v54, v241, v245
    v_mfma_f32_16x16x32_bf16 v[76:79], a[232:235], v[68:71], v[76:79]
    v_cvt_pk_bf16_f32 v44, v195, v199
    v_max3_f32 v181, v163, v164, v165
    v_mfma_f32_16x16x32_bf16 v[196:199], a[88:91], v[32:35], 0
    v_cvt_pk_bf16_f32 v58, v242, v246
    v_cvt_pk_bf16_f32 v38, v209, v213
    v_mfma_f32_16x16x32_bf16 v[208:211], a[136:139], v[32:35], 0
    s_nop 0
    v_cvt_pk_bf16_f32 v53, v233, v237
    v_cvt_pk_bf16_f32 v63, v251, v255
    v_mfma_f32_16x16x32_bf16 v[200:203], a[108:111], v[36:39], v[200:203]
    v_cvt_pk_bf16_f32 v19, v102, v103
    v_cvt_pk_bf16_f32 v21, v106, v107
    v_mfma_f32_16x16x32_bf16 v[200:203], a[112:115], v[40:43], v[200:203]
    buffer_load_dwordx4 v1, s[32:35], s92 offen offset:0  lds
    v_mfma_f32_16x16x32_bf16 v[200:203], a[116:119], v[44:47], v[200:203]
    v_cvt_pk_bf16_f32 v17, v98, v99
    v_cvt_pk_bf16_f32 v61, v235, v239
    v_mfma_f32_16x16x32_bf16 v[196:199], a[92:95], v[36:39], v[196:199]
    v_cvt_pk_bf16_f32 v22, v108, v109
    v_cvt_pk_bf16_f32 v59, v250, v254
    v_mfma_f32_16x16x32_bf16 v[196:199], a[96:99], v[40:43], v[196:199]
    v_max3_f32 v181, v181, v166, v167
    v_max3_f32 v181, v181, v170, v171
    v_mfma_f32_16x16x32_bf16 v[196:199], a[100:103], v[44:47], v[196:199]
    v_max3_f32 v181, v181, v174, v175
    v_max3_f32 v181, v181, v178, v179
    v_mfma_f32_16x16x32_bf16 v[116:119], a[172:175], v[16:19], 0
    v_max_f32 v180, v180, v181
    v_mov_b32_e64 v181, v180
    v_mfma_f32_16x16x32_bf16 v[100:103], a[156:159], v[16:19], 0
    s_nop 0
    v_permlane32_swap_b32 v180, v181
    v_mfma_f32_16x16x32_bf16 v[28:31], a[232:235], v[16:19], 0
    v_max_f32 v180, v180, v181
    v_mov_b32 v181, v180
    v_mfma_f32_16x16x32_bf16 v[204:207], a[124:127], v[36:39], v[204:207]
    s_nop 0
    v_permlane16_swap_b32 v180, v181
    v_mfma_f32_16x16x32_bf16 v[204:207], a[128:131], v[40:43], v[204:207]
    v_max_f32 v180, v180, v181
    v_mul_f32 v180, s78, v180
    v_cvt_pk_bf16_f32 v60, v227, v231
    v_cvt_pk_bf16_f32 v62, v243, v247
    v_cvt_pk_bf16_f32 v23, v110, v111
    v_pk_fma_f32 v[178:179], v[178:179], s[78:79], v[180:181] op_sel_hi:[1,0,0] neg_lo:[0,0,1] neg_hi:[0,0,1]
    v_pk_fma_f32 v[176:177], v[176:177], s[78:79], v[180:181] op_sel_hi:[1,0,0] neg_lo:[0,0,1] neg_hi:[0,0,1]
    v_pk_fma_f32 v[174:175], v[174:175], s[78:79], v[180:181] op_sel_hi:[1,0,0] neg_lo:[0,0,1] neg_hi:[0,0,1]
    v_pk_fma_f32 v[164:165], v[164:165], s[78:79], v[180:181] op_sel_hi:[1,0,0] neg_lo:[0,0,1] neg_hi:[0,0,1]
    v_pk_fma_f32 v[170:171], v[170:171], s[78:79], v[180:181] op_sel_hi:[1,0,0] neg_lo:[0,0,1] neg_hi:[0,0,1]
    v_pk_fma_f32 v[162:163], v[162:163], s[78:79], v[180:181] op_sel_hi:[1,0,0] neg_lo:[0,0,1] neg_hi:[0,0,1]
    v_pk_fma_f32 v[172:173], v[172:173], s[78:79], v[180:181] op_sel_hi:[1,0,0] neg_lo:[0,0,1] neg_hi:[0,0,1]
    v_pk_fma_f32 v[160:161], v[160:161], s[78:79], v[180:181] op_sel_hi:[1,0,0] neg_lo:[0,0,1] neg_hi:[0,0,1]
    v_exp_f32_e64 v160, v160
    v_pk_fma_f32 v[166:167], v[166:167], s[78:79], v[180:181] op_sel_hi:[1,0,0] neg_lo:[0,0,1] neg_hi:[0,0,1]
    v_pk_fma_f32 v[168:169], v[168:169], s[78:79], v[180:181] op_sel_hi:[1,0,0] neg_lo:[0,0,1] neg_hi:[0,0,1]
    v_mfma_f32_16x16x32_bf16 v[204:207], a[132:135], v[44:47], v[204:207]
    buffer_load_dwordx4 v2, s[32:35], s92 offen offset:1024  lds
    s_waitcnt lgkmcnt(0)
    v_mfma_f32_16x16x32_bf16 v[108:111], a[164:167], v[16:19], 0
    v_exp_f32 v161, v161
    v_mfma_f32_16x16x32_bf16 v[96:99], a[152:155], v[16:19], 0
    v_exp_f32_e64 v162, v162
    v_mfma_f32_16x16x32_bf16 v[112:115], a[168:171], v[16:19], 0
    v_cvt_pk_bf16_f32 v80, v160, v161
    v_cvt_pk_bf16_f32 v20, v104, v105
    v_mfma_f32_16x16x32_bf16 v[104:107], a[160:163], v[16:19], 0
    s_nop 0
    v_exp_f32 v179, v179
    v_mfma_f32_16x16x32_bf16 v[28:31], a[232:235], v[20:23], v[28:31]
    v_exp_f32_e64 v165, v165
    v_mfma_f32_16x16x32_bf16 v[240:243], a[136:139], v[48:51], 0
    v_exp_f32_e64 v177, v177
    v_mfma_f32_16x16x32_bf16 v[240:243], a[140:143], v[52:55], v[240:243]
    s_nop 0
    v_exp_f32 v171, v171
    v_mfma_f32_16x16x16_bf16 v[28:31], a[232:233], v[24:25], v[28:31]
    v_exp_f32_e64 v164, v164
    v_mfma_f32_16x16x32_bf16 v[208:211], a[140:143], v[36:39], v[208:211]
    buffer_load_dwordx4 v3, s[32:35], s92 offen offset:2048  lds
    v_mfma_f32_16x16x32_bf16 v[208:211], a[144:147], v[40:43], v[208:211]
    s_nop 0
    v_cvt_pk_bf16_f32 v82, v164, v165
    v_exp_f32 v166, v166
    v_mfma_f32_16x16x32_bf16 v[208:211], a[148:151], v[44:47], v[208:211]
    v_rcp_f32_e64 v28, v28
    v_mfma_f32_16x16x32_bf16 v[120:123], a[176:179], v[16:19], 0
    v_exp_f32_e64 v170, v170
    v_mfma_f32_16x16x16_bf16 v[76:79], a[232:233], v[72:73], v[76:79]
    v_cvt_pk_bf16_f32 v85, v170, v171
    v_exp_f32_e64 v167, v167
    v_mfma_f32_16x16x32_bf16 v[124:127], a[180:183], v[16:19], 0
    v_cvt_pk_bf16_f32 v83, v166, v167
    v_exp_f32_e64 v168, v168
    v_mfma_f32_16x16x32_bf16 v[240:243], a[144:147], v[56:59], v[240:243]
    s_nop 0
    v_exp_f32 v169, v169
    v_mfma_f32_16x16x32_bf16 v[192:195], a[72:75], v[32:35], 0
    v_cvt_pk_bf16_f32 v84, v168, v169
    v_rcp_f32_e64 v76, v76
    v_mfma_f32_16x16x32_bf16 v[192:195], a[76:79], v[36:39], v[192:195]
    v_exp_f32_e64 v163, v163
    v_mfma_f32_16x16x32_bf16 v[192:195], a[80:83], v[40:43], v[192:195]
    v_cvt_pk_bf16_f32 v81, v162, v163
    v_exp_f32_e64 v175, v175
    v_mfma_f32_16x16x32_bf16 v[192:195], a[84:87], v[44:47], v[192:195]
    buffer_load_dwordx4 v4, s[32:35], s92 offen offset:3072  lds
    v_mfma_f32_16x16x32_bf16 v[180:183], a[172:175], v[80:83], 0
    s_add_u32 m0, s91, 16384
    s_add_u32 s92, s90, 1310720
    v_exp_f32_e64 v172, v172
    v_mfma_f32_16x16x32_bf16 v[184:187], a[176:179], v[80:83], 0
    s_nop 0
    v_exp_f32 v176, v176
    v_mfma_f32_16x16x32_bf16 v[188:191], a[180:183], v[80:83], 0
    s_waitcnt vmcnt(13)
    ds_read_b64_tr_b16 a[188:189], v13 offset:4224
    v_max3_f32 v213, v195, v196, v197
    v_mfma_f32_16x16x32_bf16 v[160:163], a[152:155], v[80:83], 0
    ds_read_b64_tr_b16 a[204:205], v13 offset:4352
    v_max3_f32 v213, v213, v198, v199
    v_mfma_f32_16x16x32_bf16 v[164:167], a[156:159], v[80:83], 0
    ds_read_b64_tr_b16 a[200:201], v11 offset:4352
    v_max3_f32 v213, v213, v202, v203
    v_mfma_f32_16x16x32_bf16 v[236:239], a[120:123], v[48:51], 0
    ds_read_b64_tr_b16 a[184:185], v11 offset:4224
    v_max3_f32 v213, v213, v206, v207
    v_mfma_f32_16x16x32_bf16 v[236:239], a[124:127], v[52:55], v[236:239]
    v_max3_f32 v213, v213, v210, v211
    v_max3_f32 v212, v192, v193, v194
    v_mfma_f32_16x16x32_bf16 v[236:239], a[128:131], v[56:59], v[236:239]
    v_max3_f32 v212, v212, v200, v201
    v_max3_f32 v212, v212, v204, v205
    v_mfma_f32_16x16x32_bf16 v[168:171], a[160:163], v[80:83], 0
    v_max3_f32 v212, v212, v208, v209
    v_max_f32 v212, v212, v213
    v_mfma_f32_16x16x32_bf16 v[224:227], a[72:75], v[48:51], 0
    v_mov_b32 v213, v212
    v_xor_b32 v13, 64, v11
    v_mfma_f32_16x16x32_bf16 v[224:227], a[76:79], v[52:55], v[224:227]
    buffer_load_dwordx4 v1, s[32:35], s92 offen offset:0  lds
    v_mfma_f32_16x16x32_bf16 v[224:227], a[80:83], v[56:59], v[224:227]
    ds_read_b64_tr_b16 a[192:193], v13 offset:4224
    v_cvt_pk_bf16_f32 v88, v176, v177
    v_mfma_f32_16x16x32_bf16 v[224:227], a[84:87], v[60:63], v[224:227]
    ds_read_b64_tr_b16 a[208:209], v13 offset:4352
    v_xor_b32 v13, 96, v11
    v_mfma_f32_16x16x32_bf16 v[228:231], a[88:91], v[48:51], 0
    ds_read_b64_tr_b16 a[196:197], v13 offset:4224
    v_permlane32_swap_b32 v212, v213
    v_mfma_f32_16x16x32_bf16 v[228:231], a[92:95], v[52:55], v[228:231]
    s_nop 0
    ds_read_b64_tr_b16 a[212:213], v13 offset:4352
    v_max_f32_e64 v212, v212, v213
    v_mfma_f32_16x16x32_bf16 v[228:231], a[96:99], v[56:59], v[228:231]
    v_mov_b32 v213, v212
    v_xor_b32 v13, 32, v11
    v_mfma_f32_16x16x32_bf16 v[140:143], a[164:167], v[64:67], 0
    v_permlane16_swap_b32 v212, v213
    v_mfma_f32_16x16x32_bf16 v[92:95], a[232:235], v[80:83], 0
    v_max_f32 v212, v212, v213
    v_mul_f32 v212, s78, v212
    v_exp_f32 v178, v178
    v_max3_f32 v244, v224, v225, v226
    v_pk_fma_f32 v[194:195], v[194:195], s[78:79], v[212:213] op_sel_hi:[1,0,0] neg_lo:[0,0,1] neg_hi:[0,0,1]
    v_pk_fma_f32 v[202:203], v[202:203], s[78:79], v[212:213] op_sel_hi:[1,0,0] neg_lo:[0,0,1] neg_hi:[0,0,1]
    v_pk_fma_f32 v[196:197], v[196:197], s[78:79], v[212:213] op_sel_hi:[1,0,0] neg_lo:[0,0,1] neg_hi:[0,0,1]
    v_exp_f32_e64 v202, v202
    v_pk_fma_f32 v[204:205], v[204:205], s[78:79], v[212:213] op_sel_hi:[1,0,0] neg_lo:[0,0,1] neg_hi:[0,0,1]
    v_pk_fma_f32 v[198:199], v[198:199], s[78:79], v[212:213] op_sel_hi:[1,0,0] neg_lo:[0,0,1] neg_hi:[0,0,1]
    v_exp_f32_e64 v199, v199
    v_pk_fma_f32 v[206:207], v[206:207], s[78:79], v[212:213] op_sel_hi:[1,0,0] neg_lo:[0,0,1] neg_hi:[0,0,1]
    v_pk_fma_f32 v[200:201], v[200:201], s[78:79], v[212:213] op_sel_hi:[1,0,0] neg_lo:[0,0,1] neg_hi:[0,0,1]
    v_exp_f32 v200, v200
    v_exp_f32 v198, v198
    v_pk_fma_f32 v[192:193], v[192:193], s[78:79], v[212:213] op_sel_hi:[1,0,0] neg_lo:[0,0,1] neg_hi:[0,0,1]
    v_exp_f32_e64 v201, v201
    v_pk_fma_f32 v[208:209], v[208:209], s[78:79], v[212:213] op_sel_hi:[1,0,0] neg_lo:[0,0,1] neg_hi:[0,0,1]
    v_pk_fma_f32 v[210:211], v[210:211], s[78:79], v[212:213] op_sel_hi:[1,0,0] neg_lo:[0,0,1] neg_hi:[0,0,1]
    v_mfma_f32_16x16x32_bf16 v[156:159], a[180:183], v[64:67], 0
    s_waitcnt vmcnt(9)
    ds_read_b64_tr_b16 a[190:191], v13 offset:8448
    buffer_load_dwordx4 v2, s[32:35], s92 offen offset:1024  lds
    v_mfma_f32_16x16x32_bf16 v[240:243], a[148:151], v[60:63], v[240:243]
    ds_read_b64_tr_b16 a[206:207], v13 offset:8576
    v_xor_b32 v13, 64, v11
    v_mfma_f32_16x16x32_bf16 v[236:239], a[132:135], v[60:63], v[236:239]
    ds_read_b64_tr_b16 a[194:195], v13 offset:8448
    v_cvt_pk_bf16_f32 v89, v178, v179
    v_mfma_f32_16x16x32_bf16 v[176:179], a[168:171], v[80:83], 0
    ds_read_b64_tr_b16 a[210:211], v13 offset:8576
    v_xor_b32 v13, 96, v11
    v_mfma_f32_16x16x32_bf16 v[228:231], a[100:103], v[60:63], v[228:231]
    ds_read_b64_tr_b16 a[198:199], v13 offset:8448
    v_cvt_pk_bf16_f32 v35, v198, v199
    v_mfma_f32_16x16x32_bf16 v[148:151], a[172:175], v[64:67], 0
    ds_read_b64_tr_b16 a[214:215], v13 offset:8576
    v_xor_b32_e64 v13, 32, v12
    v_mfma_f32_16x16x32_bf16 v[232:235], a[104:107], v[48:51], 0
    s_nop 0
    ds_read_b64_tr_b16 a[202:203], v11 offset:8576
    v_exp_f32 v193, v193
    v_mfma_f32_16x16x32_bf16 v[232:235], a[108:111], v[52:55], v[232:235]
    ds_read_b64_tr_b16 a[186:187], v11 offset:8448
    buffer_load_dwordx4 v3, s[32:35], s92 offen offset:2048  lds
    s_waitcnt lgkmcnt(7)
    v_mfma_f32_16x16x32_bf16 v[100:103], a[188:191], v[20:23], v[100:103]
    v_exp_f32_e64 v204, v204
    s_waitcnt lgkmcnt(6)
    v_mfma_f32_16x16x32_bf16 v[116:119], a[204:207], v[20:23], v[116:119]
    v_exp_f32 v196, v196
    s_waitcnt lgkmcnt(5)
    v_mfma_f32_16x16x32_bf16 v[104:107], a[192:195], v[20:23], v[104:107]
    v_exp_f32 v206, v206
    s_waitcnt lgkmcnt(4)
    v_mfma_f32_16x16x32_bf16 v[152:155], a[208:211], v[68:71], v[152:155]
    v_exp_f32 v208, v208
    s_waitcnt lgkmcnt(3)
    v_mfma_f32_16x16x32_bf16 v[108:111], a[196:199], v[20:23], v[108:111]
    v_exp_f32 v203, v203
    s_waitcnt lgkmcnt(2)
    v_mfma_f32_16x16x32_bf16 v[124:127], a[212:215], v[20:23], v[124:127]
    v_exp_f32_e64 v195, v195
    v_mfma_f32_16x16x32_bf16 v[156:159], a[212:215], v[68:71], v[156:159]
    v_exp_f32 v209, v209
    s_waitcnt lgkmcnt(0)
    v_mfma_f32_16x16x32_bf16 v[96:99], a[184:187], v[20:23], v[96:99]
    v_exp_f32_e64 v192, v192
    v_mfma_f32_16x16x32_bf16 v[112:115], a[200:203], v[20:23], v[112:115]
    v_exp_f32_e64 v194, v194
    v_mfma_f32_16x16x32_bf16 v[144:147], a[200:203], v[68:71], v[144:147]
    v_exp_f32_e64 v205, v205
    v_mfma_f32_16x16x32_bf16 v[148:151], a[204:207], v[68:71], v[148:151]
    v_exp_f32_e64 v207, v207
    v_mfma_f32_16x16x32_bf16 v[120:123], a[208:211], v[20:23], v[120:123]
    buffer_load_dwordx4 v4, s[32:35], s92 offen offset:3072  lds
    v_mfma_f32_16x16x32_bf16 v[232:235], a[112:115], v[56:59], v[232:235]
    s_add_u32 m0, s91, 32768
    v_exp_f32_e64 v210, v210
    v_mfma_f32_16x16x32_bf16 v[128:131], a[184:187], v[68:71], v[128:131]
    s_add_u32 s92, s90, 2621440
    v_exp_f32_e64 v211, v211
    v_mfma_f32_16x16x32_bf16 v[232:235], a[116:119], v[60:63], v[232:235]
    v_exp_f32_e64 v197, v197
    v_mfma_f32_16x16x32_bf16 v[140:143], a[196:199], v[68:71], v[140:143]
    v_cvt_pk_bf16_f32 v40, v208, v209
    v_cvt_pk_bf16_f32 v32, v192, v193
    v_mfma_f32_16x16x32_bf16 v[132:135], a[188:191], v[68:71], v[132:135]
    s_nop 0
    v_cvt_pk_bf16_f32 v38, v204, v205
    v_cvt_pk_bf16_f32 v33, v194, v195
    v_mfma_f32_16x16x32_bf16 v[136:139], a[192:195], v[68:71], v[136:139]
    v_cvt_pk_bf16_f32 v39, v206, v207
    v_cvt_pk_bf16_f32 v41, v210, v211
    v_cvt_pk_bf16_f32 v37, v202, v203
    v_cvt_pk_bf16_f32 v36, v200, v201
    v_cvt_pk_bf16_f32 v34, v196, v197
    v_max3_f32 v244, v244, v232, v233
    v_max3_f32 v245, v227, v228, v229
    v_mfma_f32_16x16x32_bf16 v[200:203], a[160:163], v[32:35], 0
    v_max3_f32 v245, v245, v230, v231
    v_max3_f32 v245, v245, v234, v235
    v_mfma_f32_16x16x32_bf16 v[212:215], a[172:175], v[32:35], 0
    v_max3_f32 v245, v245, v238, v239
    v_max3_f32 v245, v245, v242, v243
    v_mfma_f32_16x16x32_bf16 v[212:215], a[204:207], v[36:39], v[212:215]
    v_exp_f32 v174, v174
    v_mfma_f32_16x16x32_bf16 v[200:203], a[192:195], v[36:39], v[200:203]
    buffer_load_dwordx4 v1, s[32:35], s92 offen offset:0  lds
    v_mfma_f32_16x16x32_bf16 v[204:207], a[164:167], v[32:35], 0
    v_cvt_pk_bf16_f32 v87, v174, v175
    v_max3_f32 v244, v244, v236, v237
    v_mfma_f32_16x16x32_bf16 v[208:211], a[168:171], v[32:35], 0
    v_max3_f32 v244, v244, v240, v241
    v_max_f32_e64 v244, v244, v245
    v_mfma_f32_16x16x32_bf16 v[208:211], a[200:203], v[36:39], v[208:211]
    v_mov_b32 v245, v244
    v_exp_f32 v173, v173
    v_mfma_f32_16x16x32_bf16 v[220:223], a[180:183], v[32:35], 0
    v_cvt_pk_bf16_f32 v86, v172, v173
    v_permlane32_swap_b32 v244, v245
    v_mfma_f32_16x16x32_bf16 v[172:175], a[164:167], v[80:83], 0
    v_max_f32 v244, v244, v245
    v_mov_b32_e64 v245, v244
    v_mfma_f32_16x16x32_bf16 v[176:179], a[200:203], v[84:87], v[176:179]
    s_waitcnt vmcnt(9)
    ds_read_b64_tr_b16 a[226:227], v13 offset:128
    v_permlane16_swap_b32 v244, v245
    v_mfma_f32_16x16x32_bf16 v[172:175], a[196:199], v[84:87], v[172:175]
    ds_read_b64_tr_b16 a[216:217], v12 offset:0
    v_max_f32_e64 v244, v244, v245
    v_mfma_f32_16x16x32_bf16 v[164:167], a[188:191], v[84:87], v[164:167]
    ds_read_b64_tr_b16 a[218:219], v13 offset:0
    v_xor_b32_e64 v13, 64, v12
    v_mfma_f32_16x16x32_bf16 v[220:223], a[212:215], v[36:39], v[220:223]
    ds_read_b64_tr_b16 a[224:225], v12 offset:128
    v_mul_f32_e64 v244, s78, v244
    v_fma_f32 v224, v224, s78, -v244
    v_fma_f32 v225, v225, s78, -v244
    v_exp_f32_e64 v225, v225
    v_pk_fma_f32 v[242:243], v[242:243], s[78:79], v[244:245] op_sel_hi:[1,0,0] neg_lo:[0,0,1] neg_hi:[0,0,1]
    v_pk_fma_f32 v[238:239], v[238:239], s[78:79], v[244:245] op_sel_hi:[1,0,0] neg_lo:[0,0,1] neg_hi:[0,0,1]
    v_pk_fma_f32 v[236:237], v[236:237], s[78:79], v[244:245] op_sel_hi:[1,0,0] neg_lo:[0,0,1] neg_hi:[0,0,1]
    v_pk_fma_f32 v[240:241], v[240:241], s[78:79], v[244:245] op_sel_hi:[1,0,0] neg_lo:[0,0,1] neg_hi:[0,0,1]
    v_exp_f32_e64 v224, v224
    v_pk_fma_f32 v[228:229], v[228:229], s[78:79], v[244:245] op_sel_hi:[1,0,0] neg_lo:[0,0,1] neg_hi:[0,0,1]
    v_pk_fma_f32 v[226:227], v[226:227], s[78:79], v[244:245] op_sel_hi:[1,0,0] neg_lo:[0,0,1] neg_hi:[0,0,1]
    v_pk_fma_f32 v[234:235], v[234:235], s[78:79], v[244:245] op_sel_hi:[1,0,0] neg_lo:[0,0,1] neg_hi:[0,0,1]
    v_pk_fma_f32 v[232:233], v[232:233], s[78:79], v[244:245] op_sel_hi:[1,0,0] neg_lo:[0,0,1] neg_hi:[0,0,1]
    v_exp_f32_e64 v234, v234
    v_pk_fma_f32 v[230:231], v[230:231], s[78:79], v[244:245] op_sel_hi:[1,0,0] neg_lo:[0,0,1] neg_hi:[0,0,1]
    s_waitcnt lgkmcnt(3)
    v_mfma_f32_16x16x16_bf16 v[148:151], a[226:227], v[72:73], v[148:151]
    buffer_load_dwordx4 v2, s[32:35], s92 offen offset:1024  lds
    s_waitcnt lgkmcnt(2)
    v_mfma_f32_16x16x16_bf16 v[96:99], a[216:217], v[24:25], v[96:99]
    ds_read_b64_tr_b16 a[220:221], v13 offset:0
    v_cvt_pk_bf16_f32 v48, v224, v225
    s_waitcnt lgkmcnt(2)
    v_mfma_f32_16x16x16_bf16 v[100:103], a[218:219], v[24:25], v[100:103]
    s_nop 0
    ds_read_b64_tr_b16 a[228:229], v13 offset:128
    v_xor_b32 v13, 96, v12
    s_waitcnt lgkmcnt(2)
    v_mfma_f32_16x16x16_bf16 v[144:147], a[224:225], v[72:73], v[144:147]
    s_nop 0
    ds_read_b64_tr_b16 a[222:223], v13 offset:0
    v_exp_f32_e64 v235, v235
    v_mfma_f32_16x16x16_bf16 v[112:115], a[224:225], v[24:25], v[112:115]
    ds_read_b64_tr_b16 a[230:231], v13 offset:128
    v_cvt_pk_bf16_f32 v53, v234, v235
    v_exp_f32 v238, v238
    v_exp_f32 v227, v227
    v_pk_mul_f32 v[96:97], v[96:97], v[28:29] op_sel_hi:[1,0]
    v_pk_mul_f32 v[100:101], v[100:101], v[28:29] op_sel_hi:[1,0]
    v_pk_mul_f32 v[148:149], v[148:149], v[76:77] op_sel_hi:[1,0]
    v_pk_mul_f32 v[98:99], v[98:99], v[28:29] op_sel_hi:[1,0]
    v_pk_mul_f32 v[114:115], v[114:115], v[28:29] op_sel_hi:[1,0]
    v_pk_mul_f32 v[112:113], v[112:113], v[28:29] op_sel_hi:[1,0]
    v_cvt_pk_bf16_f32 v112, v112, v113
    v_cvt_pk_bf16_f32 v113, v114, v115
    v_pk_mul_f32 v[146:147], v[146:147], v[76:77] op_sel_hi:[1,0]
    v_cvt_pk_bf16_f32 v96, v96, v97
    v_pk_mul_f32 v[144:145], v[144:145], v[76:77] op_sel_hi:[1,0]
    v_pk_mul_f32 v[150:151], v[150:151], v[76:77] op_sel_hi:[1,0]
    v_pk_mul_f32 v[102:103], v[102:103], v[28:29] op_sel_hi:[1,0]
    s_waitcnt lgkmcnt(3)
    v_mfma_f32_16x16x16_bf16 v[104:107], a[220:221], v[24:25], v[104:107]
    buffer_load_dwordx4 v3, s[32:35], s92 offen offset:2048  lds
    s_waitcnt lgkmcnt(2)
    v_mfma_f32_16x16x16_bf16 v[152:155], a[228:229], v[72:73], v[152:155]
    s_waitcnt lgkmcnt(0)
    s_barrier
    v_mfma_f32_16x16x16_bf16 v[120:123], a[228:229], v[24:25], v[120:123]
    s_nop 0
    v_add_u32 v11, 122880, v7
    v_add_u32 v9, 81920, v14
    v_mfma_f32_16x16x16_bf16 v[156:159], a[230:231], v[72:73], v[156:159]
    s_nop 0
    v_add_u32 v10, 122880, v14
    v_add_u32 v8, 0x10000, v7
    v_mfma_f32_16x16x16_bf16 v[108:111], a[222:223], v[24:25], v[108:111]
    v_cvt_pk_bf16_f32 v97, v98, v99
    v_cvt_pk_bf16_f32 v98, v100, v101
    v_cvt_pk_bf16_f32 v99, v102, v103
    v_exp_f32_e64 v232, v232
    v_pk_mul_f32 v[158:159], v[158:159], v[76:77] op_sel_hi:[1,0]
    v_pk_mul_f32 v[154:155], v[154:155], v[76:77] op_sel_hi:[1,0]
    v_pk_mul_f32 v[120:121], v[120:121], v[28:29] op_sel_hi:[1,0]
    v_cvt_pk_bf16_f32 v120, v120, v121
    v_pk_mul_f32 v[110:111], v[110:111], v[28:29] op_sel_hi:[1,0]
    v_pk_mul_f32 v[156:157], v[156:157], v[76:77] op_sel_hi:[1,0]
    v_pk_mul_f32 v[122:123], v[122:123], v[28:29] op_sel_hi:[1,0]
    v_cvt_pk_bf16_f32 v121, v122, v123
    v_pk_mul_f32 v[108:109], v[108:109], v[28:29] op_sel_hi:[1,0]
    v_pk_mul_f32 v[104:105], v[104:105], v[28:29] op_sel_hi:[1,0]
    v_cvt_pk_bf16_f32 v104, v104, v105
    v_pk_mul_f32 v[152:153], v[152:153], v[76:77] op_sel_hi:[1,0]
    v_pk_mul_f32 v[106:107], v[106:107], v[28:29] op_sel_hi:[1,0]
    v_mfma_f32_16x16x16_bf16 v[200:203], a[220:221], v[40:41], v[200:203]
    buffer_load_dwordx4 v4, s[32:35], s92 offen offset:3072  lds
    v_mfma_f32_16x16x16_bf16 v[116:119], a[226:227], v[24:25], v[116:119]
    s_add_u32 m0, s91, 49152
    ds_write_b128 v5, v[96:99] offset:16384
    v_mfma_f32_16x16x16_bf16 v[128:131], a[216:217], v[72:73], v[128:131]
    s_add_u32 s92, s90, 3932160
    s_add_u32 s90, s90, 128
    s_sub_u32 s87, s90, 1280
    v_mfma_f32_16x16x16_bf16 v[140:143], a[222:223], v[72:73], v[140:143]
    s_cselect_b32 s90, s90, s87
    v_mul_f32 v118, v118, v28
    v_mul_f32_e64 v119, v119, v28
    v_mfma_f32_16x16x16_bf16 v[136:139], a[220:221], v[72:73], v[136:139]
    v_cvt_pk_bf16_f32 v115, v118, v119
    v_cvt_pk_bf16_f32 v105, v106, v107
    v_mfma_f32_16x16x16_bf16 v[124:127], a[230:231], v[24:25], v[124:127]
    s_nop 0
    v_cvt_pk_bf16_f32 v107, v110, v111
    v_cvt_pk_bf16_f32 v106, v108, v109
    v_mfma_f32_16x16x32_bf16 v[184:187], a[208:211], v[84:87], v[184:187]
    s_nop 0
    ds_write_b128 v5, v[104:107] offset:17408
    v_pk_mul_f32 v[116:117], v[116:117], v[28:29] op_sel_hi:[1,0]
    v_cvt_pk_bf16_f32 v114, v116, v117
    v_pk_mul_f32 v[124:125], v[124:125], v[28:29] op_sel_hi:[1,0]
    v_cvt_pk_bf16_f32 v122, v124, v125
    v_pk_mul_f32 v[128:129], v[128:129], v[76:77] op_sel_hi:[1,0]
    v_cvt_pk_bf16_f32 v128, v128, v129
    v_pk_mul_f32 v[126:127], v[126:127], v[28:29] op_sel_hi:[1,0]
    v_cvt_pk_bf16_f32 v123, v126, v127
L_pad5:
    s_cbranch_execz L_pad9
    v_pk_mul_f32 v[140:141], v[140:141], v[76:77] op_sel_hi:[1,0]
    v_pk_mul_f32 v[130:131], v[130:131], v[76:77] op_sel_hi:[1,0]
    v_cvt_pk_bf16_f32 v129, v130, v131
    v_pk_mul_f32 v[136:137], v[136:137], v[76:77] op_sel_hi:[1,0]
    v_pk_mul_f32 v[138:139], v[138:139], v[76:77] op_sel_hi:[1,0]
    v_pk_mul_f32 v[142:143], v[142:143], v[76:77] op_sel_hi:[1,0]
    v_mfma_f32_16x16x32_bf16 v[196:199], a[156:159], v[32:35], 0
    buffer_load_dwordx4 v1, s[32:35], s92 offen offset:0  lds
    v_mfma_f32_16x16x32_bf16 v[216:219], a[176:179], v[32:35], 0
    ds_write_b128 v5, v[112:115] offset:18432
    v_mfma_f32_16x16x32_bf16 v[216:219], a[208:211], v[36:39], v[216:219]
    v_exp_f32 v237, v237
    v_mfma_f32_16x16x16_bf16 v[220:223], a[230:231], v[40:41], v[220:223]
    v_cvt_pk_bf16_f32 v136, v136, v137
    v_cvt_pk_bf16_f32 v137, v138, v139
    v_mfma_f32_16x16x16_bf16 v[208:211], a[224:225], v[40:41], v[208:211]
    s_nop 0
    ds_write_b128 v5, v[120:123] offset:19456
    v_mfma_f32_16x16x16_bf16 v[132:135], a[218:219], v[72:73], v[132:135]
    v_cvt_pk_bf16_f32 v139, v142, v143
    v_cvt_pk_bf16_f32 v138, v140, v141
    v_mfma_f32_16x16x32_bf16 v[44:47], a[232:235], v[32:35], 0
    v_exp_f32 v228, v228
    v_mfma_f32_16x16x32_bf16 v[196:199], a[188:191], v[36:39], v[196:199]
    s_nop 0
    ds_write_b128 v5, v[136:139] offset:1024
    v_mfma_f32_16x16x16_bf16 v[172:175], a[222:223], v[88:89], v[172:175]
    buffer_load_dwordx4 v2, s[32:35], s92 offen offset:1024  lds
    v_cvt_pk_bf16_f32 v144, v144, v145
    v_mfma_f32_16x16x32_bf16 v[160:163], a[184:187], v[84:87], v[160:163]
    v_cvt_pk_bf16_f32 v145, v146, v147
    v_cvt_pk_bf16_f32 v147, v150, v151
    v_mfma_f32_16x16x16_bf16 v[196:199], a[218:219], v[40:41], v[196:199]
    v_mul_f32 v132, v132, v76
    v_mul_f32_e64 v133, v133, v76
    v_mfma_f32_16x16x32_bf16 v[168:171], a[192:195], v[84:87], v[168:171]
    v_cvt_pk_bf16_f32 v130, v132, v133
    v_cvt_pk_bf16_f32 v152, v152, v153
    v_mfma_f32_16x16x32_bf16 v[192:195], a[152:155], v[32:35], 0
    v_mul_f32 v134, v134, v76
    v_mul_f32 v135, v135, v76
    v_mfma_f32_16x16x32_bf16 v[204:207], a[196:199], v[36:39], v[204:207]
    v_cvt_pk_bf16_f32 v131, v134, v135
    v_cvt_pk_bf16_f32 v153, v154, v155
    v_mfma_f32_16x16x16_bf16 v[168:171], a[220:221], v[88:89], v[168:171]
    ds_write_b128 v5, v[128:131] offset:0
    v_mfma_f32_16x16x16_bf16 v[212:215], a[226:227], v[40:41], v[212:215]
    s_nop 0
    v_cvt_pk_bf16_f32 v154, v156, v157
    v_cvt_pk_bf16_f32 v155, v158, v159
    v_mfma_f32_16x16x16_bf16 v[204:207], a[222:223], v[40:41], v[204:207]
    v_exp_f32 v233, v233
    v_mfma_f32_16x16x16_bf16 v[164:167], a[218:219], v[88:89], v[164:167]
    ds_write_b128 v5, v[152:155] offset:3072
    v_mfma_f32_16x16x16_bf16 v[216:219], a[228:229], v[40:41], v[216:219]
    buffer_load_dwordx4 v3, s[32:35], s92 offen offset:2048  lds
    v_cvt_pk_bf16_f32 v52, v232, v233
    v_mfma_f32_16x16x32_bf16 v[188:191], a[212:215], v[84:87], v[188:191]
    v_exp_f32_e64 v242, v242
    v_mfma_f32_16x16x32_bf16 v[192:195], a[184:187], v[36:39], v[192:195]
    v_exp_f32_e64 v239, v239
    v_mfma_f32_16x16x32_bf16 v[180:183], a[204:207], v[84:87], v[180:183]
    s_nop 0
    v_cvt_pk_bf16_f32 v55, v238, v239
    v_cvt_pk_bf16_f32 v146, v148, v149
    v_mfma_f32_16x16x16_bf16 v[188:191], a[230:231], v[88:89], v[188:191]
    ds_write_b128 v5, v[144:147] offset:2048
    v_mfma_f32_16x16x16_bf16 v[192:195], a[216:217], v[40:41], v[192:195]
    v_exp_f32 v241, v241
    v_mfma_f32_16x16x32_bf16 v[44:47], a[232:235], v[36:39], v[44:47]
    v_exp_f32_e64 v236, v236
    v_mfma_f32_16x16x32_bf16 v[92:95], a[232:235], v[84:87], v[92:95]
    v_cvt_pk_bf16_f32 v54, v236, v237
    v_exp_f32_e64 v226, v226
    v_mfma_f32_16x16x16_bf16 v[184:187], a[228:229], v[88:89], v[184:187]
    s_nop 0
    v_cvt_pk_bf16_f32 v49, v226, v227
    v_exp_f32 v230, v230
    v_mfma_f32_16x16x16_bf16 v[44:47], a[232:233], v[40:41], v[44:47]
    v_exp_f32_e64 v229, v229
    v_mfma_f32_16x16x16_bf16 v[92:95], a[232:233], v[88:89], v[92:95]
    buffer_load_dwordx4 v4, s[32:35], s92 offen offset:3072  lds
    v_mfma_f32_16x16x16_bf16 v[160:163], a[216:217], v[88:89], v[160:163]
    s_nop 0
    v_cvt_pk_bf16_f32 v50, v228, v229
    v_exp_f32 v240, v240
    v_mfma_f32_16x16x16_bf16 v[176:179], a[224:225], v[88:89], v[176:179]
    s_nop 0
    v_rcp_f32 v44, v44
    v_mfma_f32_16x16x16_bf16 v[180:183], a[226:227], v[88:89], v[180:183]
    v_exp_f32 v231, v231
    v_exp_f32 v243, v243
    v_cvt_pk_bf16_f32 v51, v230, v231
    v_pk_mul_f32 v[194:195], v[194:195], v[44:45] op_sel_hi:[1,0]
    v_pk_mul_f32 v[210:211], v[210:211], v[44:45] op_sel_hi:[1,0]
    v_pk_mul_f32 v[198:199], v[198:199], v[44:45] op_sel_hi:[1,0]
    v_pk_mul_f32 v[206:207], v[206:207], v[44:45] op_sel_hi:[1,0]
    v_pk_mul_f32 v[204:205], v[204:205], v[44:45] op_sel_hi:[1,0]
    v_pk_mul_f32 v[192:193], v[192:193], v[44:45] op_sel_hi:[1,0]
    v_pk_mul_f32 v[208:209], v[208:209], v[44:45] op_sel_hi:[1,0]
    v_pk_mul_f32 v[196:197], v[196:197], v[44:45] op_sel_hi:[1,0]
    v_pk_mul_f32 v[202:203], v[202:203], v[44:45] op_sel_hi:[1,0]
    v_pk_mul_f32 v[200:201], v[200:201], v[44:45] op_sel_hi:[1,0]
    v_pk_mul_f32 v[212:213], v[212:213], v[44:45] op_sel_hi:[1,0]
    v_pk_mul_f32 v[216:217], v[216:217], v[44:45] op_sel_hi:[1,0]
    v_pk_mul_f32 v[218:219], v[218:219], v[44:45] op_sel_hi:[1,0]
    v_pk_mul_f32 v[222:223], v[222:223], v[44:45] op_sel_hi:[1,0]
    v_pk_mul_f32 v[214:215], v[214:215], v[44:45] op_sel_hi:[1,0]
    v_rcp_f32_e64 v92, v92
    v_pk_mul_f32 v[220:221], v[220:221], v[44:45] op_sel_hi:[1,0]
    v_pk_mul_f32 v[172:173], v[172:173], v[92:93] op_sel_hi:[1,0]
    v_pk_mul_f32 v[170:171], v[170:171], v[92:93] op_sel_hi:[1,0]
    v_pk_mul_f32 v[178:179], v[178:179], v[92:93] op_sel_hi:[1,0]
    v_pk_mul_f32 v[180:181], v[180:181], v[92:93] op_sel_hi:[1,0]
    v_pk_mul_f32 v[176:177], v[176:177], v[92:93] op_sel_hi:[1,0]
    v_pk_mul_f32 v[182:183], v[182:183], v[92:93] op_sel_hi:[1,0]
    v_pk_mul_f32 v[174:175], v[174:175], v[92:93] op_sel_hi:[1,0]
    v_pk_mul_f32 v[184:185], v[184:185], v[92:93] op_sel_hi:[1,0]
    v_pk_mul_f32 v[186:187], v[186:187], v[92:93] op_sel_hi:[1,0]
    v_pk_mul_f32 v[188:189], v[188:189], v[92:93] op_sel_hi:[1,0]
    v_pk_mul_f32 v[190:191], v[190:191], v[92:93] op_sel_hi:[1,0]
    v_cvt_pk_bf16_f32 v176, v176, v177
    v_pk_mul_f32 v[168:169], v[168:169], v[92:93] op_sel_hi:[1,0]
    v_cvt_pk_bf16_f32 v168, v168, v169
    v_cvt_pk_bf16_f32 v169, v170, v171
    v_cvt_pk_bf16_f32 v171, v174, v175
    v_cvt_pk_bf16_f32 v170, v172, v173
    v_cvt_pk_bf16_f32 v177, v178, v179
    v_cvt_pk_bf16_f32 v179, v182, v183
    v_cvt_pk_bf16_f32 v178, v180, v181
    v_pk_mul_f32 v[164:165], v[164:165], v[92:93] op_sel_hi:[1,0]
    v_pk_mul_f32 v[162:163], v[162:163], v[92:93] op_sel_hi:[1,0]
    v_pk_mul_f32 v[166:167], v[166:167], v[92:93] op_sel_hi:[1,0]
    v_pk_mul_f32 v[160:161], v[160:161], v[92:93] op_sel_hi:[1,0]
    v_mfma_f32_16x16x32_bf16 v[252:255], a[180:183], v[48:51], 0
    ds_write_b128 v5, v[168:171] offset:5120
    v_mfma_f32_16x16x32_bf16 v[252:255], a[212:215], v[52:55], v[252:255]
    v_cvt_pk_bf16_f32 v160, v160, v161
    v_cvt_pk_bf16_f32 v161, v162, v163
    v_mfma_f32_16x16x32_bf16 v[244:247], a[172:175], v[48:51], 0
    v_cvt_pk_bf16_f32 v162, v164, v165
    v_cvt_pk_bf16_f32 v163, v166, v167
    v_mfma_f32_16x16x32_bf16 v[244:247], a[204:207], v[52:55], v[244:247]
    ds_write_b128 v5, v[160:163] offset:4096
    v_mfma_f32_16x16x32_bf16 v[248:251], a[176:179], v[48:51], 0
    v_cvt_pk_bf16_f32 v184, v184, v185
    v_cvt_pk_bf16_f32 v185, v186, v187
    v_mfma_f32_16x16x32_bf16 v[248:251], a[208:211], v[52:55], v[248:251]
    v_cvt_pk_bf16_f32 v186, v188, v189
    v_cvt_pk_bf16_f32 v192, v192, v193
    v_mfma_f32_16x16x32_bf16 v[232:235], a[160:163], v[48:51], 0
    ds_write_b128 v5, v[176:179] offset:6144
    v_mfma_f32_16x16x32_bf16 v[232:235], a[192:195], v[52:55], v[232:235]
    v_cvt_pk_bf16_f32 v193, v194, v195
    v_cvt_pk_bf16_f32 v194, v196, v197
    v_mfma_f32_16x16x32_bf16 v[236:239], a[164:167], v[48:51], 0
    v_cvt_pk_bf16_f32 v57, v242, v243
    v_cvt_pk_bf16_f32 v195, v198, v199
    v_mfma_f32_16x16x32_bf16 v[236:239], a[196:199], v[52:55], v[236:239]
    ds_write_b128 v5, v[192:195] offset:8192
    v_mfma_f32_16x16x32_bf16 v[60:63], a[232:235], v[48:51], 0
    v_cvt_pk_bf16_f32 v187, v190, v191
    v_cvt_pk_bf16_f32 v200, v200, v201
    v_mfma_f32_16x16x32_bf16 v[60:63], a[232:235], v[52:55], v[60:63]
    v_cvt_pk_bf16_f32 v201, v202, v203
    v_cvt_pk_bf16_f32 v203, v206, v207
    v_mfma_f32_16x16x32_bf16 v[224:227], a[152:155], v[48:51], 0
    ds_write_b128 v5, v[184:187] offset:7168
    v_mfma_f32_16x16x32_bf16 v[224:227], a[184:187], v[52:55], v[224:227]
    v_cvt_pk_bf16_f32 v202, v204, v205
    v_cvt_pk_bf16_f32 v56, v240, v241
    v_mfma_f32_16x16x32_bf16 v[240:243], a[168:171], v[48:51], 0
    s_nop 0
    v_cvt_pk_bf16_f32 v208, v208, v209
    v_cvt_pk_bf16_f32 v209, v210, v211
    v_mfma_f32_16x16x16_bf16 v[236:239], a[222:223], v[56:57], v[236:239]
    ds_write_b128 v5, v[200:203] offset:9216
    v_mfma_f32_16x16x16_bf16 v[60:63], a[232:233], v[56:57], v[60:63]
    v_cvt_pk_bf16_f32 v210, v212, v213
    v_cvt_pk_bf16_f32 v211, v214, v215
    v_mfma_f32_16x16x16_bf16 v[224:227], a[216:217], v[56:57], v[224:227]
    v_cvt_pk_bf16_f32 v216, v216, v217
    v_cvt_pk_bf16_f32 v217, v218, v219
    v_mfma_f32_16x16x32_bf16 v[240:243], a[200:203], v[52:55], v[240:243]
    s_nop 0
    ds_write_b128 v5, v[208:211] offset:10240
    v_mfma_f32_16x16x16_bf16 v[232:235], a[220:221], v[56:57], v[232:235]
    s_nop 0
    v_cvt_pk_bf16_f32 v219, v222, v223
    v_cvt_pk_bf16_f32 v218, v220, v221
    v_mfma_f32_16x16x16_bf16 v[240:243], a[224:225], v[56:57], v[240:243]
    v_rcp_f32 v60, v60
    v_mfma_f32_16x16x16_bf16 v[244:247], a[226:227], v[56:57], v[244:247]
    s_nop 0
    ds_write_b128 v5, v[216:219] offset:11264
    v_pk_mul_f32 v[232:233], v[232:233], v[60:61] op_sel_hi:[1,0]
    v_pk_mul_f32 v[236:237], v[236:237], v[60:61] op_sel_hi:[1,0]
    v_pk_mul_f32 v[238:239], v[238:239], v[60:61] op_sel_hi:[1,0]
    v_pk_mul_f32 v[234:235], v[234:235], v[60:61] op_sel_hi:[1,0]
    v_pk_mul_f32 v[242:243], v[242:243], v[60:61] op_sel_hi:[1,0]
    v_pk_mul_f32 v[224:225], v[224:225], v[60:61] op_sel_hi:[1,0]
    v_pk_mul_f32 v[244:245], v[244:245], v[60:61] op_sel_hi:[1,0]
    v_pk_mul_f32 v[246:247], v[246:247], v[60:61] op_sel_hi:[1,0]
    v_pk_mul_f32 v[226:227], v[226:227], v[60:61] op_sel_hi:[1,0]
    v_cvt_pk_bf16_f32 v232, v232, v233
    v_cvt_pk_bf16_f32 v233, v234, v235
    v_cvt_pk_bf16_f32 v235, v238, v239
    v_cvt_pk_bf16_f32 v234, v236, v237
    v_pk_mul_f32 v[240:241], v[240:241], v[60:61] op_sel_hi:[1,0]
    v_mfma_f32_16x16x16_bf16 v[248:251], a[228:229], v[56:57], v[248:251]
    ds_write_b128 v5, v[232:235] offset:13312
    v_mfma_f32_16x16x32_bf16 v[228:231], a[156:159], v[48:51], 0
    s_nop 0
    v_cvt_pk_bf16_f32 v240, v240, v241
    v_cvt_pk_bf16_f32 v241, v242, v243
    v_mfma_f32_16x16x32_bf16 v[228:231], a[188:191], v[52:55], v[228:231]
    s_nop 0
    v_cvt_pk_bf16_f32 v243, v246, v247
    v_cvt_pk_bf16_f32 v242, v244, v245
    v_mfma_f32_16x16x16_bf16 v[252:255], a[230:231], v[56:57], v[252:255]
    ds_write_b128 v5, v[240:243] offset:14336
    v_pk_mul_f32 v[248:249], v[248:249], v[60:61] op_sel_hi:[1,0]
    v_cvt_pk_bf16_f32 v248, v248, v249
    v_pk_mul_f32 v[250:251], v[250:251], v[60:61] op_sel_hi:[1,0]
    v_mfma_f32_16x16x16_bf16 v[228:231], a[218:219], v[56:57], v[228:231]
    s_nop 0
    v_cvt_pk_bf16_f32 v249, v250, v251
    v_cvt_pk_bf16_f32 v224, v224, v225
    v_cvt_pk_bf16_f32 v225, v226, v227
    v_mul_f32 v252, v252, v60
    v_mul_f32 v253, v253, v60
    v_cvt_pk_bf16_f32 v250, v252, v253
    v_pk_mul_f32 v[254:255], v[254:255], v[60:61] op_sel_hi:[1,0]
    v_cvt_pk_bf16_f32 v251, v254, v255
    ds_write_b128 v5, v[248:251] offset:15360
    v_pk_mul_f32 v[230:231], v[230:231], v[60:61] op_sel_hi:[1,0]
    v_cvt_pk_bf16_f32 v227, v230, v231
    v_pk_mul_f32 v[228:229], v[228:229], v[60:61] op_sel_hi:[1,0]
    v_cvt_pk_bf16_f32 v226, v228, v229
    ds_write_b128 v5, v[224:227] offset:12288
    s_waitcnt vmcnt(12)
    s_waitcnt lgkmcnt(0)
    s_barrier
    ds_read_b64_tr_b16 v[148:149], v7 offset:0
    ds_read_b64_tr_b16 v[150:151], v7 offset:2048
    ds_read_b128 a[0:3], v9 offset:0
    ds_read_b128 a[16:19], v9 offset:4096
    ds_read_b128 a[32:35], v9 offset:8192
    ds_read_b128 a[48:51], v9 offset:12288
    ds_read_b128 a[64:67], v9 offset:16384
    ds_read_b64_tr_b16 v[152:153], v7 offset:4096
    ds_read_b64_tr_b16 v[154:155], v7 offset:6144
    ds_read_b128 a[4:7], v9 offset:1024
    ds_read_b128 a[20:23], v9 offset:5120
    ds_read_b128 a[36:39], v9 offset:9216
    ds_read_b128 a[52:55], v9 offset:13312
    ds_read_b128 a[68:71], v9 offset:17408
    ds_read_b64_tr_b16 v[156:157], v7 offset:8192
    ds_read_b128 a[8:11], v9 offset:2048
    ds_read_b128 a[24:27], v9 offset:6144
    ds_read_b128 a[40:43], v9 offset:10240
    ds_read_b128 a[56:59], v9 offset:14336
    ds_read_b128 a[72:75], v9 offset:18432
L_out:
    v_mov_b32 v188, 0
    v_bfe_u32 v5, v0, 2, 2
    v_lshrrev_b32 v6, 4, v0
    v_and_b32 v12, 3, v0
    v_lshl_add_u32 v5, v5, 2, v6
    v_lshl_add_u32 v5, v5, 2, v12
    v_lshlrev_b32 v186, 4, v5
    v_lshlrev_b32 v187, 3, v5
    v_lshrrev_b32 v84, 5, v0
    v_lshlrev_b32 v84, 24, v84
    v_lshl_add_u32 v84, v0, 2, v84
    s_sub_u32 s83, 3, s3
    v_lshl_add_u32 v189, s83, 28, v84
    v_lshlrev_b32_e64 v191, 28, s83
    s_mul_i32 s83, s83, 2688
    v_mov_b32_e64 v190, s83
    s_waitcnt lgkmcnt(6)
    v_mfma_f32_16x16x32_bf16 v[128:131], v[148:151], a[0:3], 0
    buffer_load_dword v82, v188, s[48:51], 0 offen sc1
    ds_read_b64_tr_b16 v[158:159], v7 offset:10240
    v_mfma_f32_16x16x32_bf16 v[128:131], v[152:155], a[4:7], v[128:131]
    s_add_u32 m0, s91, 65536
    ds_read_b64_tr_b16 v[160:161], v7 offset:12288
    s_add_u32 s92, s90, 0
    v_mfma_f32_16x16x32_bf16 v[132:135], v[152:155], a[20:23], 0
    buffer_load_dwordx4 v1, s[32:35], s92 offen offset:0  lds
    ds_read_b64_tr_b16 v[162:163], v7 offset:14336
    v_mfma_f32_16x16x32_bf16 v[132:135], v[148:151], a[16:19], v[132:135]
    buffer_load_dwordx4 v2, s[32:35], s92 offen offset:1024  lds
    ds_read_b128 a[12:15], v9 offset:3072
    v_mfma_f32_16x16x32_bf16 v[136:139], v[148:151], a[32:35], 0
    ds_read_b128 a[28:31], v9 offset:7168
    ds_read_b128 a[44:47], v9 offset:11264
    ds_read_b128 a[60:63], v9 offset:15360
    ds_read_b128 a[76:79], v9 offset:19456
    v_mfma_f32_16x16x32_bf16 v[136:139], v[152:155], a[36:39], v[136:139]
    ds_read_b128 a[80:83], v9 offset:20480
    v_mfma_f32_16x16x32_bf16 v[140:143], v[152:155], a[52:55], 0
    buffer_load_dwordx4 v3, s[32:35], s92 offen offset:2048  lds
    ds_read_b128 a[96:99], v9 offset:24576
    v_mfma_f32_16x16x32_bf16 v[140:143], v[148:151], a[48:51], v[140:143]
    ds_read_b128 a[112:115], v9 offset:28672
    ds_read_b128 a[128:131], v9 offset:32768
    v_mfma_f32_16x16x32_bf16 v[144:147], v[148:151], a[64:67], 0
    s_waitcnt vmcnt(12)
    s_barrier
    ds_read_b128 a[144:147], v9 offset:36864
    v_mfma_f32_16x16x32_bf16 v[144:147], v[152:155], a[68:71], v[144:147]
    s_waitcnt lgkmcnt(5)
    ds_read_b64_tr_b16 v[148:149], v7 offset:16384
    v_mfma_f32_16x16x32_bf16 v[144:147], v[156:159], a[72:75], v[144:147]
    buffer_load_dwordx4 v4, s[32:35], s92 offen offset:3072  lds
    ds_read_b64_tr_b16 v[150:151], v7 offset:18432
    v_mfma_f32_16x16x32_bf16 v[144:147], v[160:163], a[76:79], v[144:147]
    s_waitcnt vmcnt(9)
    s_barrier
    ds_read_b64_tr_b16 v[152:153], v7 offset:20480
    v_mfma_f32_16x16x32_bf16 v[140:143], v[160:163], a[60:63], v[140:143]
    s_add_u32 m0, s91, 0
    ds_read_b64_tr_b16 v[154:155], v7 offset:22528
    s_add_u32 s92, s90, 1310720
    v_mfma_f32_16x16x32_bf16 v[140:143], v[156:159], a[56:59], v[140:143]
    buffer_load_dwordx4 v1, s[32:35], s92 offen offset:0  lds
    ds_read_b128 a[84:87], v9 offset:21504
    v_mfma_f32_16x16x32_bf16 v[136:139], v[156:159], a[40:43], v[136:139]
    ds_read_b128 a[100:103], v9 offset:25600
    ds_read_b128 a[116:119], v9 offset:29696
    ds_read_b128 a[132:135], v9 offset:33792
    ds_read_b128 a[148:151], v9 offset:37888
    v_mfma_f32_16x16x32_bf16 v[136:139], v[160:163], a[44:47], v[136:139]
    buffer_load_dwordx4 v2, s[32:35], s92 offen offset:1024  lds
    ds_read_b128 a[88:91], v9 offset:22528
    v_mfma_f32_16x16x32_bf16 v[132:135], v[160:163], a[28:31], v[132:135]
    ds_read_b128 a[104:107], v9 offset:26624
    v_mfma_f32_16x16x32_bf16 v[132:135], v[156:159], a[24:27], v[132:135]
    buffer_load_dwordx4 v3, s[32:35], s92 offen offset:2048  lds
    ds_read_b128 a[120:123], v9 offset:30720
    v_mfma_f32_16x16x32_bf16 v[128:131], v[156:159], a[8:11], v[128:131]
    ds_read_b128 a[136:139], v9 offset:34816
    ds_read_b128 a[152:155], v9 offset:38912
    v_mfma_f32_16x16x32_bf16 v[128:131], v[160:163], a[12:15], v[128:131]
    s_waitcnt lgkmcnt(5)
    ds_read_b64_tr_b16 v[156:157], v7 offset:24576
    v_mfma_f32_16x16x32_bf16 v[128:131], v[148:151], a[80:83], v[128:131]
    buffer_load_dwordx4 v4, s[32:35], s92 offen offset:3072  lds
    ds_read_b64_tr_b16 v[158:159], v7 offset:26624
    v_mfma_f32_16x16x32_bf16 v[128:131], v[152:155], a[84:87], v[128:131]
    s_add_u32 m0, s91, 81920
    ds_read_b64_tr_b16 v[160:161], v7 offset:28672
    s_add_u32 s92, s90, 2621440
    v_mfma_f32_16x16x32_bf16 v[132:135], v[152:155], a[100:103], v[132:135]
    buffer_load_dwordx4 v1, s[32:35], s92 offen offset:0  lds
    ds_read_b64_tr_b16 v[162:163], v7 offset:30720
    v_mfma_f32_16x16x32_bf16 v[132:135], v[148:151], a[96:99], v[132:135]
    ds_read_b128 a[92:95], v9 offset:23552
    v_mfma_f32_16x16x32_bf16 v[136:139], v[148:151], a[112:115], v[136:139]
    ds_read_b128 a[108:111], v9 offset:27648
    ds_read_b128 a[124:127], v9 offset:31744
    ds_read_b128 a[140:143], v9 offset:35840
    ds_read_b128 a[156:159], v9 offset:39936
    v_mfma_f32_16x16x32_bf16 v[136:139], v[152:155], a[116:119], v[136:139]
    buffer_load_dwordx4 v2, s[32:35], s92 offen offset:1024  lds
    ds_read_b128 a[160:163], v10 offset:0
    v_mfma_f32_16x16x32_bf16 v[140:143], v[152:155], a[132:135], v[140:143]
    ds_read_b128 a[176:179], v10 offset:4096
    v_mfma_f32_16x16x32_bf16 v[140:143], v[148:151], a[128:131], v[140:143]
    buffer_load_dwordx4 v3, s[32:35], s92 offen offset:2048  lds
    ds_read_b128 a[192:195], v10 offset:8192
    v_mfma_f32_16x16x32_bf16 v[144:147], v[148:151], a[144:147], v[144:147]
    ds_read_b128 a[208:211], v10 offset:12288
    ds_read_b128 a[224:227], v10 offset:16384
    v_mfma_f32_16x16x32_bf16 v[144:147], v[152:155], a[148:151], v[144:147]
    s_waitcnt lgkmcnt(5)
    ds_read_b64_tr_b16 v[148:149], v7 offset:32768
    v_mfma_f32_16x16x32_bf16 v[144:147], v[156:159], a[152:155], v[144:147]
    buffer_load_dwordx4 v4, s[32:35], s92 offen offset:3072  lds
    ds_read_b64_tr_b16 v[150:151], v7 offset:34816
    v_mfma_f32_16x16x32_bf16 v[144:147], v[160:163], a[156:159], v[144:147]
    s_waitcnt vmcnt(13)
    s_barrier
    ds_read_b64_tr_b16 v[152:153], v7 offset:36864
    v_mfma_f32_16x16x32_bf16 v[140:143], v[160:163], a[140:143], v[140:143]
    s_add_u32 m0, s91, 16384
    ds_read_b64_tr_b16 v[154:155], v7 offset:38912
    s_add_u32 s92, s90, 3932160
    v_mfma_f32_16x16x32_bf16 v[140:143], v[156:159], a[136:139], v[140:143]
    s_add_u32 s90, s90, 128
    ds_read_b128 a[164:167], v10 offset:1024
    v_mfma_f32_16x16x32_bf16 v[136:139], v[156:159], a[120:123], v[136:139]
    ds_read_b128 a[180:183], v10 offset:5120
    ds_read_b128 a[196:199], v10 offset:9216
    ds_read_b128 a[212:215], v10 offset:13312
    ds_read_b128 a[228:231], v10 offset:17408
    v_mfma_f32_16x16x32_bf16 v[136:139], v[160:163], a[124:127], v[136:139]
    s_sub_u32 s87, s90, 1280
    s_cselect_b32 s90, s90, s87
    ds_read_b128 a[168:171], v10 offset:2048
    v_mfma_f32_16x16x32_bf16 v[132:135], v[160:163], a[108:111], v[132:135]
    buffer_load_dwordx4 v1, s[32:35], s92 offen offset:0  lds
    ds_read_b128 a[184:187], v10 offset:6144
    v_mfma_f32_16x16x32_bf16 v[132:135], v[156:159], a[104:107], v[132:135]
    buffer_load_dwordx4 v2, s[32:35], s92 offen offset:1024  lds
    ds_read_b128 a[200:203], v10 offset:10240
    v_mfma_f32_16x16x32_bf16 v[128:131], v[156:159], a[88:91], v[128:131]
    ds_read_b128 a[216:219], v10 offset:14336
    ds_read_b128 a[232:235], v10 offset:18432
    v_mfma_f32_16x16x32_bf16 v[128:131], v[160:163], a[92:95], v[128:131]
    s_waitcnt lgkmcnt(5)
    ds_read_b64_tr_b16 v[156:157], v7 offset:40960
    v_mfma_f32_16x16x32_bf16 v[128:131], v[148:151], a[160:163], v[128:131]
    buffer_load_dwordx4 v3, s[32:35], s92 offen offset:2048  lds
    ds_read_b64_tr_b16 v[158:159], v7 offset:43008
    v_mfma_f32_16x16x32_bf16 v[128:131], v[152:155], a[164:167], v[128:131]
    ds_read_b64_tr_b16 v[160:161], v7 offset:45056
    v_mfma_f32_16x16x32_bf16 v[132:135], v[152:155], a[180:183], v[132:135]
    buffer_load_dwordx4 v4, s[32:35], s92 offen offset:3072  lds
    ds_read_b64_tr_b16 v[162:163], v7 offset:47104
    v_mfma_f32_16x16x32_bf16 v[132:135], v[148:151], a[176:179], v[132:135]
    s_add_u32 m0, s91, 102400
    ds_read_b128 a[172:175], v10 offset:3072
    s_add_u32 s92, s90, 0
    v_mfma_f32_16x16x32_bf16 v[136:139], v[148:151], a[192:195], v[136:139]
    ds_read_b128 a[188:191], v10 offset:7168
    ds_read_b128 a[204:207], v10 offset:11264
    ds_read_b128 a[220:223], v10 offset:15360
    ds_read_b128 a[236:239], v10 offset:19456
    v_mfma_f32_16x16x32_bf16 v[136:139], v[152:155], a[196:199], v[136:139]
    buffer_load_dwordx4 v1, s[32:35], s92 offen offset:0  lds
    ds_read_b128 a[240:243], v10 offset:20480
    v_mfma_f32_16x16x32_bf16 v[140:143], v[152:155], a[212:215], v[140:143]
    ds_read_b128 v[192:195], v10 offset:24576
    v_mfma_f32_16x16x32_bf16 v[140:143], v[148:151], a[208:211], v[140:143]
    buffer_load_dwordx4 v2, s[32:35], s92 offen offset:1024  lds
    ds_read_b128 v[208:211], v10 offset:28672
    v_mfma_f32_16x16x32_bf16 v[144:147], v[148:151], a[224:227], v[144:147]
    ds_read_b128 v[224:227], v10 offset:32768
    ds_read_b128 v[240:243], v10 offset:36864
    v_mfma_f32_16x16x32_bf16 v[144:147], v[152:155], a[228:231], v[144:147]
    s_waitcnt lgkmcnt(5)
    ds_read_b64_tr_b16 v[148:149], v7 offset:49152
    v_mfma_f32_16x16x32_bf16 v[144:147], v[156:159], a[232:235], v[144:147]
    buffer_load_dwordx4 v3, s[32:35], s92 offen offset:2048  lds
    ds_read_b64_tr_b16 v[150:151], v7 offset:51200
    v_mfma_f32_16x16x32_bf16 v[144:147], v[160:163], a[236:239], v[144:147]
    s_waitcnt vmcnt(15)
    s_barrier
    ds_read_b64_tr_b16 v[152:153], v7 offset:53248
    v_mfma_f32_16x16x32_bf16 v[140:143], v[160:163], a[220:223], v[140:143]
    buffer_load_dwordx4 v4, s[32:35], s92 offen offset:3072  lds
    ds_read_b64_tr_b16 v[154:155], v7 offset:55296
    v_mfma_f32_16x16x32_bf16 v[140:143], v[156:159], a[216:219], v[140:143]
    s_add_u32 m0, s91, 32768
    ds_read_b128 a[244:247], v10 offset:21504
    s_add_u32 s92, s90, 1310720
    v_mfma_f32_16x16x32_bf16 v[136:139], v[156:159], a[200:203], v[136:139]
    ds_read_b128 v[196:199], v10 offset:25600
    ds_read_b128 v[212:215], v10 offset:29696
    ds_read_b128 v[228:231], v10 offset:33792
    ds_read_b128 v[244:247], v10 offset:37888
    v_mfma_f32_16x16x32_bf16 v[136:139], v[160:163], a[204:207], v[136:139]
    buffer_load_dwordx4 v1, s[32:35], s92 offen offset:0  lds
    ds_read_b128 a[248:251], v10 offset:22528
    v_mfma_f32_16x16x32_bf16 v[132:135], v[160:163], a[188:191], v[132:135]
    ds_read_b128 v[200:203], v10 offset:26624
    v_mfma_f32_16x16x32_bf16 v[132:135], v[156:159], a[184:187], v[132:135]
    buffer_load_dwordx4 v2, s[32:35], s92 offen offset:1024  lds
    ds_read_b128 v[216:219], v10 offset:30720
    v_mfma_f32_16x16x32_bf16 v[128:131], v[156:159], a[168:171], v[128:131]
    ds_read_b128 v[232:235], v10 offset:34816
    ds_read_b128 v[248:251], v10 offset:38912
    v_mfma_f32_16x16x32_bf16 v[128:131], v[160:163], a[172:175], v[128:131]
    s_waitcnt lgkmcnt(5)
    ds_read_b64_tr_b16 v[156:157], v7 offset:57344
    v_mfma_f32_16x16x32_bf16 v[128:131], v[148:151], a[240:243], v[128:131]
    buffer_load_dwordx4 v3, s[32:35], s92 offen offset:2048  lds
    ds_read_b64_tr_b16 v[158:159], v7 offset:59392
    v_mfma_f32_16x16x32_bf16 v[128:131], v[152:155], a[244:247], v[128:131]
    ds_read_b64_tr_b16 v[160:161], v7 offset:61440
    v_mfma_f32_16x16x32_bf16 v[132:135], v[152:155], v[196:199], v[132:135]
    buffer_load_dwordx4 v4, s[32:35], s92 offen offset:3072  lds
    ds_read_b64_tr_b16 v[162:163], v7 offset:63488
    v_mfma_f32_16x16x32_bf16 v[132:135], v[148:151], v[192:195], v[132:135]
    s_add_u32 m0, s91, 122880
    ds_read_b128 a[252:255], v10 offset:23552
    s_add_u32 s92, s90, 2621440
    v_mfma_f32_16x16x32_bf16 v[136:139], v[148:151], v[208:211], v[136:139]
    ds_read_b128 v[204:207], v10 offset:27648
    ds_read_b128 v[220:223], v10 offset:31744
    ds_read_b128 v[236:239], v10 offset:35840
    ds_read_b128 v[252:255], v10 offset:39936
    v_mfma_f32_16x16x32_bf16 v[136:139], v[152:155], v[212:215], v[136:139]
    buffer_load_dwordx4 v1, s[32:35], s92 offen offset:0  lds
    v_mfma_f32_16x16x32_bf16 v[140:143], v[152:155], v[228:231], v[140:143]
    v_mfma_f32_16x16x32_bf16 v[140:143], v[148:151], v[224:227], v[140:143]
    buffer_load_dwordx4 v2, s[32:35], s92 offen offset:1024  lds
    v_mfma_f32_16x16x32_bf16 v[144:147], v[148:151], v[240:243], v[144:147]
    v_mfma_f32_16x16x32_bf16 v[144:147], v[152:155], v[244:247], v[144:147]
    s_waitcnt lgkmcnt(0)
    ds_read_b64_tr_b16 v[148:149], v8 offset:0
    v_mfma_f32_16x16x32_bf16 v[144:147], v[156:159], v[248:251], v[144:147]
    buffer_load_dwordx4 v3, s[32:35], s92 offen offset:2048  lds
    ds_read_b64_tr_b16 v[150:151], v8 offset:2048
    v_mfma_f32_16x16x32_bf16 v[144:147], v[160:163], v[252:255], v[144:147]
    ds_read_b64_tr_b16 v[152:153], v8 offset:4096
    v_mfma_f32_16x16x32_bf16 v[140:143], v[160:163], v[236:239], v[140:143]
    buffer_load_dwordx4 v4, s[32:35], s92 offen offset:3072  lds
    ds_read_b64_tr_b16 v[154:155], v8 offset:6144
    v_mfma_f32_16x16x32_bf16 v[140:143], v[156:159], v[232:235], v[140:143]
    v_mfma_f32_16x16x32_bf16 v[136:139], v[156:159], v[216:219], v[136:139]
    v_mfma_f32_16x16x32_bf16 v[136:139], v[160:163], v[220:223], v[136:139]
    v_mfma_f32_16x16x32_bf16 v[132:135], v[160:163], v[204:207], v[132:135]
    v_mfma_f32_16x16x32_bf16 v[132:135], v[156:159], v[200:203], v[132:135]
    v_mfma_f32_16x16x32_bf16 v[128:131], v[156:159], a[248:251], v[128:131]
    v_mfma_f32_16x16x32_bf16 v[128:131], v[160:163], a[252:255], v[128:131]
    s_waitcnt lgkmcnt(0)
    ds_read_b64_tr_b16 v[156:157], v8 offset:8192
    v_mfma_f32_16x16x32_bf16 v[108:111], v[148:151], a[0:3], 0
    ds_read_b64_tr_b16 v[158:159], v8 offset:10240
    v_cvt_pk_bf16_f32 v173, v146, v147
    v_mfma_f32_16x16x32_bf16 v[108:111], v[152:155], a[4:7], v[108:111]
    ds_read_b64_tr_b16 v[160:161], v8 offset:12288
    v_cvt_pk_bf16_f32 v172, v144, v145
    v_mfma_f32_16x16x32_bf16 v[112:115], v[152:155], a[20:23], 0
    ds_read_b64_tr_b16 v[162:163], v8 offset:14336
    v_cvt_pk_bf16_f32 v171, v142, v143
    v_mfma_f32_16x16x32_bf16 v[112:115], v[148:151], a[16:19], v[112:115]
    v_cvt_pk_bf16_f32 v170, v140, v141
    v_cvt_pk_bf16_f32 v169, v138, v139
    v_mfma_f32_16x16x32_bf16 v[116:119], v[148:151], a[32:35], 0
    v_cvt_pk_bf16_f32 v168, v136, v137
    v_cvt_pk_bf16_f32 v167, v134, v135
    v_mfma_f32_16x16x32_bf16 v[116:119], v[152:155], a[36:39], v[116:119]
    v_cvt_pk_bf16_f32 v166, v132, v133
    v_cvt_pk_bf16_f32 v165, v130, v131
    v_mfma_f32_16x16x32_bf16 v[120:123], v[152:155], a[52:55], 0
    v_cvt_pk_bf16_f32 v164, v128, v129
    v_mfma_f32_16x16x32_bf16 v[120:123], v[148:151], a[48:51], v[120:123]
    v_mfma_f32_16x16x32_bf16 v[124:127], v[148:151], a[64:67], 0
    s_waitcnt vmcnt(20)
    s_barrier
L_pad6:
    s_cbranch_execz L_pad10
    v_mfma_f32_16x16x32_bf16 v[124:127], v[152:155], a[68:71], v[124:127]
    s_waitcnt lgkmcnt(0)
    ds_read_b64_tr_b16 v[148:149], v7 offset:0
    s_add_u32 m0, s91, 49152
    v_mfma_f32_16x16x32_bf16 v[124:127], v[156:159], a[72:75], v[124:127]
    s_add_u32 s92, s90, 3932160
    ds_read_b64_tr_b16 v[150:151], v7 offset:2048
    v_and_b32_e64 v19, 7, v0
    v_mfma_f32_16x16x32_bf16 v[124:127], v[160:163], a[76:79], v[124:127]
    buffer_store_dwordx4 v[164:167], v186, s[36:39], s93 offen sc1
    ds_read_b64_tr_b16 v[152:153], v7 offset:4096
    v_mfma_f32_16x16x32_bf16 v[120:123], v[160:163], a[60:63], v[120:123]
    buffer_store_dwordx4 v[168:171], v186, s[36:39], s93 offen offset:1024 sc1
    ds_read_b64_tr_b16 v[154:155], v7 offset:6144
    v_mfma_f32_16x16x32_bf16 v[120:123], v[156:159], a[56:59], v[120:123]
    s_and_b32 s83, s81, 3
    v_lshrrev_b32 v5, 4, v0
    v_and_b32_e64 v6, 15, v0
    v_mfma_f32_16x16x32_bf16 v[116:119], v[156:159], a[40:43], v[116:119]
    buffer_store_dwordx2 v[172:173], v187, s[36:39], s93 offen offset:2048 sc1
    s_add_u32 s93, s93, 10752
    v_mfma_f32_16x16x32_bf16 v[116:119], v[160:163], a[44:47], v[116:119]
    s_add_u32 s90, s90, 128
    s_sub_u32 s87, s90, 1280
    s_cselect_b32 s90, s90, s87
    v_mfma_f32_16x16x32_bf16 v[112:115], v[160:163], a[28:31], v[112:115]
    buffer_load_dwordx4 v1, s[32:35], s92 offen offset:0  lds
    v_cmp_gt_u32 vcc, 32, v0
    v_mfma_f32_16x16x32_bf16 v[112:115], v[156:159], a[24:27], v[112:115]
    v_mov_b32 v12, 128
    v_mov_b32 v13, 256
    v_mfma_f32_16x16x32_bf16 v[108:111], v[156:159], a[8:11], v[108:111]
    v_cndmask_b32 v12, v12, v13, vcc
    v_mul_u32_u24 v12, s83, v12
    v_mfma_f32_16x16x32_bf16 v[108:111], v[160:163], a[12:15], v[108:111]
    s_waitcnt lgkmcnt(0)
    ds_read_b64_tr_b16 v[156:157], v7 offset:8192
    v_lshl_add_u32 v12, v5, 10, v12
    v_mfma_f32_16x16x32_bf16 v[108:111], v[148:151], a[80:83], v[108:111]
    buffer_load_dwordx4 v2, s[32:35], s92 offen offset:1024  lds
    ds_read_b64_tr_b16 v[158:159], v7 offset:10240
    v_mfma_f32_16x16x32_bf16 v[108:111], v[152:155], a[84:87], v[108:111]
    ds_read_b64_tr_b16 v[160:161], v7 offset:12288
    v_lshl_add_u32 v86, v6, 4, v12
    v_mfma_f32_16x16x32_bf16 v[112:115], v[152:155], a[100:103], v[112:115]
    ds_read_b64_tr_b16 v[162:163], v7 offset:14336
    v_bfe_u32 v12, v0, 2, 2
    v_mfma_f32_16x16x32_bf16 v[112:115], v[148:151], a[96:99], v[112:115]
    v_bfe_u32 v13, v0, 1, 2
    v_cndmask_b32 v12, v13, v12, vcc
    v_mfma_f32_16x16x32_bf16 v[116:119], v[148:151], a[112:115], v[116:119]
    buffer_load_dwordx4 v3, s[32:35], s92 offen offset:2048  lds
    v_and_b32_e64 v13, 3, v0
    v_mfma_f32_16x16x32_bf16 v[116:119], v[152:155], a[116:119], v[116:119]
    v_and_b32 v22, 1, v0
    v_lshlrev_b32 v22, 1, v22
    v_mfma_f32_16x16x32_bf16 v[120:123], v[152:155], a[132:135], v[120:123]
    v_cndmask_b32 v13, v22, v13, vcc
    v_lshl_add_u32 v13, v5, 3, v13
    v_mfma_f32_16x16x32_bf16 v[120:123], v[148:151], a[128:131], v[120:123]
    v_mov_b32 v22, 144
    v_mov_b32 v23, 576
    v_mfma_f32_16x16x32_bf16 v[124:127], v[148:151], a[144:147], v[124:127]
    s_waitcnt vmcnt(22)
    s_barrier
    v_mfma_f32_16x16x32_bf16 v[124:127], v[152:155], a[148:151], v[124:127]
    s_waitcnt lgkmcnt(0)
    ds_read_b64_tr_b16 v[148:149], v8 offset:16384
    v_cndmask_b32 v22, v22, v23, vcc
    v_mfma_f32_16x16x32_bf16 v[124:127], v[156:159], a[152:155], v[124:127]
    buffer_load_dwordx4 v4, s[32:35], s92 offen offset:3072  lds
    ds_read_b64_tr_b16 v[150:151], v8 offset:18432
    v_mfma_f32_16x16x32_bf16 v[124:127], v[160:163], a[156:159], v[124:127]
    s_add_u32 m0, s91, 143360
    ds_read_b64_tr_b16 v[152:153], v8 offset:20480
    s_add_u32 s92, s90, 0
    v_mfma_f32_16x16x32_bf16 v[120:123], v[160:163], a[140:143], v[120:123]
    ds_read_b64_tr_b16 v[154:155], v8 offset:22528
    v_cmp_gt_u32 vcc, 40, v0
    v_mfma_f32_16x16x32_bf16 v[120:123], v[156:159], a[136:139], v[120:123]
    v_mov_b32_e64 v23, 1073741824
    s_lshl_b32 s89, s3, 5
    v_mfma_f32_16x16x32_bf16 v[116:119], v[156:159], a[120:123], v[116:119]
    buffer_load_dwordx4 v1, s[32:35], s92 offen offset:0  lds
    v_cndmask_b32 v86, v23, v86, vcc
    v_mfma_f32_16x16x32_bf16 v[116:119], v[160:163], a[124:127], v[116:119]
    v_cndmask_b32 v13, 24, v13, vcc
    v_mul_u32_u24 v13, 144, v13
    v_mfma_f32_16x16x32_bf16 v[112:115], v[160:163], a[108:111], v[112:115]
    s_add_u32 s89, s89, 0
    v_lshl_add_u32 v13, v12, 3, v13
    v_add_u32 v20, s89, v13
    v_mfma_f32_16x16x32_bf16 v[112:115], v[156:159], a[104:107], v[112:115]
    v_add_u32_e64 v21, v20, v22
    v_mul_u32_u24 v16, 144, v6
    v_mfma_f32_16x16x32_bf16 v[108:111], v[156:159], a[88:91], v[108:111]
    v_lshl_add_u32 v16, v5, 3, v16
    v_add_u32_e64 v16, s89, v16
    v_mfma_f32_16x16x32_bf16 v[108:111], v[160:163], a[92:95], v[108:111]
    s_waitcnt lgkmcnt(0)
    ds_read_b64_tr_b16 v[156:157], v8 offset:24576
    v_lshlrev_b32 v5, 2, v5
    v_mfma_f32_16x16x32_bf16 v[108:111], v[148:151], a[160:163], v[108:111]
    buffer_load_dwordx4 v2, s[32:35], s92 offen offset:1024  lds
    ds_read_b64_tr_b16 v[158:159], v8 offset:26624
    v_mfma_f32_16x16x32_bf16 v[108:111], v[152:155], a[164:167], v[108:111]
    ds_read_b64_tr_b16 v[160:161], v8 offset:28672
    v_sub_u32_e64 v5, v6, v5
    v_mfma_f32_16x16x32_bf16 v[112:115], v[152:155], a[180:183], v[112:115]
    ds_read_b64_tr_b16 v[162:163], v8 offset:30720
    v_lshrrev_b32_e64 v6, 3, v0
    v_mfma_f32_16x16x32_bf16 v[112:115], v[148:151], a[176:179], v[112:115]
    buffer_load_dwordx4 v3, s[32:35], s92 offen offset:2048  lds
    s_mul_i32 s89, s3, 5
    v_mfma_f32_16x16x32_bf16 v[116:119], v[148:151], a[192:195], v[116:119]
    v_add_u32 v12, s89, v6
    v_mul_u32_u24 v9, 144, v12
    v_mfma_f32_16x16x32_bf16 v[116:119], v[152:155], a[196:199], v[116:119]
    v_lshl_add_u32 v9, v19, 4, v9
    v_add_u32_e64 v9, 0, v9
    v_mfma_f32_16x16x32_bf16 v[120:123], v[152:155], a[212:215], v[120:123]
    v_lshrrev_b32 v13, 2, v12
    v_and_b32 v12, 3, v12
    v_mfma_f32_16x16x32_bf16 v[120:123], v[148:151], a[208:211], v[120:123]
    v_lshl_add_u32 v12, v13, 4, v12
    v_lshl_add_u32 v12, s83, 2, v12
    v_mfma_f32_16x16x32_bf16 v[124:127], v[148:151], a[224:227], v[124:127]
    s_waitcnt vmcnt(22)
    s_barrier
    v_mfma_f32_16x16x32_bf16 v[124:127], v[152:155], a[228:231], v[124:127]
    s_waitcnt lgkmcnt(0)
    ds_read_b64_tr_b16 v[148:149], v7 offset:16384
    v_mul_u32_u24 v12, 2560, v12
    v_mfma_f32_16x16x32_bf16 v[124:127], v[156:159], a[232:235], v[124:127]
    buffer_load_dwordx4 v4, s[32:35], s92 offen offset:3072  lds
    ds_read_b64_tr_b16 v[150:151], v7 offset:18432
    v_mfma_f32_16x16x32_bf16 v[124:127], v[160:163], a[236:239], v[124:127]
    s_add_u32 m0, s91, 65536
    ds_read_b64_tr_b16 v[152:153], v7 offset:20480
    s_add_u32 s92, s90, 1310720
    v_mfma_f32_16x16x32_bf16 v[120:123], v[160:163], a[220:223], v[120:123]
    ds_read_b64_tr_b16 v[154:155], v7 offset:22528
    v_lshl_add_u32 v12, v19, 4, v12
    v_mfma_f32_16x16x32_bf16 v[120:123], v[156:159], a[216:219], v[120:123]
    buffer_load_dwordx4 v1, s[32:35], s92 offen offset:0  lds
    v_cndmask_b32 v10, v23, v12, vcc
    v_mfma_f32_16x16x32_bf16 v[116:119], v[156:159], a[200:203], v[116:119]
    v_cmp_eq_u32 vcc, 0, v5
    v_mov_b32 v12, 0x3f80
    v_mfma_f32_16x16x32_bf16 v[116:119], v[160:163], a[204:207], v[116:119]
    v_mov_b32_e64 v13, 0x3f800000
    v_cndmask_b32 v80, 0, v12, vcc
    v_mfma_f32_16x16x32_bf16 v[112:115], v[160:163], a[188:191], v[112:115]
    v_cmp_eq_u32 vcc, 1, v5
    s_mul_i32 s89, s3, 20
    v_mfma_f32_16x16x32_bf16 v[112:115], v[156:159], a[184:187], v[112:115]
    v_add_u32 v6, s89, v6
    v_cndmask_b32 v80, v80, v13, vcc
    v_mfma_f32_16x16x32_bf16 v[108:111], v[156:159], a[168:171], v[108:111]
    buffer_load_dwordx4 v2, s[32:35], s92 offen offset:1024  lds
    v_cmp_eq_u32 vcc, 2, v5
    v_mfma_f32_16x16x32_bf16 v[108:111], v[160:163], a[172:175], v[108:111]
    s_waitcnt lgkmcnt(0)
    ds_read_b64_tr_b16 v[156:157], v7 offset:24576
    v_mul_u32_u24 v17, 144, v6
    v_mfma_f32_16x16x32_bf16 v[108:111], v[148:151], a[240:243], v[108:111]
    ds_read_b64_tr_b16 v[158:159], v7 offset:26624
    v_lshl_add_u32 v17, v19, 4, v17
    v_mfma_f32_16x16x32_bf16 v[108:111], v[152:155], a[244:247], v[108:111]
    ds_read_b64_tr_b16 v[160:161], v7 offset:28672
    v_cndmask_b32 v81, 0, v12, vcc
    v_mfma_f32_16x16x32_bf16 v[112:115], v[152:155], v[196:199], v[112:115]
    ds_read_b64_tr_b16 v[162:163], v7 offset:30720
    v_cmp_eq_u32 vcc, 3, v5
    v_mfma_f32_16x16x32_bf16 v[112:115], v[148:151], v[192:195], v[112:115]
    buffer_load_dwordx4 v3, s[32:35], s92 offen offset:2048  lds
    v_add_u32_e64 v17, 0, v17
    v_mfma_f32_16x16x32_bf16 v[116:119], v[148:151], v[208:211], v[116:119]
    v_mul_u32_u24 v18, 2560, v6
    v_cndmask_b32 v81, v81, v13, vcc
    v_mfma_f32_16x16x32_bf16 v[116:119], v[152:155], v[212:215], v[116:119]
    v_cmp_gt_u32 vcc, 32, v0
    v_lshl_add_u32 v18, v19, 4, v18
    v_mfma_f32_16x16x32_bf16 v[120:123], v[152:155], v[228:231], v[120:123]
    v_add_u32 v19, 40960, v18
    v_cndmask_b32 v19, v23, v19, vcc
    v_mfma_f32_16x16x32_bf16 v[120:123], v[148:151], v[224:227], v[120:123]
    s_cmp_lt_u32 s96, 96768
    s_cselect_b32 s88, s101, 0xfffeb000
    s_add_u32 s8, s96, s88
    v_mfma_f32_16x16x32_bf16 v[124:127], v[148:151], v[240:243], v[124:127]
    s_waitcnt vmcnt(22)
    s_barrier
    v_mfma_f32_16x16x32_bf16 v[124:127], v[152:155], v[244:247], v[124:127]
    s_waitcnt lgkmcnt(0)
    ds_read_b64_tr_b16 v[148:149], v8 offset:36864
    v_mfma_f32_16x16x32_bf16 v[124:127], v[156:159], v[248:251], v[124:127]
    buffer_load_dwordx4 v4, s[32:35], s92 offen offset:3072  lds
    ds_read_b64_tr_b16 v[150:151], v8 offset:38912
    v_mfma_f32_16x16x32_bf16 v[124:127], v[160:163], v[252:255], v[124:127]
    s_add_u32 m0, s91, 0
    ds_read_b64_tr_b16 v[152:153], v8 offset:40960
    s_add_u32 s92, s90, 2621440
    v_mfma_f32_16x16x32_bf16 v[120:123], v[160:163], v[236:239], v[120:123]
    s_cmp_lt_u32 s97, 96768
    s_cselect_b32 s88, s101, 0xfffeb000
    ds_read_b64_tr_b16 v[154:155], v8 offset:43008
    v_mfma_f32_16x16x32_bf16 v[120:123], v[156:159], v[232:235], v[120:123]
    buffer_load_dwordx4 v1, s[32:35], s92 offen offset:0  lds
    s_add_u32 s9, s97, s88
    v_mfma_f32_16x16x32_bf16 v[116:119], v[156:159], v[216:219], v[116:119]
    s_cmp_lt_u32 s8, 96768
    s_cselect_b32 s88, s101, 0xfffeb000
    s_add_u32 s10, s8, s88
    v_mfma_f32_16x16x32_bf16 v[116:119], v[160:163], v[220:223], v[116:119]
    s_cmp_lt_u32 s9, 96768
    s_cselect_b32 s88, s101, 0xfffeb000
    s_add_u32 s11, s9, s88
    v_mfma_f32_16x16x32_bf16 v[112:115], v[160:163], v[204:207], v[112:115]
    s_cmp_lt_u32 s10, 96768
    s_cselect_b32 s88, s101, 0xfffeb000
    s_add_u32 s12, s10, s88
    v_mfma_f32_16x16x32_bf16 v[112:115], v[156:159], v[200:203], v[112:115]
    s_cmp_lt_u32 s11, 96768
    s_cselect_b32 s88, s101, 0xfffeb000
    s_add_u32 s13, s11, s88
    v_mfma_f32_16x16x32_bf16 v[108:111], v[156:159], a[248:251], v[108:111]
    buffer_load_dwordx4 v2, s[32:35], s92 offen offset:1024  lds
    v_mfma_f32_16x16x32_bf16 v[108:111], v[160:163], a[252:255], v[108:111]
    s_waitcnt lgkmcnt(0)
    ds_read_b64_tr_b16 v[156:157], v8 offset:45056
    v_mfma_f32_16x16x32_bf16 v[128:131], v[148:151], a[0:3], 0
    ds_read_b64_tr_b16 v[158:159], v8 offset:47104
    v_cvt_pk_bf16_f32 v185, v126, v127
    v_mfma_f32_16x16x32_bf16 v[128:131], v[152:155], a[4:7], v[128:131]
    ds_read_b64_tr_b16 v[160:161], v8 offset:49152
    v_cvt_pk_bf16_f32 v184, v124, v125
    v_mfma_f32_16x16x32_bf16 v[132:135], v[152:155], a[20:23], 0
    ds_read_b64_tr_b16 v[162:163], v8 offset:51200
    v_cvt_pk_bf16_f32 v183, v122, v123
    v_mfma_f32_16x16x32_bf16 v[132:135], v[148:151], a[16:19], v[132:135]
    buffer_load_dwordx4 v3, s[32:35], s92 offen offset:2048  lds
    v_cvt_pk_bf16_f32 v182, v120, v121
    v_cvt_pk_bf16_f32 v181, v118, v119
    v_mfma_f32_16x16x32_bf16 v[136:139], v[148:151], a[32:35], 0
    v_cvt_pk_bf16_f32 v180, v116, v117
    v_cvt_pk_bf16_f32 v179, v114, v115
    v_mfma_f32_16x16x32_bf16 v[136:139], v[152:155], a[36:39], v[136:139]
    v_cvt_pk_bf16_f32 v178, v112, v113
    v_cvt_pk_bf16_f32 v177, v110, v111
    v_mfma_f32_16x16x32_bf16 v[140:143], v[152:155], a[52:55], 0
    s_cmp_lt_u32 s12, 96768
    s_cselect_b32 s88, s101, 0xfffeb000
    v_cvt_pk_bf16_f32 v176, v108, v109
    v_mfma_f32_16x16x32_bf16 v[140:143], v[148:151], a[48:51], v[140:143]
    s_add_u32 s14, s12, s88
    s_cmp_lt_u32 s13, 96768
    s_cselect_b32 s88, s101, 0xfffeb000
    v_mfma_f32_16x16x32_bf16 v[144:147], v[148:151], a[64:67], 0
    s_waitcnt vmcnt(15)
    s_barrier
    v_mfma_f32_16x16x32_bf16 v[144:147], v[152:155], a[68:71], v[144:147]
    s_waitcnt lgkmcnt(0)
    ds_read_b64_tr_b16 v[148:149], v7 offset:32768
    s_add_u32 s15, s13, s88
    v_mfma_f32_16x16x32_bf16 v[144:147], v[156:159], a[72:75], v[144:147]
    buffer_load_dwordx4 v4, s[32:35], s92 offen offset:3072  lds
    ds_read_b64_tr_b16 v[150:151], v7 offset:34816
    v_mfma_f32_16x16x32_bf16 v[144:147], v[160:163], a[76:79], v[144:147]
    ds_read_b64_tr_b16 v[152:153], v7 offset:36864
    v_mfma_f32_16x16x32_bf16 v[140:143], v[160:163], a[60:63], v[140:143]
    s_cmp_lt_u32 s14, 96768
    s_cselect_b32 s88, s101, 0xfffeb000
    ds_read_b64_tr_b16 v[154:155], v7 offset:38912
    v_mfma_f32_16x16x32_bf16 v[140:143], v[156:159], a[56:59], v[140:143]
    buffer_store_dword v188, v189, s[36:39], s100 offen offset:2560 sc1
    s_add_u32 s100, s100, 10752
    v_mfma_f32_16x16x32_bf16 v[136:139], v[156:159], a[40:43], v[136:139]
    buffer_store_dwordx4 v[176:179], v186, s[36:39], s93 offen sc1
    s_add_u32 s16, s14, s88
    v_mfma_f32_16x16x32_bf16 v[136:139], v[160:163], a[44:47], v[136:139]
    s_cmp_lt_u32 s15, 96768
    s_cselect_b32 s88, s101, 0xfffeb000
    s_add_u32 s17, s15, s88
    v_mfma_f32_16x16x32_bf16 v[132:135], v[160:163], a[28:31], v[132:135]
    buffer_store_dwordx4 v[180:183], v186, s[36:39], s93 offen offset:1024 sc1
    v_mfma_f32_16x16x32_bf16 v[132:135], v[156:159], a[24:27], v[132:135]
    s_cmp_lt_u32 s16, 96768
    s_cselect_b32 s88, s101, 0xfffeb000
    s_add_u32 s18, s16, s88
    v_mfma_f32_16x16x32_bf16 v[128:131], v[156:159], a[8:11], v[128:131]
    buffer_store_dwordx2 v[184:185], v187, s[36:39], s93 offen offset:2048 sc1
    s_add_u32 s93, s93, 10752
    v_mfma_f32_16x16x32_bf16 v[128:131], v[160:163], a[12:15], v[128:131]
    s_waitcnt lgkmcnt(0)
    ds_read_b64_tr_b16 v[156:157], v7 offset:40960
    s_add_u32 m0, s91, 81920
    v_mfma_f32_16x16x32_bf16 v[128:131], v[148:151], a[80:83], v[128:131]
    s_add_u32 s92, s90, 3932160
    ds_read_b64_tr_b16 v[158:159], v7 offset:43008
    s_add_u32 s90, s90, 128
    v_mfma_f32_16x16x32_bf16 v[128:131], v[152:155], a[84:87], v[128:131]
    s_sub_u32 s87, s90, 1280
    s_cselect_b32 s90, s90, s87
    ds_read_b64_tr_b16 v[160:161], v7 offset:45056
    v_mfma_f32_16x16x32_bf16 v[132:135], v[152:155], a[100:103], v[132:135]
    buffer_load_dwordx4 v1, s[32:35], s92 offen offset:0  lds
    ds_read_b64_tr_b16 v[162:163], v7 offset:47104
    v_mfma_f32_16x16x32_bf16 v[132:135], v[148:151], a[96:99], v[132:135]
    s_cmp_lt_u32 s17, 96768
    s_cselect_b32 s88, s101, 0xfffeb000
    s_add_u32 s19, s17, s88
    v_mfma_f32_16x16x32_bf16 v[136:139], v[148:151], a[112:115], v[136:139]
    s_cmp_lt_u32 s18, 96768
    s_cselect_b32 s88, s101, 0xfffeb000
    s_add_u32 s20, s18, s88
    v_mfma_f32_16x16x32_bf16 v[136:139], v[152:155], a[116:119], v[136:139]
    buffer_load_dwordx4 v2, s[32:35], s92 offen offset:1024  lds
    v_mfma_f32_16x16x32_bf16 v[140:143], v[152:155], a[132:135], v[140:143]
    s_cmp_lt_u32 s19, 96768
    s_cselect_b32 s88, s101, 0xfffeb000
    s_add_u32 s21, s19, s88
    v_mfma_f32_16x16x32_bf16 v[140:143], v[148:151], a[128:131], v[140:143]
    s_cmp_lt_u32 s20, 96768
    s_cselect_b32 s88, s101, 0xfffeb000
    s_add_u32 s22, s20, s88
    v_mfma_f32_16x16x32_bf16 v[144:147], v[148:151], a[144:147], v[144:147]
    s_barrier
    v_mfma_f32_16x16x32_bf16 v[144:147], v[152:155], a[148:151], v[144:147]
    s_waitcnt lgkmcnt(0)
    ds_read_b64_tr_b16 v[148:149], v11 offset:0
    v_mfma_f32_16x16x32_bf16 v[144:147], v[156:159], a[152:155], v[144:147]
    buffer_load_dwordx4 v3, s[32:35], s92 offen offset:2048  lds
    ds_read_b64_tr_b16 v[150:151], v11 offset:2048
    v_mfma_f32_16x16x32_bf16 v[144:147], v[160:163], a[156:159], v[144:147]
    s_cmp_lt_u32 s21, 96768
    s_cselect_b32 s88, s101, 0xfffeb000
    ds_read_b64_tr_b16 v[152:153], v11 offset:4096
    v_mfma_f32_16x16x32_bf16 v[140:143], v[160:163], a[140:143], v[140:143]
    s_add_u32 s23, s21, s88
    ds_read_b64_tr_b16 v[154:155], v11 offset:6144
    v_mfma_f32_16x16x32_bf16 v[140:143], v[156:159], a[136:139], v[140:143]
    v_mfma_f32_16x16x32_bf16 v[136:139], v[156:159], a[120:123], v[136:139]
    v_mfma_f32_16x16x32_bf16 v[136:139], v[160:163], a[124:127], v[136:139]
    buffer_load_dwordx4 v4, s[32:35], s92 offen offset:3072  lds
    s_add_u32 m0, s91, 16384
    v_mfma_f32_16x16x32_bf16 v[132:135], v[160:163], a[108:111], v[132:135]
    s_add_u32 s92, s90, 0
    v_mfma_f32_16x16x32_bf16 v[132:135], v[156:159], a[104:107], v[132:135]
    v_mfma_f32_16x16x32_bf16 v[128:131], v[156:159], a[88:91], v[128:131]
    v_mfma_f32_16x16x32_bf16 v[128:131], v[160:163], a[92:95], v[128:131]
    s_waitcnt lgkmcnt(0)
    ds_read_b64_tr_b16 v[156:157], v11 offset:8192
    v_mfma_f32_16x16x32_bf16 v[128:131], v[148:151], a[160:163], v[128:131]
    buffer_load_dwordx4 v1, s[32:35], s92 offen offset:0  lds
    ds_read_b64_tr_b16 v[158:159], v11 offset:10240
    v_mfma_f32_16x16x32_bf16 v[128:131], v[152:155], a[164:167], v[128:131]
    ds_read_b64_tr_b16 v[160:161], v11 offset:12288
    v_mfma_f32_16x16x32_bf16 v[132:135], v[152:155], a[180:183], v[132:135]
    ds_read_b64_tr_b16 v[162:163], v11 offset:14336
    v_mfma_f32_16x16x32_bf16 v[132:135], v[148:151], a[176:179], v[132:135]
    v_mfma_f32_16x16x32_bf16 v[136:139], v[148:151], a[192:195], v[136:139]
    v_mfma_f32_16x16x32_bf16 v[136:139], v[152:155], a[196:199], v[136:139]
    buffer_load_dwordx4 v2, s[32:35], s92 offen offset:1024  lds
    v_mfma_f32_16x16x32_bf16 v[140:143], v[152:155], a[212:215], v[140:143]
    v_mfma_f32_16x16x32_bf16 v[140:143], v[148:151], a[208:211], v[140:143]
    v_mfma_f32_16x16x32_bf16 v[144:147], v[148:151], a[224:227], v[144:147]
    s_waitcnt vmcnt(22)
    s_barrier
    v_mfma_f32_16x16x32_bf16 v[144:147], v[152:155], a[228:231], v[144:147]
    s_waitcnt lgkmcnt(0)
    ds_read_b64_tr_b16 v[148:149], v7 offset:49152
    v_mfma_f32_16x16x32_bf16 v[144:147], v[156:159], a[232:235], v[144:147]
    buffer_load_dwordx4 v3, s[32:35], s92 offen offset:2048  lds
    ds_read_b64_tr_b16 v[150:151], v7 offset:51200
    v_mfma_f32_16x16x32_bf16 v[144:147], v[160:163], a[236:239], v[144:147]
    ds_read_b64_tr_b16 v[152:153], v7 offset:53248
    v_mfma_f32_16x16x32_bf16 v[140:143], v[160:163], a[220:223], v[140:143]
    ds_read_b64_tr_b16 v[154:155], v7 offset:55296
    v_mfma_f32_16x16x32_bf16 v[140:143], v[156:159], a[216:219], v[140:143]
    v_mfma_f32_16x16x32_bf16 v[136:139], v[156:159], a[200:203], v[136:139]
    buffer_load_dwordx4 v4, s[32:35], s92 offen offset:3072  lds
    s_add_u32 m0, s91, 102400
    v_mfma_f32_16x16x32_bf16 v[136:139], v[160:163], a[204:207], v[136:139]
    s_add_u32 s92, s90, 1310720
    v_mfma_f32_16x16x32_bf16 v[132:135], v[160:163], a[188:191], v[132:135]
    v_mfma_f32_16x16x32_bf16 v[132:135], v[156:159], a[184:187], v[132:135]
    v_mfma_f32_16x16x32_bf16 v[128:131], v[156:159], a[168:171], v[128:131]
    v_mfma_f32_16x16x32_bf16 v[128:131], v[160:163], a[172:175], v[128:131]
    s_waitcnt lgkmcnt(0)
    ds_read_b64_tr_b16 v[156:157], v7 offset:57344
    v_mfma_f32_16x16x32_bf16 v[128:131], v[148:151], a[240:243], v[128:131]
    buffer_load_dwordx4 v1, s[32:35], s92 offen offset:0  lds
    ds_read_b64_tr_b16 v[158:159], v7 offset:59392
    v_mfma_f32_16x16x32_bf16 v[128:131], v[152:155], a[244:247], v[128:131]
    ds_read_b64_tr_b16 v[160:161], v7 offset:61440
    v_mfma_f32_16x16x32_bf16 v[132:135], v[152:155], v[196:199], v[132:135]
    ds_read_b64_tr_b16 v[162:163], v7 offset:63488
    v_mfma_f32_16x16x32_bf16 v[132:135], v[148:151], v[192:195], v[132:135]
    v_mfma_f32_16x16x32_bf16 v[136:139], v[148:151], v[208:211], v[136:139]
    buffer_load_dwordx4 v2, s[32:35], s92 offen offset:1024  lds
    v_mfma_f32_16x16x32_bf16 v[136:139], v[152:155], v[212:215], v[136:139]
    v_mfma_f32_16x16x32_bf16 v[140:143], v[152:155], v[228:231], v[140:143]
    v_mfma_f32_16x16x32_bf16 v[140:143], v[148:151], v[224:227], v[140:143]
    v_mfma_f32_16x16x32_bf16 v[144:147], v[148:151], v[240:243], v[144:147]
    s_waitcnt vmcnt(22)
    s_barrier
    v_mfma_f32_16x16x32_bf16 v[144:147], v[152:155], v[244:247], v[144:147]
    s_waitcnt lgkmcnt(0)
    ds_read_b64_tr_b16 v[148:149], v11 offset:20480
    v_mfma_f32_16x16x32_bf16 v[144:147], v[156:159], v[248:251], v[144:147]
    buffer_load_dwordx4 v3, s[32:35], s92 offen offset:2048  lds
    ds_read_b64_tr_b16 v[150:151], v11 offset:22528
    v_mfma_f32_16x16x32_bf16 v[144:147], v[160:163], v[252:255], v[144:147]
    ds_read_b64_tr_b16 v[152:153], v11 offset:24576
    v_mfma_f32_16x16x32_bf16 v[140:143], v[160:163], v[236:239], v[140:143]
    ds_read_b64_tr_b16 v[154:155], v11 offset:26624
    v_mfma_f32_16x16x32_bf16 v[140:143], v[156:159], v[232:235], v[140:143]
    buffer_load_dwordx4 v4, s[32:35], s92 offen offset:3072  lds
    s_add_u32 m0, s91, 32768
    v_mfma_f32_16x16x32_bf16 v[136:139], v[156:159], v[216:219], v[136:139]
    s_add_u32 s92, s90, 2621440
    v_mfma_f32_16x16x32_bf16 v[136:139], v[160:163], v[220:223], v[136:139]
    v_mfma_f32_16x16x32_bf16 v[132:135], v[160:163], v[204:207], v[132:135]
    v_mfma_f32_16x16x32_bf16 v[132:135], v[156:159], v[200:203], v[132:135]
    v_mfma_f32_16x16x32_bf16 v[128:131], v[156:159], a[248:251], v[128:131]
    buffer_load_dwordx4 v1, s[32:35], s92 offen offset:0  lds
    v_mfma_f32_16x16x32_bf16 v[128:131], v[160:163], a[252:255], v[128:131]
    s_waitcnt lgkmcnt(0)
    ds_read_b64_tr_b16 v[156:157], v11 offset:28672
    v_mfma_f32_16x16x32_bf16 v[108:111], v[148:151], a[0:3], 0
    ds_read_b64_tr_b16 v[158:159], v11 offset:30720
    v_cvt_pk_bf16_f32 v173, v146, v147
    v_mfma_f32_16x16x32_bf16 v[108:111], v[152:155], a[4:7], v[108:111]
    ds_read_b64_tr_b16 v[160:161], v11 offset:32768
    v_mfma_f32_16x16x32_bf16 v[112:115], v[152:155], a[20:23], 0
    ds_read_b64_tr_b16 v[162:163], v11 offset:34816
    v_cmp_gt_u32 vcc, 8, v82
    v_mfma_f32_16x16x32_bf16 v[112:115], v[148:151], a[16:19], v[112:115]
    buffer_load_dwordx4 v2, s[32:35], s92 offen offset:1024  lds
    v_cvt_pk_bf16_f32 v172, v144, v145
    v_cvt_pk_bf16_f32 v171, v142, v143
    v_mfma_f32_16x16x32_bf16 v[116:119], v[148:151], a[32:35], 0
    v_cvt_pk_bf16_f32 v170, v140, v141
    v_cvt_pk_bf16_f32 v169, v138, v139
    v_mfma_f32_16x16x32_bf16 v[116:119], v[152:155], a[36:39], v[116:119]
    v_cvt_pk_bf16_f32 v168, v136, v137
    v_cvt_pk_bf16_f32 v167, v134, v135
    v_mfma_f32_16x16x32_bf16 v[120:123], v[152:155], a[52:55], 0
    s_cbranch_vccnz L_retry13
L_back13:
    v_mfma_f32_16x16x32_bf16 v[120:123], v[148:151], a[48:51], v[120:123]
    v_cvt_pk_bf16_f32 v166, v132, v133
    v_cvt_pk_bf16_f32 v165, v130, v131
    v_mfma_f32_16x16x32_bf16 v[124:127], v[148:151], a[64:67], 0
    s_waitcnt vmcnt(14)
    s_barrier
    v_mfma_f32_16x16x32_bf16 v[124:127], v[152:155], a[68:71], v[124:127]
    s_waitcnt lgkmcnt(0)
    ds_read_b64_tr_b16 v[148:149], v8 offset:0
    v_cvt_pk_bf16_f32 v164, v128, v129
    v_mfma_f32_16x16x32_bf16 v[124:127], v[156:159], a[72:75], v[124:127]
    buffer_load_dwordx4 v3, s[32:35], s92 offen offset:2048  lds
    ds_read_b64_tr_b16 v[150:151], v8 offset:2048
    v_mfma_f32_16x16x32_bf16 v[124:127], v[160:163], a[76:79], v[124:127]
    ds_read_b64_tr_b16 v[152:153], v8 offset:4096
    v_mfma_f32_16x16x32_bf16 v[120:123], v[160:163], a[60:63], v[120:123]
    ds_read_b64_tr_b16 v[154:155], v8 offset:6144
    v_mfma_f32_16x16x32_bf16 v[120:123], v[156:159], a[56:59], v[120:123]
    buffer_store_dword v188, v189, s[36:39], s100 offen offset:2560 sc1
    s_add_u32 s100, s100, 10752
    v_mfma_f32_16x16x32_bf16 v[116:119], v[156:159], a[40:43], v[116:119]
    buffer_store_dwordx4 v[164:167], v186, s[36:39], s93 offen sc1
    v_mfma_f32_16x16x32_bf16 v[116:119], v[160:163], a[44:47], v[116:119]
    v_mfma_f32_16x16x32_bf16 v[112:115], v[160:163], a[28:31], v[112:115]
    buffer_store_dwordx4 v[168:171], v186, s[36:39], s93 offen offset:1024 sc1
    v_mfma_f32_16x16x32_bf16 v[112:115], v[156:159], a[24:27], v[112:115]
    v_mfma_f32_16x16x32_bf16 v[108:111], v[156:159], a[8:11], v[108:111]
    buffer_store_dwordx2 v[172:173], v187, s[36:39], s93 offen offset:2048 sc1
    s_add_u32 s93, s93, 10752
    v_mfma_f32_16x16x32_bf16 v[108:111], v[160:163], a[12:15], v[108:111]
    s_waitcnt lgkmcnt(0)
    ds_read_b64_tr_b16 v[156:157], v8 offset:8192
    v_mfma_f32_16x16x32_bf16 v[108:111], v[148:151], a[80:83], v[108:111]
    buffer_load_dword v82, v191, s[36:39], s96 offen offset:2560 sc1
    ds_read_b64_tr_b16 v[158:159], v8 offset:10240
    v_mfma_f32_16x16x32_bf16 v[108:111], v[152:155], a[84:87], v[108:111]
    buffer_load_dword v83, v191, s[36:39], s97 offen offset:2560 sc1
    ds_read_b64_tr_b16 v[160:161], v8 offset:12288
    v_mfma_f32_16x16x32_bf16 v[112:115], v[152:155], a[100:103], v[112:115]
    buffer_load_dwordx4 v4, s[32:35], s92 offen offset:3072  lds
    ds_read_b64_tr_b16 v[162:163], v8 offset:14336
    v_mfma_f32_16x16x32_bf16 v[112:115], v[148:151], a[96:99], v[112:115]
    s_add_u32 m0, s91, 122880
    s_add_u32 s92, s90, 3932160
    s_add_u32 s90, s90, 128
    v_mfma_f32_16x16x32_bf16 v[116:119], v[148:151], a[112:115], v[116:119]
    s_sub_u32 s87, s90, 1280
    s_cselect_b32 s90, s90, s87
    v_mfma_f32_16x16x32_bf16 v[116:119], v[152:155], a[116:119], v[116:119]
    buffer_load_dwordx4 v1, s[32:35], s92 offen offset:0  lds
    v_mfma_f32_16x16x32_bf16 v[120:123], v[152:155], a[132:135], v[120:123]
    v_mfma_f32_16x16x32_bf16 v[120:123], v[148:151], a[128:131], v[120:123]
    v_mfma_f32_16x16x32_bf16 v[124:127], v[148:151], a[144:147], v[124:127]
    s_barrier
    v_mfma_f32_16x16x32_bf16 v[124:127], v[152:155], a[148:151], v[124:127]
    s_waitcnt lgkmcnt(0)
    ds_read_b64_tr_b16 v[148:149], v7 offset:0
    v_mfma_f32_16x16x32_bf16 v[124:127], v[156:159], a[152:155], v[124:127]
    buffer_load_dwordx4 v2, s[32:35], s92 offen offset:1024  lds
    ds_read_b64_tr_b16 v[150:151], v7 offset:2048
    v_mfma_f32_16x16x32_bf16 v[124:127], v[160:163], a[156:159], v[124:127]
    ds_read_b64_tr_b16 v[152:153], v7 offset:4096
    v_mfma_f32_16x16x32_bf16 v[120:123], v[160:163], a[140:143], v[120:123]
    ds_read_b64_tr_b16 v[154:155], v7 offset:6144
    v_mfma_f32_16x16x32_bf16 v[120:123], v[156:159], a[136:139], v[120:123]
    v_mfma_f32_16x16x32_bf16 v[116:119], v[156:159], a[120:123], v[116:119]
    v_mfma_f32_16x16x32_bf16 v[116:119], v[160:163], a[124:127], v[116:119]
    buffer_load_dwordx4 v3, s[32:35], s92 offen offset:2048  lds
    v_mfma_f32_16x16x32_bf16 v[112:115], v[160:163], a[108:111], v[112:115]
    v_mfma_f32_16x16x32_bf16 v[112:115], v[156:159], a[104:107], v[112:115]
    v_mfma_f32_16x16x32_bf16 v[108:111], v[156:159], a[88:91], v[108:111]
    v_mfma_f32_16x16x32_bf16 v[108:111], v[160:163], a[92:95], v[108:111]
    s_waitcnt lgkmcnt(0)
    ds_read_b64_tr_b16 v[156:157], v7 offset:8192
    v_mfma_f32_16x16x32_bf16 v[108:111], v[148:151], a[160:163], v[108:111]
    buffer_load_dwordx4 v4, s[32:35], s92 offen offset:3072  lds
    ds_read_b64_tr_b16 v[158:159], v7 offset:10240
    v_mfma_f32_16x16x32_bf16 v[108:111], v[152:155], a[164:167], v[108:111]
    s_add_u32 m0, s91, 49152
    ds_read_b64_tr_b16 v[160:161], v7 offset:12288
    s_add_u32 s92, s90, 0
    v_mfma_f32_16x16x32_bf16 v[112:115], v[152:155], a[180:183], v[112:115]
    ds_read_b64_tr_b16 v[162:163], v7 offset:14336
    v_mfma_f32_16x16x32_bf16 v[112:115], v[148:151], a[176:179], v[112:115]
    v_mfma_f32_16x16x32_bf16 v[116:119], v[148:151], a[192:195], v[116:119]
    v_mfma_f32_16x16x32_bf16 v[116:119], v[152:155], a[196:199], v[116:119]
    buffer_load_dwordx4 v1, s[32:35], s92 offen offset:0  lds
    v_mfma_f32_16x16x32_bf16 v[120:123], v[152:155], a[212:215], v[120:123]
    v_mfma_f32_16x16x32_bf16 v[120:123], v[148:151], a[208:211], v[120:123]
    v_mfma_f32_16x16x32_bf16 v[124:127], v[148:151], a[224:227], v[124:127]
    s_waitcnt vmcnt(23)
    s_barrier
    v_mfma_f32_16x16x32_bf16 v[124:127], v[152:155], a[228:231], v[124:127]
    s_waitcnt lgkmcnt(0)
    ds_read_b64_tr_b16 v[148:149], v8 offset:16384
    v_mfma_f32_16x16x32_bf16 v[124:127], v[156:159], a[232:235], v[124:127]
    buffer_load_dwordx4 v2, s[32:35], s92 offen offset:1024  lds
    ds_read_b64_tr_b16 v[150:151], v8 offset:18432
    v_mfma_f32_16x16x32_bf16 v[124:127], v[160:163], a[236:239], v[124:127]
    ds_read_b64_tr_b16 v[152:153], v8 offset:20480
    v_mfma_f32_16x16x32_bf16 v[120:123], v[160:163], a[220:223], v[120:123]
    ds_read_b64_tr_b16 v[154:155], v8 offset:22528
    v_mfma_f32_16x16x32_bf16 v[120:123], v[156:159], a[216:219], v[120:123]
    v_mfma_f32_16x16x32_bf16 v[116:119], v[156:159], a[200:203], v[116:119]
    buffer_load_dwordx4 v3, s[32:35], s92 offen offset:2048  lds
    v_mfma_f32_16x16x32_bf16 v[116:119], v[160:163], a[204:207], v[116:119]
    v_mfma_f32_16x16x32_bf16 v[112:115], v[160:163], a[188:191], v[112:115]
    v_mfma_f32_16x16x32_bf16 v[112:115], v[156:159], a[184:187], v[112:115]
    v_mfma_f32_16x16x32_bf16 v[108:111], v[156:159], a[168:171], v[108:111]
    v_mfma_f32_16x16x32_bf16 v[108:111], v[160:163], a[172:175], v[108:111]
    s_waitcnt lgkmcnt(0)
L_pad7:
    s_cbranch_execz L_pad11
    ds_read_b64_tr_b16 v[156:157], v8 offset:24576
    v_mfma_f32_16x16x32_bf16 v[108:111], v[148:151], a[240:243], v[108:111]
    buffer_load_dwordx4 v4, s[32:35], s92 offen offset:3072  lds
    ds_read_b64_tr_b16 v[158:159], v8 offset:26624
    v_mfma_f32_16x16x32_bf16 v[108:111], v[152:155], a[244:247], v[108:111]
    s_add_u32 m0, s91, 143360
    ds_read_b64_tr_b16 v[160:161], v8 offset:28672
    s_add_u32 s92, s90, 1310720
    v_mfma_f32_16x16x32_bf16 v[112:115], v[152:155], v[196:199], v[112:115]
    ds_read_b64_tr_b16 v[162:163], v8 offset:30720
    v_mfma_f32_16x16x32_bf16 v[112:115], v[148:151], v[192:195], v[112:115]
    v_mfma_f32_16x16x32_bf16 v[116:119], v[148:151], v[208:211], v[116:119]
    buffer_load_dwordx4 v1, s[32:35], s92 offen offset:0  lds
    v_mfma_f32_16x16x32_bf16 v[116:119], v[152:155], v[212:215], v[116:119]
    v_mfma_f32_16x16x32_bf16 v[120:123], v[152:155], v[228:231], v[120:123]
    v_mfma_f32_16x16x32_bf16 v[120:123], v[148:151], v[224:227], v[120:123]
    v_mfma_f32_16x16x32_bf16 v[124:127], v[148:151], v[240:243], v[124:127]
    s_waitcnt vmcnt(23)
    s_barrier
    v_mfma_f32_16x16x32_bf16 v[124:127], v[152:155], v[244:247], v[124:127]
    s_waitcnt lgkmcnt(0)
    ds_read_b64_tr_b16 v[148:149], v7 offset:16384
    v_mfma_f32_16x16x32_bf16 v[124:127], v[156:159], v[248:251], v[124:127]
    buffer_load_dwordx4 v2, s[32:35], s92 offen offset:1024  lds
    ds_read_b64_tr_b16 v[150:151], v7 offset:18432
    v_mfma_f32_16x16x32_bf16 v[124:127], v[160:163], v[252:255], v[124:127]
    ds_read_b64_tr_b16 v[152:153], v7 offset:20480
    v_mfma_f32_16x16x32_bf16 v[120:123], v[160:163], v[236:239], v[120:123]
    ds_read_b64_tr_b16 v[154:155], v7 offset:22528
    v_mfma_f32_16x16x32_bf16 v[120:123], v[156:159], v[232:235], v[120:123]
    buffer_load_dwordx4 v3, s[32:35], s92 offen offset:2048  lds
    v_mfma_f32_16x16x32_bf16 v[116:119], v[156:159], v[216:219], v[116:119]
    v_mfma_f32_16x16x32_bf16 v[116:119], v[160:163], v[220:223], v[116:119]
    v_mfma_f32_16x16x32_bf16 v[112:115], v[160:163], v[204:207], v[112:115]
    v_mfma_f32_16x16x32_bf16 v[112:115], v[156:159], v[200:203], v[112:115]
    v_mfma_f32_16x16x32_bf16 v[108:111], v[156:159], a[248:251], v[108:111]
    buffer_load_dwordx4 v4, s[32:35], s92 offen offset:3072  lds
    s_add_u32 m0, s91, 65536
    v_mfma_f32_16x16x32_bf16 v[108:111], v[160:163], a[252:255], v[108:111]
    s_waitcnt lgkmcnt(0)
    ds_read_b64_tr_b16 v[156:157], v7 offset:24576
    s_add_u32 s92, s90, 2621440
    v_mfma_f32_16x16x32_bf16 v[128:131], v[148:151], a[0:3], 0
    ds_read_b64_tr_b16 v[158:159], v7 offset:26624
    v_cvt_pk_bf16_f32 v185, v126, v127
    v_mfma_f32_16x16x32_bf16 v[128:131], v[152:155], a[4:7], v[128:131]
    ds_read_b64_tr_b16 v[160:161], v7 offset:28672
    s_waitcnt vmcnt(13)
    v_mfma_f32_16x16x32_bf16 v[132:135], v[152:155], a[20:23], 0
    ds_read_b64_tr_b16 v[162:163], v7 offset:30720
    v_or_b32_e64 v82, v82, v83
    v_mfma_f32_16x16x32_bf16 v[132:135], v[148:151], a[16:19], v[132:135]
    buffer_load_dwordx4 v1, s[32:35], s92 offen offset:0  lds
    v_cmp_ne_u32 vcc, 0, v82
    v_cvt_pk_bf16_f32 v184, v124, v125
    v_mfma_f32_16x16x32_bf16 v[136:139], v[148:151], a[32:35], 0
    v_cvt_pk_bf16_f32 v183, v122, v123
    v_cvt_pk_bf16_f32 v182, v120, v121
    v_mfma_f32_16x16x32_bf16 v[136:139], v[152:155], a[36:39], v[136:139]
    v_cvt_pk_bf16_f32 v181, v118, v119
    v_cvt_pk_bf16_f32 v180, v116, v117
    v_mfma_f32_16x16x32_bf16 v[140:143], v[152:155], a[52:55], 0
    s_cbranch_vccnz L_retry14
L_back14:
    v_mfma_f32_16x16x32_bf16 v[140:143], v[148:151], a[48:51], v[140:143]
    v_cvt_pk_bf16_f32 v179, v114, v115
    v_cvt_pk_bf16_f32 v178, v112, v113
    v_mfma_f32_16x16x32_bf16 v[144:147], v[148:151], a[64:67], 0
    s_barrier
    v_mfma_f32_16x16x32_bf16 v[144:147], v[152:155], a[68:71], v[144:147]
    s_waitcnt lgkmcnt(0)
    ds_read_b64_tr_b16 v[148:149], v8 offset:36864
    v_cvt_pk_bf16_f32 v177, v110, v111
    v_cvt_pk_bf16_f32 v176, v108, v109
    v_mfma_f32_16x16x32_bf16 v[144:147], v[156:159], a[72:75], v[144:147]
    buffer_load_dwordx4 v2, s[32:35], s92 offen offset:1024  lds
    ds_read_b64_tr_b16 v[150:151], v8 offset:38912
    v_mfma_f32_16x16x32_bf16 v[144:147], v[160:163], a[76:79], v[144:147]
    ds_read_b64_tr_b16 v[152:153], v8 offset:40960
    v_mfma_f32_16x16x32_bf16 v[140:143], v[160:163], a[60:63], v[140:143]
    ds_read_b64_tr_b16 v[154:155], v8 offset:43008
    v_mfma_f32_16x16x32_bf16 v[140:143], v[156:159], a[56:59], v[140:143]
    buffer_store_dword v188, v189, s[36:39], s100 offen offset:2560 sc1
    s_add_u32 s100, s100, 10752
    v_mfma_f32_16x16x32_bf16 v[136:139], v[156:159], a[40:43], v[136:139]
    buffer_load_dwordx4 v[32:35], v186, s[36:39], s96 offen sc1
    v_mfma_f32_16x16x32_bf16 v[136:139], v[160:163], a[44:47], v[136:139]
    v_mfma_f32_16x16x32_bf16 v[132:135], v[160:163], a[28:31], v[132:135]
    buffer_load_dwordx4 v[36:39], v186, s[36:39], s96 offen offset:1024 sc1
    v_mfma_f32_16x16x32_bf16 v[132:135], v[156:159], a[24:27], v[132:135]
    v_mfma_f32_16x16x32_bf16 v[128:131], v[156:159], a[8:11], v[128:131]
    buffer_load_dwordx2 v[40:41], v187, s[36:39], s96 offen offset:2048 sc1
    v_mfma_f32_16x16x32_bf16 v[128:131], v[160:163], a[12:15], v[128:131]
    s_waitcnt lgkmcnt(0)
    ds_read_b64_tr_b16 v[156:157], v8 offset:45056
    v_mfma_f32_16x16x32_bf16 v[128:131], v[148:151], a[80:83], v[128:131]
    buffer_load_dwordx4 v[44:47], v86, s[36:39], s97 offen sc1
    ds_read_b64_tr_b16 v[158:159], v8 offset:47104
    v_mfma_f32_16x16x32_bf16 v[128:131], v[152:155], a[84:87], v[128:131]
    buffer_store_dwordx4 v[176:179], v186, s[36:39], s93 offen sc1
    ds_read_b64_tr_b16 v[160:161], v8 offset:49152
    v_mfma_f32_16x16x32_bf16 v[132:135], v[152:155], a[100:103], v[132:135]
    ds_read_b64_tr_b16 v[162:163], v8 offset:51200
    v_mfma_f32_16x16x32_bf16 v[132:135], v[148:151], a[96:99], v[132:135]
    buffer_store_dwordx4 v[180:183], v186, s[36:39], s93 offen offset:1024 sc1
    v_mfma_f32_16x16x32_bf16 v[136:139], v[148:151], a[112:115], v[136:139]
    v_mfma_f32_16x16x32_bf16 v[136:139], v[152:155], a[116:119], v[136:139]
    buffer_store_dwordx2 v[184:185], v187, s[36:39], s93 offen offset:2048 sc1
    s_add_u32 s93, s93, 10752
    v_mfma_f32_16x16x32_bf16 v[140:143], v[152:155], a[132:135], v[140:143]
    buffer_load_dword v85, v191, s[36:39], s8 offen offset:2560 sc1
    v_mfma_f32_16x16x32_bf16 v[140:143], v[148:151], a[128:131], v[140:143]
    buffer_load_dword v87, v191, s[36:39], s9 offen offset:2560 sc1
    buffer_load_dwordx4 v3, s[32:35], s92 offen offset:2048  lds
    v_mfma_f32_16x16x32_bf16 v[144:147], v[148:151], a[144:147], v[144:147]
    s_waitcnt vmcnt(25)
    s_barrier
    v_mfma_f32_16x16x32_bf16 v[144:147], v[152:155], a[148:151], v[144:147]
    s_waitcnt lgkmcnt(0)
    ds_read_b64_tr_b16 v[148:149], v7 offset:32768
    v_mfma_f32_16x16x32_bf16 v[144:147], v[156:159], a[152:155], v[144:147]
    ds_read_b64_tr_b16 v[150:151], v7 offset:34816
    v_mfma_f32_16x16x32_bf16 v[144:147], v[160:163], a[156:159], v[144:147]
    ds_read_b64_tr_b16 v[152:153], v7 offset:36864
    v_mfma_f32_16x16x32_bf16 v[140:143], v[160:163], a[140:143], v[140:143]
    buffer_load_dwordx4 v4, s[32:35], s92 offen offset:3072  lds
    ds_read_b64_tr_b16 v[154:155], v7 offset:38912
    v_mfma_f32_16x16x32_bf16 v[140:143], v[156:159], a[136:139], v[140:143]
    s_add_u32 m0, s91, 0
    s_add_u32 s92, s90, 3932160
    s_add_u32 s90, s90, 128
    v_mfma_f32_16x16x32_bf16 v[136:139], v[156:159], a[120:123], v[136:139]
    s_sub_u32 s87, s90, 1280
    s_cselect_b32 s90, s90, s87
    v_mfma_f32_16x16x32_bf16 v[136:139], v[160:163], a[124:127], v[136:139]
    v_mfma_f32_16x16x32_bf16 v[132:135], v[160:163], a[108:111], v[132:135]
    v_mfma_f32_16x16x32_bf16 v[132:135], v[156:159], a[104:107], v[132:135]
    buffer_load_dwordx4 v1, s[32:35], s92 offen offset:0  lds
    v_mfma_f32_16x16x32_bf16 v[128:131], v[156:159], a[88:91], v[128:131]
    v_mfma_f32_16x16x32_bf16 v[128:131], v[160:163], a[92:95], v[128:131]
    s_waitcnt lgkmcnt(0)
    ds_read_b64_tr_b16 v[156:157], v7 offset:40960
    v_mfma_f32_16x16x32_bf16 v[128:131], v[148:151], a[160:163], v[128:131]
    ds_read_b64_tr_b16 v[158:159], v7 offset:43008
    v_mfma_f32_16x16x32_bf16 v[128:131], v[152:155], a[164:167], v[128:131]
    ds_read_b64_tr_b16 v[160:161], v7 offset:45056
    v_mfma_f32_16x16x32_bf16 v[132:135], v[152:155], a[180:183], v[132:135]
    buffer_load_dwordx4 v2, s[32:35], s92 offen offset:1024  lds
    ds_read_b64_tr_b16 v[162:163], v7 offset:47104
    v_mfma_f32_16x16x32_bf16 v[132:135], v[148:151], a[176:179], v[132:135]
    v_mfma_f32_16x16x32_bf16 v[136:139], v[148:151], a[192:195], v[136:139]
    v_mfma_f32_16x16x32_bf16 v[136:139], v[152:155], a[196:199], v[136:139]
    v_mfma_f32_16x16x32_bf16 v[140:143], v[152:155], a[212:215], v[140:143]
    v_mfma_f32_16x16x32_bf16 v[140:143], v[148:151], a[208:211], v[140:143]
    buffer_load_dwordx4 v3, s[32:35], s92 offen offset:2048  lds
    v_mfma_f32_16x16x32_bf16 v[144:147], v[148:151], a[224:227], v[144:147]
    s_waitcnt vmcnt(25)
    s_barrier
    v_mfma_f32_16x16x32_bf16 v[144:147], v[152:155], a[228:231], v[144:147]
    s_waitcnt lgkmcnt(0)
    ds_read_b64_tr_b16 v[148:149], v11 offset:0
    v_mfma_f32_16x16x32_bf16 v[144:147], v[156:159], a[232:235], v[144:147]
    ds_read_b64_tr_b16 v[150:151], v11 offset:2048
    v_mfma_f32_16x16x32_bf16 v[144:147], v[160:163], a[236:239], v[144:147]
    buffer_load_dwordx4 v4, s[32:35], s92 offen offset:3072  lds
    ds_read_b64_tr_b16 v[152:153], v11 offset:4096
    v_mfma_f32_16x16x32_bf16 v[140:143], v[160:163], a[220:223], v[140:143]
    s_add_u32 m0, s91, 81920
    ds_read_b64_tr_b16 v[154:155], v11 offset:6144
    s_add_u32 s92, s90, 0
    v_mfma_f32_16x16x32_bf16 v[140:143], v[156:159], a[216:219], v[140:143]
    v_mfma_f32_16x16x32_bf16 v[136:139], v[156:159], a[200:203], v[136:139]
    v_mfma_f32_16x16x32_bf16 v[136:139], v[160:163], a[204:207], v[136:139]
    v_mfma_f32_16x16x32_bf16 v[132:135], v[160:163], a[188:191], v[132:135]
    buffer_load_dwordx4 v1, s[32:35], s92 offen offset:0  lds
    v_mfma_f32_16x16x32_bf16 v[132:135], v[156:159], a[184:187], v[132:135]
    v_mfma_f32_16x16x32_bf16 v[128:131], v[156:159], a[168:171], v[128:131]
    v_mfma_f32_16x16x32_bf16 v[128:131], v[160:163], a[172:175], v[128:131]
    s_waitcnt lgkmcnt(0)
    ds_read_b64_tr_b16 v[156:157], v11 offset:8192
    v_mfma_f32_16x16x32_bf16 v[128:131], v[148:151], a[240:243], v[128:131]
    ds_read_b64_tr_b16 v[158:159], v11 offset:10240
    v_mfma_f32_16x16x32_bf16 v[128:131], v[152:155], a[244:247], v[128:131]
    buffer_load_dwordx4 v2, s[32:35], s92 offen offset:1024  lds
    ds_read_b64_tr_b16 v[160:161], v11 offset:12288
    v_mfma_f32_16x16x32_bf16 v[132:135], v[152:155], v[196:199], v[132:135]
    ds_read_b64_tr_b16 v[162:163], v11 offset:14336
    v_mfma_f32_16x16x32_bf16 v[132:135], v[148:151], v[192:195], v[132:135]
    v_mfma_f32_16x16x32_bf16 v[136:139], v[148:151], v[208:211], v[136:139]
    v_mfma_f32_16x16x32_bf16 v[136:139], v[152:155], v[212:215], v[136:139]
    v_mfma_f32_16x16x32_bf16 v[140:143], v[152:155], v[228:231], v[140:143]
    buffer_load_dwordx4 v3, s[32:35], s92 offen offset:2048  lds
    v_mfma_f32_16x16x32_bf16 v[140:143], v[148:151], v[224:227], v[140:143]
    v_mfma_f32_16x16x32_bf16 v[144:147], v[148:151], v[240:243], v[144:147]
    s_waitcnt vmcnt(25)
    s_barrier
    v_mfma_f32_16x16x32_bf16 v[144:147], v[152:155], v[244:247], v[144:147]
    s_waitcnt lgkmcnt(0)
    ds_read_b64_tr_b16 v[148:149], v7 offset:49152
    s_waitcnt vmcnt(14)
    v_mfma_f32_16x16x16_bf16 v[24:27], v[80:81], v[44:45], 0
    v_mfma_f32_16x16x16_bf16 v[88:91], v[80:81], v[32:33], 0
    buffer_load_dwordx4 v4, s[32:35], s92 offen offset:3072  lds
    s_add_u32 m0, s91, 16384
    v_mfma_f32_16x16x16_bf16 v[92:95], v[80:81], v[34:35], 0
    s_add_u32 s92, s90, 1310720
    v_mfma_f32_16x16x16_bf16 v[96:99], v[80:81], v[36:37], 0
    v_mfma_f32_16x16x16_bf16 v[100:103], v[80:81], v[38:39], 0
    v_mfma_f32_16x16x16_bf16 v[104:107], v[80:81], v[40:41], 0
    buffer_load_dwordx4 v1, s[32:35], s92 offen offset:0  lds
    v_mfma_f32_16x16x16_bf16 v[28:31], v[80:81], v[46:47], 0
    v_mfma_f32_16x16x32_bf16 v[144:147], v[156:159], v[248:251], v[144:147]
    ds_read_b64_tr_b16 v[150:151], v7 offset:51200
    v_mfma_f32_16x16x32_bf16 v[144:147], v[160:163], v[252:255], v[144:147]
    ds_read_b64_tr_b16 v[152:153], v7 offset:53248
    v_mfma_f32_16x16x32_bf16 v[140:143], v[160:163], v[236:239], v[140:143]
    ds_read_b64_tr_b16 v[154:155], v7 offset:55296
    v_mfma_f32_16x16x32_bf16 v[140:143], v[156:159], v[232:235], v[140:143]
    buffer_load_dwordx4 v2, s[32:35], s92 offen offset:1024  lds
    v_mfma_f32_16x16x32_bf16 v[136:139], v[156:159], v[216:219], v[136:139]
    v_mfma_f32_16x16x32_bf16 v[136:139], v[160:163], v[220:223], v[136:139]
    v_mfma_f32_16x16x32_bf16 v[132:135], v[160:163], v[204:207], v[132:135]
    v_mfma_f32_16x16x32_bf16 v[132:135], v[156:159], v[200:203], v[132:135]
    v_mfma_f32_16x16x32_bf16 v[128:131], v[156:159], a[248:251], v[128:131]
    buffer_load_dwordx4 v3, s[32:35], s92 offen offset:2048  lds
    v_mfma_f32_16x16x32_bf16 v[128:131], v[160:163], a[252:255], v[128:131]
    s_waitcnt lgkmcnt(0)
    ds_read_b64_tr_b16 v[156:157], v7 offset:57344
    v_mfma_f32_16x16x32_bf16 v[108:111], v[148:151], a[0:3], 0
    ds_read_b64_tr_b16 v[158:159], v7 offset:59392
    v_cvt_pk_bf16_f32 v173, v146, v147
    v_mfma_f32_16x16x32_bf16 v[108:111], v[152:155], a[4:7], v[108:111]
    ds_read_b64_tr_b16 v[160:161], v7 offset:61440
    s_waitcnt vmcnt(13)
    v_mfma_f32_16x16x32_bf16 v[112:115], v[152:155], a[20:23], 0
    ds_read_b64_tr_b16 v[162:163], v7 offset:63488
    v_or_b32_e64 v85, v85, v87
    v_mfma_f32_16x16x32_bf16 v[112:115], v[148:151], a[16:19], v[112:115]
    buffer_load_dwordx4 v4, s[32:35], s92 offen offset:3072  lds
    v_cmp_ne_u32 vcc, 0, v85
    v_cvt_pk_bf16_f32 v172, v144, v145
    v_mfma_f32_16x16x32_bf16 v[116:119], v[148:151], a[32:35], 0
    s_add_u32 m0, s91, 102400
    v_cvt_pk_bf16_f32 v171, v142, v143
    v_cvt_pk_bf16_f32 v170, v140, v141
    v_mfma_f32_16x16x32_bf16 v[116:119], v[152:155], a[36:39], v[116:119]
    s_add_u32 s92, s90, 2621440
    v_cvt_pk_bf16_f32 v169, v138, v139
    v_cvt_pk_bf16_f32 v168, v136, v137
    v_mfma_f32_16x16x32_bf16 v[120:123], v[152:155], a[52:55], 0
    s_cbranch_vccnz L_retry15
L_back15:
    v_mfma_f32_16x16x32_bf16 v[120:123], v[148:151], a[48:51], v[120:123]
    v_cvt_pk_bf16_f32 v167, v134, v135
    v_cvt_pk_bf16_f32 v166, v132, v133
    v_mfma_f32_16x16x32_bf16 v[124:127], v[148:151], a[64:67], 0
    s_barrier
    v_mfma_f32_16x16x32_bf16 v[124:127], v[152:155], a[68:71], v[124:127]
    s_waitcnt lgkmcnt(0)
    ds_read_b64_tr_b16 v[148:149], v11 offset:20480
    v_cvt_pk_bf16_f32 v165, v130, v131
    v_cvt_pk_bf16_f32 v164, v128, v129
    v_mfma_f32_16x16x32_bf16 v[124:127], v[156:159], a[72:75], v[124:127]
    buffer_load_dwordx4 v1, s[32:35], s92 offen offset:0  lds
    ds_read_b64_tr_b16 v[150:151], v11 offset:22528
    v_mfma_f32_16x16x32_bf16 v[124:127], v[160:163], a[76:79], v[124:127]
    ds_read_b64_tr_b16 v[152:153], v11 offset:24576
    v_mfma_f32_16x16x32_bf16 v[120:123], v[160:163], a[60:63], v[120:123]
    ds_read_b64_tr_b16 v[154:155], v11 offset:26624
    v_mfma_f32_16x16x32_bf16 v[120:123], v[156:159], a[56:59], v[120:123]
    buffer_store_dword v188, v189, s[36:39], s100 offen offset:2560 sc1
    s_add_u32 s100, s100, 10752
    v_mfma_f32_16x16x32_bf16 v[116:119], v[156:159], a[40:43], v[116:119]
    buffer_load_dwordx4 v[48:51], v186, s[36:39], s8 offen sc1
    v_mfma_f32_16x16x32_bf16 v[116:119], v[160:163], a[44:47], v[116:119]
    v_mfma_f32_16x16x32_bf16 v[112:115], v[160:163], a[28:31], v[112:115]
    buffer_load_dwordx4 v[52:55], v186, s[36:39], s8 offen offset:1024 sc1
    v_mfma_f32_16x16x32_bf16 v[112:115], v[156:159], a[24:27], v[112:115]
    v_mfma_f32_16x16x32_bf16 v[108:111], v[156:159], a[8:11], v[108:111]
    buffer_load_dwordx2 v[56:57], v187, s[36:39], s8 offen offset:2048 sc1
    v_mfma_f32_16x16x32_bf16 v[108:111], v[160:163], a[12:15], v[108:111]
    s_waitcnt lgkmcnt(0)
    ds_read_b64_tr_b16 v[156:157], v11 offset:28672
    v_mfma_f32_16x16x32_bf16 v[108:111], v[148:151], a[80:83], v[108:111]
    buffer_load_dwordx4 v[60:63], v86, s[36:39], s9 offen sc1
    ds_read_b64_tr_b16 v[158:159], v11 offset:30720
    v_mfma_f32_16x16x32_bf16 v[108:111], v[152:155], a[84:87], v[108:111]
    buffer_store_dwordx4 v[164:167], v186, s[36:39], s93 offen sc1
    ds_read_b64_tr_b16 v[160:161], v11 offset:32768
    v_mfma_f32_16x16x32_bf16 v[112:115], v[152:155], a[100:103], v[112:115]
    ds_read_b64_tr_b16 v[162:163], v11 offset:34816
    v_mfma_f32_16x16x32_bf16 v[112:115], v[148:151], a[96:99], v[112:115]
    buffer_store_dwordx4 v[168:171], v186, s[36:39], s93 offen offset:1024 sc1
    v_mfma_f32_16x16x32_bf16 v[116:119], v[148:151], a[112:115], v[116:119]
    v_mfma_f32_16x16x32_bf16 v[116:119], v[152:155], a[116:119], v[116:119]
    buffer_store_dwordx2 v[172:173], v187, s[36:39], s93 offen offset:2048 sc1
    s_add_u32 s93, s93, 10752
    v_mfma_f32_16x16x32_bf16 v[120:123], v[152:155], a[132:135], v[120:123]
    buffer_load_dword v174, v191, s[36:39], s10 offen offset:2560 sc1
    v_mfma_f32_16x16x32_bf16 v[120:123], v[148:151], a[128:131], v[120:123]
    buffer_load_dword v175, v191, s[36:39], s11 offen offset:2560 sc1
    buffer_load_dwordx4 v2, s[32:35], s92 offen offset:1024  lds
    v_mfma_f32_16x16x32_bf16 v[124:127], v[148:151], a[144:147], v[124:127]
    s_waitcnt vmcnt(24)
    s_barrier
    v_mfma_f32_16x16x32_bf16 v[124:127], v[152:155], a[148:151], v[124:127]
    s_waitcnt lgkmcnt(0)
    ds_read_b64_tr_b16 v[148:149], v8 offset:0
    v_mfma_f32_16x16x32_bf16 v[124:127], v[156:159], a[152:155], v[124:127]
    ds_read_b64_tr_b16 v[150:151], v8 offset:2048
    v_mfma_f32_16x16x32_bf16 v[124:127], v[160:163], a[156:159], v[124:127]
    ds_read_b64_tr_b16 v[152:153], v8 offset:4096
    v_mfma_f32_16x16x32_bf16 v[120:123], v[160:163], a[140:143], v[120:123]
    buffer_load_dwordx4 v3, s[32:35], s92 offen offset:2048  lds
    ds_read_b64_tr_b16 v[154:155], v8 offset:6144
    v_mfma_f32_16x16x32_bf16 v[120:123], v[156:159], a[136:139], v[120:123]
    v_mfma_f32_16x16x32_bf16 v[116:119], v[156:159], a[120:123], v[116:119]
    v_mfma_f32_16x16x32_bf16 v[116:119], v[160:163], a[124:127], v[116:119]
    v_mfma_f32_16x16x32_bf16 v[112:115], v[160:163], a[108:111], v[112:115]
    v_mfma_f32_16x16x32_bf16 v[112:115], v[156:159], a[104:107], v[112:115]
    buffer_load_dwordx4 v4, s[32:35], s92 offen offset:3072  lds
    s_add_u32 m0, s91, 32768
    v_mfma_f32_16x16x32_bf16 v[108:111], v[156:159], a[88:91], v[108:111]
    s_add_u32 s92, s90, 3932160
    s_add_u32 s90, s90, 128
    v_mfma_f32_16x16x32_bf16 v[108:111], v[160:163], a[92:95], v[108:111]
    s_waitcnt lgkmcnt(0)
    ds_read_b64_tr_b16 v[156:157], v8 offset:8192
    v_mfma_f32_16x16x32_bf16 v[108:111], v[148:151], a[160:163], v[108:111]
    s_sub_u32 s87, s90, 1280
    s_cselect_b32 s90, s90, s87
    ds_read_b64_tr_b16 v[158:159], v8 offset:10240
    v_mfma_f32_16x16x32_bf16 v[108:111], v[152:155], a[164:167], v[108:111]
    ds_read_b64_tr_b16 v[160:161], v8 offset:12288
    v_mfma_f32_16x16x32_bf16 v[112:115], v[152:155], a[180:183], v[112:115]
    buffer_load_dwordx4 v1, s[32:35], s92 offen offset:0  lds
    ds_read_b64_tr_b16 v[162:163], v8 offset:14336
    v_mfma_f32_16x16x32_bf16 v[112:115], v[148:151], a[176:179], v[112:115]
    v_mfma_f32_16x16x32_bf16 v[116:119], v[148:151], a[192:195], v[116:119]
    v_mfma_f32_16x16x32_bf16 v[116:119], v[152:155], a[196:199], v[116:119]
    v_mfma_f32_16x16x32_bf16 v[120:123], v[152:155], a[212:215], v[120:123]
    v_mfma_f32_16x16x32_bf16 v[120:123], v[148:151], a[208:211], v[120:123]
    buffer_load_dwordx4 v2, s[32:35], s92 offen offset:1024  lds
    v_mfma_f32_16x16x32_bf16 v[124:127], v[148:151], a[224:227], v[124:127]
    s_waitcnt vmcnt(24)
    s_barrier
    v_mfma_f32_16x16x32_bf16 v[124:127], v[152:155], a[228:231], v[124:127]
    s_waitcnt lgkmcnt(0)
    ds_read_b64_tr_b16 v[148:149], v7 offset:0
    v_mfma_f32_16x16x32_bf16 v[124:127], v[156:159], a[232:235], v[124:127]
    ds_read_b64_tr_b16 v[150:151], v7 offset:2048
    v_mfma_f32_16x16x32_bf16 v[124:127], v[160:163], a[236:239], v[124:127]
    buffer_load_dwordx4 v3, s[32:35], s92 offen offset:2048  lds
    ds_read_b64_tr_b16 v[152:153], v7 offset:4096
    v_mfma_f32_16x16x32_bf16 v[120:123], v[160:163], a[220:223], v[120:123]
    ds_read_b64_tr_b16 v[154:155], v7 offset:6144
    v_mfma_f32_16x16x32_bf16 v[120:123], v[156:159], a[216:219], v[120:123]
    v_mfma_f32_16x16x32_bf16 v[116:119], v[156:159], a[200:203], v[116:119]
    v_mfma_f32_16x16x32_bf16 v[116:119], v[160:163], a[204:207], v[116:119]
    v_mfma_f32_16x16x32_bf16 v[112:115], v[160:163], a[188:191], v[112:115]
    buffer_load_dwordx4 v4, s[32:35], s92 offen offset:3072  lds
    s_add_u32 m0, s91, 122880
    v_mfma_f32_16x16x32_bf16 v[112:115], v[156:159], a[184:187], v[112:115]
    s_add_u32 s92, s90, 0
    v_mfma_f32_16x16x32_bf16 v[108:111], v[156:159], a[168:171], v[108:111]
    v_mfma_f32_16x16x32_bf16 v[108:111], v[160:163], a[172:175], v[108:111]
    s_waitcnt lgkmcnt(0)
    ds_read_b64_tr_b16 v[156:157], v7 offset:8192
    v_mfma_f32_16x16x32_bf16 v[108:111], v[148:151], a[240:243], v[108:111]
    ds_read_b64_tr_b16 v[158:159], v7 offset:10240
    v_mfma_f32_16x16x32_bf16 v[108:111], v[152:155], a[244:247], v[108:111]
    buffer_load_dwordx4 v1, s[32:35], s92 offen offset:0  lds
    ds_read_b64_tr_b16 v[160:161], v7 offset:12288
    v_mfma_f32_16x16x32_bf16 v[112:115], v[152:155], v[196:199], v[112:115]
    ds_read_b64_tr_b16 v[162:163], v7 offset:14336
    v_mfma_f32_16x16x32_bf16 v[112:115], v[148:151], v[192:195], v[112:115]
    v_mfma_f32_16x16x32_bf16 v[116:119], v[148:151], v[208:211], v[116:119]
    v_mfma_f32_16x16x32_bf16 v[116:119], v[152:155], v[212:215], v[116:119]
    v_mfma_f32_16x16x32_bf16 v[120:123], v[152:155], v[228:231], v[120:123]
    buffer_load_dwordx4 v2, s[32:35], s92 offen offset:1024  lds
    v_mfma_f32_16x16x32_bf16 v[120:123], v[148:151], v[224:227], v[120:123]
    v_mfma_f32_16x16x32_bf16 v[124:127], v[148:151], v[240:243], v[124:127]
    s_waitcnt vmcnt(24)
    s_barrier
    v_mfma_f32_16x16x32_bf16 v[124:127], v[152:155], v[244:247], v[124:127]
    s_waitcnt lgkmcnt(0)
    ds_read_b64_tr_b16 v[148:149], v8 offset:16384
    s_waitcnt vmcnt(14)
    v_mfma_f32_16x16x16_bf16 v[24:27], v[80:81], v[60:61], v[24:27]
    v_mfma_f32_16x16x16_bf16 v[88:91], v[80:81], v[48:49], v[88:91]
    buffer_load_dwordx4 v3, s[32:35], s92 offen offset:2048  lds
    v_mfma_f32_16x16x16_bf16 v[92:95], v[80:81], v[50:51], v[92:95]
    v_mfma_f32_16x16x16_bf16 v[96:99], v[80:81], v[52:53], v[96:99]
    v_mfma_f32_16x16x16_bf16 v[100:103], v[80:81], v[54:55], v[100:103]
    v_mfma_f32_16x16x16_bf16 v[104:107], v[80:81], v[56:57], v[104:107]
    buffer_load_dwordx4 v4, s[32:35], s92 offen offset:3072  lds
    s_add_u32 m0, s91, 49152
    v_mfma_f32_16x16x16_bf16 v[28:31], v[80:81], v[62:63], v[28:31]
    s_add_u32 s92, s90, 1310720
    v_mfma_f32_16x16x32_bf16 v[124:127], v[156:159], v[248:251], v[124:127]
    ds_read_b64_tr_b16 v[150:151], v8 offset:18432
    v_mfma_f32_16x16x32_bf16 v[124:127], v[160:163], v[252:255], v[124:127]
    ds_read_b64_tr_b16 v[152:153], v8 offset:20480
    v_mfma_f32_16x16x32_bf16 v[120:123], v[160:163], v[236:239], v[120:123]
    ds_read_b64_tr_b16 v[154:155], v8 offset:22528
    v_mfma_f32_16x16x32_bf16 v[120:123], v[156:159], v[232:235], v[120:123]
    buffer_load_dwordx4 v1, s[32:35], s92 offen offset:0  lds
    v_mfma_f32_16x16x32_bf16 v[116:119], v[156:159], v[216:219], v[116:119]
    v_mfma_f32_16x16x32_bf16 v[116:119], v[160:163], v[220:223], v[116:119]
    v_mfma_f32_16x16x32_bf16 v[112:115], v[160:163], v[204:207], v[112:115]
    v_mfma_f32_16x16x32_bf16 v[112:115], v[156:159], v[200:203], v[112:115]
    v_mfma_f32_16x16x32_bf16 v[108:111], v[156:159], a[248:251], v[108:111]
    buffer_load_dwordx4 v2, s[32:35], s92 offen offset:1024  lds
    v_mfma_f32_16x16x32_bf16 v[108:111], v[160:163], a[252:255], v[108:111]
    s_waitcnt lgkmcnt(0)
    ds_read_b64_tr_b16 v[156:157], v8 offset:24576
    v_mfma_f32_16x16x32_bf16 v[128:131], v[148:151], a[0:3], 0
    ds_read_b64_tr_b16 v[158:159], v8 offset:26624
    v_cvt_pk_bf16_f32 v185, v126, v127
    v_mfma_f32_16x16x32_bf16 v[128:131], v[152:155], a[4:7], v[128:131]
    ds_read_b64_tr_b16 v[160:161], v8 offset:28672
    s_waitcnt vmcnt(13)
    v_mfma_f32_16x16x32_bf16 v[132:135], v[152:155], a[20:23], 0
    ds_read_b64_tr_b16 v[162:163], v8 offset:30720
    v_or_b32 v174, v174, v175
    v_mfma_f32_16x16x32_bf16 v[132:135], v[148:151], a[16:19], v[132:135]
    buffer_load_dwordx4 v3, s[32:35], s92 offen offset:2048  lds
    v_cmp_ne_u32 vcc, 0, v174
    v_cvt_pk_bf16_f32 v184, v124, v125
    v_mfma_f32_16x16x32_bf16 v[136:139], v[148:151], a[32:35], 0
    v_cvt_pk_bf16_f32 v183, v122, v123
    v_cvt_pk_bf16_f32 v182, v120, v121
    v_mfma_f32_16x16x32_bf16 v[136:139], v[152:155], a[36:39], v[136:139]
    v_cvt_pk_bf16_f32 v181, v118, v119
    v_cvt_pk_bf16_f32 v180, v116, v117
    v_mfma_f32_16x16x32_bf16 v[140:143], v[152:155], a[52:55], 0
    s_cbranch_vccnz L_retry16
L_back16:
    v_mfma_f32_16x16x32_bf16 v[140:143], v[148:151], a[48:51], v[140:143]
    v_cvt_pk_bf16_f32 v179, v114, v115
    v_cvt_pk_bf16_f32 v178, v112, v113
    v_mfma_f32_16x16x32_bf16 v[144:147], v[148:151], a[64:67], 0
    s_barrier
    v_mfma_f32_16x16x32_bf16 v[144:147], v[152:155], a[68:71], v[144:147]
    s_waitcnt lgkmcnt(0)
    ds_read_b64_tr_b16 v[148:149], v7 offset:16384
    v_cvt_pk_bf16_f32 v177, v110, v111
    v_cvt_pk_bf16_f32 v176, v108, v109
    v_mfma_f32_16x16x32_bf16 v[144:147], v[156:159], a[72:75], v[144:147]
    buffer_load_dwordx4 v4, s[32:35], s92 offen offset:3072  lds
    ds_read_b64_tr_b16 v[150:151], v7 offset:18432
    v_mfma_f32_16x16x32_bf16 v[144:147], v[160:163], a[76:79], v[144:147]
    ds_read_b64_tr_b16 v[152:153], v7 offset:20480
    v_mfma_f32_16x16x32_bf16 v[140:143], v[160:163], a[60:63], v[140:143]
    ds_read_b64_tr_b16 v[154:155], v7 offset:22528
    v_mfma_f32_16x16x32_bf16 v[140:143], v[156:159], a[56:59], v[140:143]
    buffer_store_dword v188, v189, s[36:39], s100 offen offset:2560 sc1
    s_add_u32 s100, s100, 10752
    v_mfma_f32_16x16x32_bf16 v[136:139], v[156:159], a[40:43], v[136:139]
    buffer_load_dwordx4 v[64:67], v186, s[36:39], s10 offen sc1
    v_mfma_f32_16x16x32_bf16 v[136:139], v[160:163], a[44:47], v[136:139]
    v_mfma_f32_16x16x32_bf16 v[132:135], v[160:163], a[28:31], v[132:135]
    buffer_load_dwordx4 v[68:71], v186, s[36:39], s10 offen offset:1024 sc1
    v_mfma_f32_16x16x32_bf16 v[132:135], v[156:159], a[24:27], v[132:135]
    v_mfma_f32_16x16x32_bf16 v[128:131], v[156:159], a[8:11], v[128:131]
    buffer_load_dwordx2 v[72:73], v187, s[36:39], s10 offen offset:2048 sc1
    v_mfma_f32_16x16x32_bf16 v[128:131], v[160:163], a[12:15], v[128:131]
    s_waitcnt lgkmcnt(0)
    ds_read_b64_tr_b16 v[156:157], v7 offset:24576
    v_mfma_f32_16x16x32_bf16 v[128:131], v[148:151], a[80:83], v[128:131]
    buffer_load_dwordx4 v[76:79], v86, s[36:39], s11 offen sc1
    ds_read_b64_tr_b16 v[158:159], v7 offset:26624
    v_mfma_f32_16x16x32_bf16 v[128:131], v[152:155], a[84:87], v[128:131]
    buffer_store_dwordx4 v[176:179], v186, s[36:39], s93 offen sc1
    ds_read_b64_tr_b16 v[160:161], v7 offset:28672
    v_mfma_f32_16x16x32_bf16 v[132:135], v[152:155], a[100:103], v[132:135]
    ds_read_b64_tr_b16 v[162:163], v7 offset:30720
    v_mfma_f32_16x16x32_bf16 v[132:135], v[148:151], a[96:99], v[132:135]
    buffer_store_dwordx4 v[180:183], v186, s[36:39], s93 offen offset:1024 sc1
    v_mfma_f32_16x16x32_bf16 v[136:139], v[148:151], a[112:115], v[136:139]
    v_mfma_f32_16x16x32_bf16 v[136:139], v[152:155], a[116:119], v[136:139]
    buffer_store_dwordx2 v[184:185], v187, s[36:39], s93 offen offset:2048 sc1
    s_add_u32 s93, s93, 10752
    v_mfma_f32_16x16x32_bf16 v[140:143], v[152:155], a[132:135], v[140:143]
    buffer_load_dword v82, v191, s[36:39], s12 offen offset:2560 sc1
    v_mfma_f32_16x16x32_bf16 v[140:143], v[148:151], a[128:131], v[140:143]
    buffer_load_dword v83, v191, s[36:39], s13 offen offset:2560 sc1
    s_add_u32 m0, s91, 143360
    v_mfma_f32_16x16x32_bf16 v[144:147], v[148:151], a[144:147], v[144:147]
    s_waitcnt vmcnt(22)
    s_barrier
    v_mfma_f32_16x16x32_bf16 v[144:147], v[152:155], a[148:151], v[144:147]
    s_waitcnt lgkmcnt(0)
    ds_read_b64_tr_b16 v[148:149], v8 offset:36864
    s_add_u32 s92, s90, 2621440
    v_mfma_f32_16x16x32_bf16 v[144:147], v[156:159], a[152:155], v[144:147]
    buffer_load_dwordx4 v1, s[32:35], s92 offen offset:0  lds
    ds_read_b64_tr_b16 v[150:151], v8 offset:38912
    v_mfma_f32_16x16x32_bf16 v[144:147], v[160:163], a[156:159], v[144:147]
    ds_read_b64_tr_b16 v[152:153], v8 offset:40960
    v_mfma_f32_16x16x32_bf16 v[140:143], v[160:163], a[140:143], v[140:143]
    ds_read_b64_tr_b16 v[154:155], v8 offset:43008
    v_mfma_f32_16x16x32_bf16 v[140:143], v[156:159], a[136:139], v[140:143]
    buffer_load_dwordx4 v2, s[32:35], s92 offen offset:1024  lds
    v_mfma_f32_16x16x32_bf16 v[136:139], v[156:159], a[120:123], v[136:139]
    v_mfma_f32_16x16x32_bf16 v[136:139], v[160:163], a[124:127], v[136:139]
    v_mfma_f32_16x16x32_bf16 v[132:135], v[160:163], a[108:111], v[132:135]
    v_mfma_f32_16x16x32_bf16 v[132:135], v[156:159], a[104:107], v[132:135]
    v_mfma_f32_16x16x32_bf16 v[128:131], v[156:159], a[88:91], v[128:131]
    buffer_load_dwordx4 v3, s[32:35], s92 offen offset:2048  lds
    v_mfma_f32_16x16x32_bf16 v[128:131], v[160:163], a[92:95], v[128:131]
    s_waitcnt lgkmcnt(0)
    ds_read_b64_tr_b16 v[156:157], v8 offset:45056
    v_mfma_f32_16x16x32_bf16 v[128:131], v[148:151], a[160:163], v[128:131]
    ds_read_b64_tr_b16 v[158:159], v8 offset:47104
    v_mfma_f32_16x16x32_bf16 v[128:131], v[152:155], a[164:167], v[128:131]
    ds_read_b64_tr_b16 v[160:161], v8 offset:49152
    v_mfma_f32_16x16x32_bf16 v[132:135], v[152:155], a[180:183], v[132:135]
    ds_read_b64_tr_b16 v[162:163], v8 offset:51200
    v_mfma_f32_16x16x32_bf16 v[132:135], v[148:151], a[176:179], v[132:135]
    buffer_load_dwordx4 v4, s[32:35], s92 offen offset:3072  lds
    s_add_u32 m0, s91, 65536
    v_mfma_f32_16x16x32_bf16 v[136:139], v[148:151], a[192:195], v[136:139]
    s_add_u32 s92, s90, 3932160
    s_add_u32 s90, s90, 128
    v_mfma_f32_16x16x32_bf16 v[136:139], v[152:155], a[196:199], v[136:139]
    s_sub_u32 s87, s90, 1280
    s_cselect_b32 s90, s90, s87
    v_mfma_f32_16x16x32_bf16 v[140:143], v[152:155], a[212:215], v[140:143]
    v_mfma_f32_16x16x32_bf16 v[140:143], v[148:151], a[208:211], v[140:143]
    v_mfma_f32_16x16x32_bf16 v[144:147], v[148:151], a[224:227], v[144:147]
    s_waitcnt vmcnt(22)
    s_barrier
    v_mfma_f32_16x16x32_bf16 v[144:147], v[152:155], a[228:231], v[144:147]
    s_waitcnt lgkmcnt(0)
    ds_read_b64_tr_b16 v[148:149], v7 offset:32768
    v_mfma_f32_16x16x32_bf16 v[144:147], v[156:159], a[232:235], v[144:147]
    buffer_load_dwordx4 v1, s[32:35], s92 offen offset:0  lds
    ds_read_b64_tr_b16 v[150:151], v7 offset:34816
    v_mfma_f32_16x16x32_bf16 v[144:147], v[160:163], a[236:239], v[144:147]
    ds_read_b64_tr_b16 v[152:153], v7 offset:36864
    v_mfma_f32_16x16x32_bf16 v[140:143], v[160:163], a[220:223], v[140:143]
    ds_read_b64_tr_b16 v[154:155], v7 offset:38912
    v_mfma_f32_16x16x32_bf16 v[140:143], v[156:159], a[216:219], v[140:143]
    buffer_load_dwordx4 v2, s[32:35], s92 offen offset:1024  lds
    v_mfma_f32_16x16x32_bf16 v[136:139], v[156:159], a[200:203], v[136:139]
L_pad8:
    s_cbranch_execz L_pad12
    v_mfma_f32_16x16x32_bf16 v[136:139], v[160:163], a[204:207], v[136:139]
    v_mfma_f32_16x16x32_bf16 v[132:135], v[160:163], a[188:191], v[132:135]
    v_mfma_f32_16x16x32_bf16 v[132:135], v[156:159], a[184:187], v[132:135]
    v_mfma_f32_16x16x32_bf16 v[128:131], v[156:159], a[168:171], v[128:131]
    buffer_load_dwordx4 v3, s[32:35], s92 offen offset:2048  lds
    v_mfma_f32_16x16x32_bf16 v[128:131], v[160:163], a[172:175], v[128:131]
    s_waitcnt lgkmcnt(0)
    ds_read_b64_tr_b16 v[156:157], v7 offset:40960
    v_mfma_f32_16x16x32_bf16 v[128:131], v[148:151], a[240:243], v[128:131]
    ds_read_b64_tr_b16 v[158:159], v7 offset:43008
    v_mfma_f32_16x16x32_bf16 v[128:131], v[152:155], a[244:247], v[128:131]
    ds_read_b64_tr_b16 v[160:161], v7 offset:45056
    v_mfma_f32_16x16x32_bf16 v[132:135], v[152:155], v[196:199], v[132:135]
    ds_read_b64_tr_b16 v[162:163], v7 offset:47104
    v_mfma_f32_16x16x32_bf16 v[132:135], v[148:151], v[192:195], v[132:135]
    buffer_load_dwordx4 v4, s[32:35], s92 offen offset:3072  lds
    s_add_u32 m0, s91, 0
    v_mfma_f32_16x16x32_bf16 v[136:139], v[148:151], v[208:211], v[136:139]
    s_add_u32 s92, s90, 0
    v_mfma_f32_16x16x32_bf16 v[136:139], v[152:155], v[212:215], v[136:139]
    v_mfma_f32_16x16x32_bf16 v[140:143], v[152:155], v[228:231], v[140:143]
    v_mfma_f32_16x16x32_bf16 v[140:143], v[148:151], v[224:227], v[140:143]
    v_mfma_f32_16x16x32_bf16 v[144:147], v[148:151], v[240:243], v[144:147]
    s_waitcnt vmcnt(22)
    s_barrier
    v_mfma_f32_16x16x32_bf16 v[144:147], v[152:155], v[244:247], v[144:147]
    s_waitcnt lgkmcnt(0)
    ds_read_b64_tr_b16 v[148:149], v11 offset:0
    s_waitcnt vmcnt(13)
    v_mfma_f32_16x16x16_bf16 v[24:27], v[80:81], v[76:77], v[24:27]
    buffer_load_dwordx4 v1, s[32:35], s92 offen offset:0  lds
    v_mfma_f32_16x16x16_bf16 v[88:91], v[80:81], v[64:65], v[88:91]
    v_mfma_f32_16x16x16_bf16 v[92:95], v[80:81], v[66:67], v[92:95]
    v_mfma_f32_16x16x16_bf16 v[96:99], v[80:81], v[68:69], v[96:99]
    buffer_load_dwordx4 v2, s[32:35], s92 offen offset:1024  lds
    v_mfma_f32_16x16x16_bf16 v[100:103], v[80:81], v[70:71], v[100:103]
    v_mfma_f32_16x16x16_bf16 v[104:107], v[80:81], v[72:73], v[104:107]
    v_mfma_f32_16x16x16_bf16 v[28:31], v[80:81], v[78:79], v[28:31]
    v_mfma_f32_16x16x32_bf16 v[144:147], v[156:159], v[248:251], v[144:147]
    ds_read_b64_tr_b16 v[150:151], v11 offset:2048
    v_mfma_f32_16x16x32_bf16 v[144:147], v[160:163], v[252:255], v[144:147]
    buffer_load_dwordx4 v3, s[32:35], s92 offen offset:2048  lds
    ds_read_b64_tr_b16 v[152:153], v11 offset:4096
    v_mfma_f32_16x16x32_bf16 v[140:143], v[160:163], v[236:239], v[140:143]
    ds_read_b64_tr_b16 v[154:155], v11 offset:6144
    v_mfma_f32_16x16x32_bf16 v[140:143], v[156:159], v[232:235], v[140:143]
    v_mfma_f32_16x16x32_bf16 v[136:139], v[156:159], v[216:219], v[136:139]
    v_mfma_f32_16x16x32_bf16 v[136:139], v[160:163], v[220:223], v[136:139]
    v_mfma_f32_16x16x32_bf16 v[132:135], v[160:163], v[204:207], v[132:135]
    buffer_load_dwordx4 v4, s[32:35], s92 offen offset:3072  lds
    s_add_u32 m0, s91, 81920
    v_mfma_f32_16x16x32_bf16 v[132:135], v[156:159], v[200:203], v[132:135]
    s_add_u32 s92, s90, 1310720
    v_mfma_f32_16x16x32_bf16 v[128:131], v[156:159], a[248:251], v[128:131]
    v_mfma_f32_16x16x32_bf16 v[128:131], v[160:163], a[252:255], v[128:131]
    s_waitcnt lgkmcnt(0)
    ds_read_b64_tr_b16 v[156:157], v11 offset:8192
    v_mfma_f32_16x16x32_bf16 v[108:111], v[148:151], a[0:3], 0
    ds_read_b64_tr_b16 v[158:159], v11 offset:10240
    v_cvt_pk_bf16_f32 v173, v146, v147
    v_mfma_f32_16x16x32_bf16 v[108:111], v[152:155], a[4:7], v[108:111]
    ds_read_b64_tr_b16 v[160:161], v11 offset:12288
    s_waitcnt vmcnt(12)
    v_mfma_f32_16x16x32_bf16 v[112:115], v[152:155], a[20:23], 0
    buffer_load_dwordx4 v1, s[32:35], s92 offen offset:0  lds
    ds_read_b64_tr_b16 v[162:163], v11 offset:14336
    v_or_b32 v82, v82, v83
    v_mfma_f32_16x16x32_bf16 v[112:115], v[148:151], a[16:19], v[112:115]
    v_cmp_ne_u32 vcc, 0, v82
    v_cvt_pk_bf16_f32 v172, v144, v145
    v_mfma_f32_16x16x32_bf16 v[116:119], v[148:151], a[32:35], 0
    v_cvt_pk_bf16_f32 v171, v142, v143
    v_cvt_pk_bf16_f32 v170, v140, v141
    v_mfma_f32_16x16x32_bf16 v[116:119], v[152:155], a[36:39], v[116:119]
    buffer_load_dwordx4 v2, s[32:35], s92 offen offset:1024  lds
    v_cvt_pk_bf16_f32 v169, v138, v139
    v_cvt_pk_bf16_f32 v168, v136, v137
    v_mfma_f32_16x16x32_bf16 v[120:123], v[152:155], a[52:55], 0
    s_cbranch_vccnz L_retry17
L_back17:
    v_mfma_f32_16x16x32_bf16 v[120:123], v[148:151], a[48:51], v[120:123]
    v_cvt_pk_bf16_f32 v167, v134, v135
    v_cvt_pk_bf16_f32 v166, v132, v133
    v_mfma_f32_16x16x32_bf16 v[124:127], v[148:151], a[64:67], 0
    s_barrier
    v_mfma_f32_16x16x32_bf16 v[124:127], v[152:155], a[68:71], v[124:127]
    s_waitcnt lgkmcnt(0)
    ds_read_b64_tr_b16 v[148:149], v7 offset:49152
    v_cvt_pk_bf16_f32 v165, v130, v131
    v_cvt_pk_bf16_f32 v164, v128, v129
    v_mfma_f32_16x16x32_bf16 v[124:127], v[156:159], a[72:75], v[124:127]
    ds_read_b64_tr_b16 v[150:151], v7 offset:51200
    v_mfma_f32_16x16x32_bf16 v[124:127], v[160:163], a[76:79], v[124:127]
    buffer_store_dword v188, v189, s[36:39], s100 offen offset:2560 sc1
    ds_read_b64_tr_b16 v[152:153], v7 offset:53248
    v_mfma_f32_16x16x32_bf16 v[120:123], v[160:163], a[60:63], v[120:123]
    s_add_u32 s100, s100, 10752
    ds_read_b64_tr_b16 v[154:155], v7 offset:55296
    v_mfma_f32_16x16x32_bf16 v[120:123], v[156:159], a[56:59], v[120:123]
    buffer_load_dwordx4 v[32:35], v186, s[36:39], s12 offen sc1
    v_mfma_f32_16x16x32_bf16 v[116:119], v[156:159], a[40:43], v[116:119]
    buffer_load_dwordx4 v[36:39], v186, s[36:39], s12 offen offset:1024 sc1
    v_mfma_f32_16x16x32_bf16 v[116:119], v[160:163], a[44:47], v[116:119]
    v_mfma_f32_16x16x32_bf16 v[112:115], v[160:163], a[28:31], v[112:115]
    buffer_load_dwordx2 v[40:41], v187, s[36:39], s12 offen offset:2048 sc1
    v_mfma_f32_16x16x32_bf16 v[112:115], v[156:159], a[24:27], v[112:115]
    buffer_load_dwordx4 v[44:47], v86, s[36:39], s13 offen sc1
    v_mfma_f32_16x16x32_bf16 v[108:111], v[156:159], a[8:11], v[108:111]
    v_mfma_f32_16x16x32_bf16 v[108:111], v[160:163], a[12:15], v[108:111]
    s_waitcnt lgkmcnt(0)
    ds_read_b64_tr_b16 v[156:157], v7 offset:57344
    v_mfma_f32_16x16x32_bf16 v[108:111], v[148:151], a[80:83], v[108:111]
    buffer_store_dwordx4 v[164:167], v186, s[36:39], s93 offen sc1
    ds_read_b64_tr_b16 v[158:159], v7 offset:59392
    v_mfma_f32_16x16x32_bf16 v[108:111], v[152:155], a[84:87], v[108:111]
    buffer_store_dwordx4 v[168:171], v186, s[36:39], s93 offen offset:1024 sc1
    ds_read_b64_tr_b16 v[160:161], v7 offset:61440
    v_mfma_f32_16x16x32_bf16 v[112:115], v[152:155], a[100:103], v[112:115]
    ds_read_b64_tr_b16 v[162:163], v7 offset:63488
    v_mfma_f32_16x16x32_bf16 v[112:115], v[148:151], a[96:99], v[112:115]
    buffer_store_dwordx2 v[172:173], v187, s[36:39], s93 offen offset:2048 sc1
    s_add_u32 s93, s93, 10752
    v_mfma_f32_16x16x32_bf16 v[116:119], v[148:151], a[112:115], v[116:119]
    buffer_load_dword v85, v191, s[36:39], s14 offen offset:2560 sc1
    v_mfma_f32_16x16x32_bf16 v[116:119], v[152:155], a[116:119], v[116:119]
    buffer_load_dword v87, v191, s[36:39], s15 offen offset:2560 sc1
    v_mfma_f32_16x16x32_bf16 v[120:123], v[152:155], a[132:135], v[120:123]
    buffer_load_dwordx4 v3, s[32:35], s92 offen offset:2048  lds
    v_mfma_f32_16x16x32_bf16 v[120:123], v[148:151], a[128:131], v[120:123]
    v_mfma_f32_16x16x32_bf16 v[124:127], v[148:151], a[144:147], v[124:127]
    s_waitcnt vmcnt(21)
    s_barrier
    v_mfma_f32_16x16x32_bf16 v[124:127], v[152:155], a[148:151], v[124:127]
    s_waitcnt lgkmcnt(0)
    ds_read_b64_tr_b16 v[148:149], v11 offset:20480
    v_mfma_f32_16x16x32_bf16 v[124:127], v[156:159], a[152:155], v[124:127]
    buffer_load_dwordx4 v4, s[32:35], s92 offen offset:3072  lds
    ds_read_b64_tr_b16 v[150:151], v11 offset:22528
    v_mfma_f32_16x16x32_bf16 v[124:127], v[160:163], a[156:159], v[124:127]
    s_add_u32 m0, s91, 16384
    ds_read_b64_tr_b16 v[152:153], v11 offset:24576
    s_add_u32 s92, s90, 2621440
    v_mfma_f32_16x16x32_bf16 v[120:123], v[160:163], a[140:143], v[120:123]
    ds_read_b64_tr_b16 v[154:155], v11 offset:26624
    v_mfma_f32_16x16x32_bf16 v[120:123], v[156:159], a[136:139], v[120:123]
    v_mfma_f32_16x16x32_bf16 v[116:119], v[156:159], a[120:123], v[116:119]
    v_mfma_f32_16x16x32_bf16 v[116:119], v[160:163], a[124:127], v[116:119]
    buffer_load_dwordx4 v1, s[32:35], s92 offen offset:0  lds
    v_mfma_f32_16x16x32_bf16 v[112:115], v[160:163], a[108:111], v[112:115]
    v_mfma_f32_16x16x32_bf16 v[112:115], v[156:159], a[104:107], v[112:115]
    v_mfma_f32_16x16x32_bf16 v[108:111], v[156:159], a[88:91], v[108:111]
    v_mfma_f32_16x16x32_bf16 v[108:111], v[160:163], a[92:95], v[108:111]
    s_waitcnt lgkmcnt(0)
    ds_read_b64_tr_b16 v[156:157], v11 offset:28672
    v_mfma_f32_16x16x32_bf16 v[108:111], v[148:151], a[160:163], v[108:111]
    buffer_load_dwordx4 v2, s[32:35], s92 offen offset:1024  lds
    ds_read_b64_tr_b16 v[158:159], v11 offset:30720
    v_mfma_f32_16x16x32_bf16 v[108:111], v[152:155], a[164:167], v[108:111]
    ds_read_b64_tr_b16 v[160:161], v11 offset:32768
    v_mfma_f32_16x16x32_bf16 v[112:115], v[152:155], a[180:183], v[112:115]
    ds_read_b64_tr_b16 v[162:163], v11 offset:34816
    v_mfma_f32_16x16x32_bf16 v[112:115], v[148:151], a[176:179], v[112:115]
    v_mfma_f32_16x16x32_bf16 v[116:119], v[148:151], a[192:195], v[116:119]
    buffer_load_dwordx4 v3, s[32:35], s92 offen offset:2048  lds
    v_mfma_f32_16x16x32_bf16 v[116:119], v[152:155], a[196:199], v[116:119]
    v_mfma_f32_16x16x32_bf16 v[120:123], v[152:155], a[212:215], v[120:123]
    v_mfma_f32_16x16x32_bf16 v[120:123], v[148:151], a[208:211], v[120:123]
    v_mfma_f32_16x16x32_bf16 v[124:127], v[148:151], a[224:227], v[124:127]
    s_waitcnt vmcnt(21)
    s_barrier
    v_mfma_f32_16x16x32_bf16 v[124:127], v[152:155], a[228:231], v[124:127]
    s_waitcnt lgkmcnt(0)
    ds_read_b64_tr_b16 v[148:149], v8 offset:0
    v_mfma_f32_16x16x32_bf16 v[124:127], v[156:159], a[232:235], v[124:127]
    buffer_load_dwordx4 v4, s[32:35], s92 offen offset:3072  lds
    ds_read_b64_tr_b16 v[150:151], v8 offset:2048
    v_mfma_f32_16x16x32_bf16 v[124:127], v[160:163], a[236:239], v[124:127]
    s_add_u32 m0, s91, 102400
    ds_read_b64_tr_b16 v[152:153], v8 offset:4096
    s_add_u32 s92, s90, 3932160
    v_mfma_f32_16x16x32_bf16 v[120:123], v[160:163], a[220:223], v[120:123]
    s_add_u32 s90, s90, 128
    ds_read_b64_tr_b16 v[154:155], v8 offset:6144
    v_mfma_f32_16x16x32_bf16 v[120:123], v[156:159], a[216:219], v[120:123]
    s_sub_u32 s87, s90, 1280
    s_cselect_b32 s90, s90, s87
    v_mfma_f32_16x16x32_bf16 v[116:119], v[156:159], a[200:203], v[116:119]
    buffer_load_dwordx4 v1, s[32:35], s92 offen offset:0  lds
    v_mfma_f32_16x16x32_bf16 v[116:119], v[160:163], a[204:207], v[116:119]
    v_mfma_f32_16x16x32_bf16 v[112:115], v[160:163], a[188:191], v[112:115]
    v_mfma_f32_16x16x32_bf16 v[112:115], v[156:159], a[184:187], v[112:115]
    v_mfma_f32_16x16x32_bf16 v[108:111], v[156:159], a[168:171], v[108:111]
    buffer_load_dwordx4 v2, s[32:35], s92 offen offset:1024  lds
    v_mfma_f32_16x16x32_bf16 v[108:111], v[160:163], a[172:175], v[108:111]
    s_waitcnt lgkmcnt(0)
    ds_read_b64_tr_b16 v[156:157], v8 offset:8192
    v_mfma_f32_16x16x32_bf16 v[108:111], v[148:151], a[240:243], v[108:111]
    ds_read_b64_tr_b16 v[158:159], v8 offset:10240
    v_mfma_f32_16x16x32_bf16 v[108:111], v[152:155], a[244:247], v[108:111]
    ds_read_b64_tr_b16 v[160:161], v8 offset:12288
    v_mfma_f32_16x16x32_bf16 v[112:115], v[152:155], v[196:199], v[112:115]
    ds_read_b64_tr_b16 v[162:163], v8 offset:14336
    v_mfma_f32_16x16x32_bf16 v[112:115], v[148:151], v[192:195], v[112:115]
    buffer_load_dwordx4 v3, s[32:35], s92 offen offset:2048  lds
    v_mfma_f32_16x16x32_bf16 v[116:119], v[148:151], v[208:211], v[116:119]
    v_mfma_f32_16x16x32_bf16 v[116:119], v[152:155], v[212:215], v[116:119]
    v_mfma_f32_16x16x32_bf16 v[120:123], v[152:155], v[228:231], v[120:123]
    v_mfma_f32_16x16x32_bf16 v[120:123], v[148:151], v[224:227], v[120:123]
    v_mfma_f32_16x16x32_bf16 v[124:127], v[148:151], v[240:243], v[124:127]
    s_waitcnt vmcnt(21)
    s_barrier
    v_mfma_f32_16x16x32_bf16 v[124:127], v[152:155], v[244:247], v[124:127]
    s_waitcnt lgkmcnt(0)
    ds_read_b64_tr_b16 v[148:149], v7 offset:0
    s_waitcnt vmcnt(14)
    v_mfma_f32_16x16x16_bf16 v[24:27], v[80:81], v[44:45], v[24:27]
    buffer_load_dwordx4 v4, s[32:35], s92 offen offset:3072  lds
    s_add_u32 m0, s91, 32768
    v_mfma_f32_16x16x16_bf16 v[88:91], v[80:81], v[32:33], v[88:91]
    s_add_u32 s92, s90, 0
    v_mfma_f32_16x16x16_bf16 v[92:95], v[80:81], v[34:35], v[92:95]
    v_mfma_f32_16x16x16_bf16 v[96:99], v[80:81], v[36:37], v[96:99]
    buffer_load_dwordx4 v1, s[32:35], s92 offen offset:0  lds
    v_mfma_f32_16x16x16_bf16 v[100:103], v[80:81], v[38:39], v[100:103]
    v_mfma_f32_16x16x16_bf16 v[104:107], v[80:81], v[40:41], v[104:107]
    v_mfma_f32_16x16x16_bf16 v[28:31], v[80:81], v[46:47], v[28:31]
    v_mfma_f32_16x16x32_bf16 v[124:127], v[156:159], v[248:251], v[124:127]
    ds_read_b64_tr_b16 v[150:151], v7 offset:2048
    v_mfma_f32_16x16x32_bf16 v[124:127], v[160:163], v[252:255], v[124:127]
    buffer_load_dwordx4 v2, s[32:35], s92 offen offset:1024  lds
    ds_read_b64_tr_b16 v[152:153], v7 offset:4096
    v_mfma_f32_16x16x32_bf16 v[120:123], v[160:163], v[236:239], v[120:123]
    ds_read_b64_tr_b16 v[154:155], v7 offset:6144
    v_mfma_f32_16x16x32_bf16 v[120:123], v[156:159], v[232:235], v[120:123]
    v_mfma_f32_16x16x32_bf16 v[116:119], v[156:159], v[216:219], v[116:119]
    v_mfma_f32_16x16x32_bf16 v[116:119], v[160:163], v[220:223], v[116:119]
    v_mfma_f32_16x16x32_bf16 v[112:115], v[160:163], v[204:207], v[112:115]
    buffer_load_dwordx4 v3, s[32:35], s92 offen offset:2048  lds
    v_mfma_f32_16x16x32_bf16 v[112:115], v[156:159], v[200:203], v[112:115]
    v_mfma_f32_16x16x32_bf16 v[108:111], v[156:159], a[248:251], v[108:111]
    v_mfma_f32_16x16x32_bf16 v[108:111], v[160:163], a[252:255], v[108:111]
    s_waitcnt lgkmcnt(0)
    ds_read_b64_tr_b16 v[156:157], v7 offset:8192
    v_mfma_f32_16x16x32_bf16 v[128:131], v[148:151], a[0:3], 0
    ds_read_b64_tr_b16 v[158:159], v7 offset:10240
    v_cvt_pk_bf16_f32 v185, v126, v127
    v_mfma_f32_16x16x32_bf16 v[128:131], v[152:155], a[4:7], v[128:131]
    ds_read_b64_tr_b16 v[160:161], v7 offset:12288
    s_waitcnt vmcnt(13)
    v_mfma_f32_16x16x32_bf16 v[132:135], v[152:155], a[20:23], 0
    buffer_load_dwordx4 v4, s[32:35], s92 offen offset:3072  lds
    ds_read_b64_tr_b16 v[162:163], v7 offset:14336
    v_or_b32 v85, v85, v87
    v_mfma_f32_16x16x32_bf16 v[132:135], v[148:151], a[16:19], v[132:135]
    s_add_u32 m0, s91, 122880
    v_cmp_ne_u32 vcc, 0, v85
    v_cvt_pk_bf16_f32 v184, v124, v125
    v_mfma_f32_16x16x32_bf16 v[136:139], v[148:151], a[32:35], 0
    s_add_u32 s92, s90, 1310720
    v_cvt_pk_bf16_f32 v183, v122, v123
    v_cvt_pk_bf16_f32 v182, v120, v121
    v_mfma_f32_16x16x32_bf16 v[136:139], v[152:155], a[36:39], v[136:139]
    buffer_load_dwordx4 v1, s[32:35], s92 offen offset:0  lds
    v_cvt_pk_bf16_f32 v181, v118, v119
    v_cvt_pk_bf16_f32 v180, v116, v117
    v_mfma_f32_16x16x32_bf16 v[140:143], v[152:155], a[52:55], 0
    s_cbranch_vccnz L_retry18
L_back18:
    v_mfma_f32_16x16x32_bf16 v[140:143], v[148:151], a[48:51], v[140:143]
    v_cvt_pk_bf16_f32 v179, v114, v115
    v_cvt_pk_bf16_f32 v178, v112, v113
    v_mfma_f32_16x16x32_bf16 v[144:147], v[148:151], a[64:67], 0
    s_waitcnt vmcnt(13)
    s_barrier
    v_mfma_f32_16x16x32_bf16 v[144:147], v[152:155], a[68:71], v[144:147]
    s_waitcnt lgkmcnt(0)
    ds_read_b64_tr_b16 v[148:149], v8 offset:16384
    v_cvt_pk_bf16_f32 v177, v110, v111
    v_cvt_pk_bf16_f32 v176, v108, v109
    v_mfma_f32_16x16x32_bf16 v[144:147], v[156:159], a[72:75], v[144:147]
    ds_read_b64_tr_b16 v[150:151], v8 offset:18432
    v_mfma_f32_16x16x32_bf16 v[144:147], v[160:163], a[76:79], v[144:147]
    buffer_store_dword v188, v189, s[36:39], s100 offen offset:2560 sc1
    ds_read_b64_tr_b16 v[152:153], v8 offset:20480
    v_mfma_f32_16x16x32_bf16 v[140:143], v[160:163], a[60:63], v[140:143]
    s_add_u32 s100, s100, 10752
    ds_read_b64_tr_b16 v[154:155], v8 offset:22528
    v_mfma_f32_16x16x32_bf16 v[140:143], v[156:159], a[56:59], v[140:143]
    buffer_load_dwordx4 v[48:51], v186, s[36:39], s14 offen sc1
    v_mfma_f32_16x16x32_bf16 v[136:139], v[156:159], a[40:43], v[136:139]
    buffer_load_dwordx4 v[52:55], v186, s[36:39], s14 offen offset:1024 sc1
    v_mfma_f32_16x16x32_bf16 v[136:139], v[160:163], a[44:47], v[136:139]
    v_mfma_f32_16x16x32_bf16 v[132:135], v[160:163], a[28:31], v[132:135]
    buffer_load_dwordx2 v[56:57], v187, s[36:39], s14 offen offset:2048 sc1
    v_mfma_f32_16x16x32_bf16 v[132:135], v[156:159], a[24:27], v[132:135]
    buffer_load_dwordx4 v[60:63], v86, s[36:39], s15 offen sc1
    v_mfma_f32_16x16x32_bf16 v[128:131], v[156:159], a[8:11], v[128:131]
    v_mfma_f32_16x16x32_bf16 v[128:131], v[160:163], a[12:15], v[128:131]
    s_waitcnt lgkmcnt(0)
    ds_read_b64_tr_b16 v[156:157], v8 offset:24576
    v_mfma_f32_16x16x32_bf16 v[128:131], v[148:151], a[80:83], v[128:131]
    buffer_store_dwordx4 v[176:179], v186, s[36:39], s93 offen sc1
    ds_read_b64_tr_b16 v[158:159], v8 offset:26624
    v_mfma_f32_16x16x32_bf16 v[128:131], v[152:155], a[84:87], v[128:131]
    buffer_store_dwordx4 v[180:183], v186, s[36:39], s93 offen offset:1024 sc1
    ds_read_b64_tr_b16 v[160:161], v8 offset:28672
    v_mfma_f32_16x16x32_bf16 v[132:135], v[152:155], a[100:103], v[132:135]
    ds_read_b64_tr_b16 v[162:163], v8 offset:30720
    v_mfma_f32_16x16x32_bf16 v[132:135], v[148:151], a[96:99], v[132:135]
    buffer_store_dwordx2 v[184:185], v187, s[36:39], s93 offen offset:2048 sc1
    s_add_u32 s93, s93, 10752
    v_mfma_f32_16x16x32_bf16 v[136:139], v[148:151], a[112:115], v[136:139]
    buffer_load_dword v174, v191, s[36:39], s16 offen offset:2560 sc1
    v_mfma_f32_16x16x32_bf16 v[136:139], v[152:155], a[116:119], v[136:139]
    buffer_load_dword v175, v191, s[36:39], s17 offen offset:2560 sc1
    v_mfma_f32_16x16x32_bf16 v[140:143], v[152:155], a[132:135], v[140:143]
    buffer_load_dwordx4 v2, s[32:35], s92 offen offset:1024  lds
    v_mfma_f32_16x16x32_bf16 v[140:143], v[148:151], a[128:131], v[140:143]
    v_mfma_f32_16x16x32_bf16 v[144:147], v[148:151], a[144:147], v[144:147]
    s_waitcnt vmcnt(20)
    s_barrier
    v_mfma_f32_16x16x32_bf16 v[144:147], v[152:155], a[148:151], v[144:147]
    s_waitcnt lgkmcnt(0)
    ds_read_b64_tr_b16 v[148:149], v7 offset:16384
    v_mfma_f32_16x16x32_bf16 v[144:147], v[156:159], a[152:155], v[144:147]
    buffer_load_dwordx4 v3, s[32:35], s92 offen offset:2048  lds
    ds_read_b64_tr_b16 v[150:151], v7 offset:18432
    v_mfma_f32_16x16x32_bf16 v[144:147], v[160:163], a[156:159], v[144:147]
    ds_read_b64_tr_b16 v[152:153], v7 offset:20480
    v_mfma_f32_16x16x32_bf16 v[140:143], v[160:163], a[140:143], v[140:143]
    ds_read_b64_tr_b16 v[154:155], v7 offset:22528
    v_mfma_f32_16x16x32_bf16 v[140:143], v[156:159], a[136:139], v[140:143]
    v_mfma_f32_16x16x32_bf16 v[136:139], v[156:159], a[120:123], v[136:139]
    v_mfma_f32_16x16x32_bf16 v[136:139], v[160:163], a[124:127], v[136:139]
    buffer_load_dwordx4 v4, s[32:35], s92 offen offset:3072  lds
    s_add_u32 m0, s91, 49152
    v_mfma_f32_16x16x32_bf16 v[132:135], v[160:163], a[108:111], v[132:135]
    s_add_u32 s92, s90, 2621440
    v_mfma_f32_16x16x32_bf16 v[132:135], v[156:159], a[104:107], v[132:135]
    v_mfma_f32_16x16x32_bf16 v[128:131], v[156:159], a[88:91], v[128:131]
    v_mfma_f32_16x16x32_bf16 v[128:131], v[160:163], a[92:95], v[128:131]
    s_waitcnt lgkmcnt(0)
    ds_read_b64_tr_b16 v[156:157], v7 offset:24576
    v_mfma_f32_16x16x32_bf16 v[128:131], v[148:151], a[160:163], v[128:131]
    buffer_load_dwordx4 v1, s[32:35], s92 offen offset:0  lds
    ds_read_b64_tr_b16 v[158:159], v7 offset:26624
    v_mfma_f32_16x16x32_bf16 v[128:131], v[152:155], a[164:167], v[128:131]
    ds_read_b64_tr_b16 v[160:161], v7 offset:28672
    v_mfma_f32_16x16x32_bf16 v[132:135], v[152:155], a[180:183], v[132:135]
    ds_read_b64_tr_b16 v[162:163], v7 offset:30720
    v_mfma_f32_16x16x32_bf16 v[132:135], v[148:151], a[176:179], v[132:135]
    v_mfma_f32_16x16x32_bf16 v[136:139], v[148:151], a[192:195], v[136:139]
    buffer_load_dwordx4 v2, s[32:35], s92 offen offset:1024  lds
    v_mfma_f32_16x16x32_bf16 v[136:139], v[152:155], a[196:199], v[136:139]
    v_mfma_f32_16x16x32_bf16 v[140:143], v[152:155], a[212:215], v[140:143]
    v_mfma_f32_16x16x32_bf16 v[140:143], v[148:151], a[208:211], v[140:143]
    v_mfma_f32_16x16x32_bf16 v[144:147], v[148:151], a[224:227], v[144:147]
    s_waitcnt vmcnt(20)
    s_barrier
    v_mfma_f32_16x16x32_bf16 v[144:147], v[152:155], a[228:231], v[144:147]
    s_waitcnt lgkmcnt(0)
    ds_read_b64_tr_b16 v[148:149], v8 offset:36864
    v_mfma_f32_16x16x32_bf16 v[144:147], v[156:159], a[232:235], v[144:147]
    buffer_load_dwordx4 v3, s[32:35], s92 offen offset:2048  lds
    ds_read_b64_tr_b16 v[150:151], v8 offset:38912
    v_mfma_f32_16x16x32_bf16 v[144:147], v[160:163], a[236:239], v[144:147]
    ds_read_b64_tr_b16 v[152:153], v8 offset:40960
    v_mfma_f32_16x16x32_bf16 v[140:143], v[160:163], a[220:223], v[140:143]
    ds_read_b64_tr_b16 v[154:155], v8 offset:43008
    v_mfma_f32_16x16x32_bf16 v[140:143], v[156:159], a[216:219], v[140:143]
    v_mfma_f32_16x16x32_bf16 v[136:139], v[156:159], a[200:203], v[136:139]
    buffer_load_dwordx4 v4, s[32:35], s92 offen offset:3072  lds
    s_add_u32 m0, s91, 143360
    v_mfma_f32_16x16x32_bf16 v[136:139], v[160:163], a[204:207], v[136:139]
    s_add_u32 s92, s90, 3932160
    v_mfma_f32_16x16x32_bf16 v[132:135], v[160:163], a[188:191], v[132:135]
    v_mfma_f32_16x16x32_bf16 v[132:135], v[156:159], a[184:187], v[132:135]
    v_mfma_f32_16x16x32_bf16 v[128:131], v[156:159], a[168:171], v[128:131]
    buffer_load_dwordx4 v1, s[32:35], s92 offen offset:0  lds
    v_mfma_f32_16x16x32_bf16 v[128:131], v[160:163], a[172:175], v[128:131]
    s_waitcnt lgkmcnt(0)
    ds_read_b64_tr_b16 v[156:157], v8 offset:45056
    v_mfma_f32_16x16x32_bf16 v[128:131], v[148:151], a[240:243], v[128:131]
    ds_read_b64_tr_b16 v[158:159], v8 offset:47104
    v_mfma_f32_16x16x32_bf16 v[128:131], v[152:155], a[244:247], v[128:131]
    ds_read_b64_tr_b16 v[160:161], v8 offset:49152
    v_mfma_f32_16x16x32_bf16 v[132:135], v[152:155], v[196:199], v[132:135]
    ds_read_b64_tr_b16 v[162:163], v8 offset:51200
    v_mfma_f32_16x16x32_bf16 v[132:135], v[148:151], v[192:195], v[132:135]
    buffer_load_dwordx4 v2, s[32:35], s92 offen offset:1024  lds
    v_mfma_f32_16x16x32_bf16 v[136:139], v[148:151], v[208:211], v[136:139]
    v_mfma_f32_16x16x32_bf16 v[136:139], v[152:155], v[212:215], v[136:139]
    v_mfma_f32_16x16x32_bf16 v[140:143], v[152:155], v[228:231], v[140:143]
    v_mfma_f32_16x16x32_bf16 v[140:143], v[148:151], v[224:227], v[140:143]
    v_mfma_f32_16x16x32_bf16 v[144:147], v[148:151], v[240:243], v[144:147]
    s_waitcnt vmcnt(11)
    s_barrier
    v_mfma_f32_16x16x32_bf16 v[144:147], v[152:155], v[244:247], v[144:147]
    s_waitcnt lgkmcnt(0)
    ds_read_b64_tr_b16 v[148:149], v7 offset:32768
    v_mfma_f32_16x16x16_bf16 v[24:27], v[80:81], v[60:61], v[24:27]
    buffer_load_dwordx4 v3, s[32:35], s92 offen offset:2048  lds
    v_mfma_f32_16x16x16_bf16 v[88:91], v[80:81], v[48:49], v[88:91]
    v_mfma_f32_16x16x16_bf16 v[92:95], v[80:81], v[50:51], v[92:95]
    v_mfma_f32_16x16x16_bf16 v[96:99], v[80:81], v[52:53], v[96:99]
    buffer_store_dword v188, v189, s[36:39], s100 offen offset:2560 sc1
    s_add_u32 s100, s100, 10752
    v_mfma_f32_16x16x16_bf16 v[100:103], v[80:81], v[54:55], v[100:103]
    buffer_load_dword v82, v191, s[36:39], s18 offen offset:2560 sc1
    v_mfma_f32_16x16x16_bf16 v[104:107], v[80:81], v[56:57], v[104:107]
    buffer_load_dword v83, v191, s[36:39], s19 offen offset:2560 sc1
    v_mfma_f32_16x16x16_bf16 v[28:31], v[80:81], v[62:63], v[28:31]
    buffer_load_dwordx4 v4, s[32:35], s92 offen offset:3072  lds
    v_mfma_f32_16x16x32_bf16 v[144:147], v[156:159], v[248:251], v[144:147]
    ds_read_b64_tr_b16 v[150:151], v7 offset:34816
    v_mfma_f32_16x16x32_bf16 v[144:147], v[160:163], v[252:255], v[144:147]
    ds_read_b64_tr_b16 v[152:153], v7 offset:36864
    v_mfma_f32_16x16x32_bf16 v[140:143], v[160:163], v[236:239], v[140:143]
    ds_read_b64_tr_b16 v[154:155], v7 offset:38912
    v_mfma_f32_16x16x32_bf16 v[140:143], v[156:159], v[232:235], v[140:143]
    v_mfma_f32_16x16x32_bf16 v[136:139], v[156:159], v[216:219], v[136:139]
    v_mfma_f32_16x16x32_bf16 v[136:139], v[160:163], v[220:223], v[136:139]
    v_mfma_f32_16x16x32_bf16 v[132:135], v[160:163], v[204:207], v[132:135]
    v_mfma_f32_16x16x32_bf16 v[132:135], v[156:159], v[200:203], v[132:135]
    v_mfma_f32_16x16x32_bf16 v[128:131], v[156:159], a[248:251], v[128:131]
    v_mfma_f32_16x16x32_bf16 v[128:131], v[160:163], a[252:255], v[128:131]
    s_waitcnt lgkmcnt(0)
    ds_read_b64_tr_b16 v[156:157], v7 offset:40960
    v_mfma_f32_16x16x32_bf16 v[88:91], v[148:151], a[0:3], v[88:91]
    ds_read_b64_tr_b16 v[158:159], v7 offset:43008
    v_cvt_pk_bf16_f32 v173, v146, v147
    v_mfma_f32_16x16x32_bf16 v[88:91], v[152:155], a[4:7], v[88:91]
    ds_read_b64_tr_b16 v[160:161], v7 offset:45056
    s_waitcnt vmcnt(14)
    v_mfma_f32_16x16x32_bf16 v[92:95], v[152:155], a[20:23], v[92:95]
    ds_read_b64_tr_b16 v[162:163], v7 offset:47104
    v_or_b32 v174, v174, v175
    v_mfma_f32_16x16x32_bf16 v[92:95], v[148:151], a[16:19], v[92:95]
    v_cmp_ne_u32 vcc, 0, v174
    v_cvt_pk_bf16_f32 v172, v144, v145
    v_mfma_f32_16x16x32_bf16 v[96:99], v[148:151], a[32:35], v[96:99]
    v_cvt_pk_bf16_f32 v171, v142, v143
    v_cvt_pk_bf16_f32 v170, v140, v141
    v_mfma_f32_16x16x32_bf16 v[96:99], v[152:155], a[36:39], v[96:99]
    v_cvt_pk_bf16_f32 v169, v138, v139
    v_cvt_pk_bf16_f32 v168, v136, v137
    v_cvt_pk_bf16_f32 v167, v134, v135
    v_cvt_pk_bf16_f32 v166, v132, v133
    v_cvt_pk_bf16_f32 v165, v130, v131
    v_cvt_pk_bf16_f32 v164, v128, v129
    v_mfma_f32_16x16x32_bf16 v[100:103], v[152:155], a[52:55], v[100:103]
    s_cbranch_vccnz L_retry19
L_back19:
    v_mfma_f32_16x16x32_bf16 v[100:103], v[148:151], a[48:51], v[100:103]
    buffer_store_dwordx4 v[164:167], v186, s[36:39], s93 offen sc1
    buffer_store_dwordx4 v[168:171], v186, s[36:39], s93 offen offset:1024 sc1
    buffer_store_dwordx2 v[172:173], v187, s[36:39], s93 offen offset:2048 sc1
    v_mfma_f32_16x16x32_bf16 v[104:107], v[148:151], a[64:67], v[104:107]
    s_waitcnt vmcnt(14)
    s_barrier
    v_mfma_f32_16x16x32_bf16 v[104:107], v[152:155], a[68:71], v[104:107]
    s_waitcnt lgkmcnt(0)
    ds_read_b64_tr_b16 v[148:149], v11 offset:0
    v_mfma_f32_16x16x32_bf16 v[104:107], v[156:159], a[72:75], v[104:107]
    ds_read_b64_tr_b16 v[150:151], v11 offset:2048
    v_mfma_f32_16x16x32_bf16 v[104:107], v[160:163], a[76:79], v[104:107]
    buffer_load_dwordx4 v[64:67], v186, s[36:39], s16 offen sc1
    ds_read_b64_tr_b16 v[152:153], v11 offset:4096
    v_mfma_f32_16x16x32_bf16 v[100:103], v[160:163], a[60:63], v[100:103]
    buffer_load_dwordx4 v[68:71], v186, s[36:39], s16 offen offset:1024 sc1
    ds_read_b64_tr_b16 v[154:155], v11 offset:6144
    v_mfma_f32_16x16x32_bf16 v[100:103], v[156:159], a[56:59], v[100:103]
    buffer_load_dwordx2 v[72:73], v187, s[36:39], s16 offen offset:2048 sc1
    v_mfma_f32_16x16x32_bf16 v[96:99], v[156:159], a[40:43], v[96:99]
    buffer_load_dwordx4 v[76:79], v86, s[36:39], s17 offen sc1
    v_mfma_f32_16x16x32_bf16 v[96:99], v[160:163], a[44:47], v[96:99]
    v_mfma_f32_16x16x32_bf16 v[92:95], v[160:163], a[28:31], v[92:95]
    v_mfma_f32_16x16x32_bf16 v[92:95], v[156:159], a[24:27], v[92:95]
    v_mfma_f32_16x16x32_bf16 v[88:91], v[156:159], a[8:11], v[88:91]
    v_mfma_f32_16x16x32_bf16 v[88:91], v[160:163], a[12:15], v[88:91]
    s_waitcnt lgkmcnt(0)
    ds_read_b64_tr_b16 v[156:157], v11 offset:8192
    v_mfma_f32_16x16x32_bf16 v[88:91], v[148:151], a[80:83], v[88:91]
    ds_read_b64_tr_b16 v[158:159], v11 offset:10240
    v_mfma_f32_16x16x32_bf16 v[88:91], v[152:155], a[84:87], v[88:91]
    ds_read_b64_tr_b16 v[160:161], v11 offset:12288
    v_mfma_f32_16x16x32_bf16 v[92:95], v[152:155], a[100:103], v[92:95]
    ds_read_b64_tr_b16 v[162:163], v11 offset:14336
    v_mfma_f32_16x16x32_bf16 v[92:95], v[148:151], a[96:99], v[92:95]
    buffer_load_dword v85, v190, s[36:39], s20 offen offset:2560 sc1
    v_mfma_f32_16x16x32_bf16 v[96:99], v[148:151], a[112:115], v[96:99]
    buffer_load_dword v87, v190, s[36:39], s21 offen offset:2560 sc1
    v_mfma_f32_16x16x32_bf16 v[96:99], v[152:155], a[116:119], v[96:99]
    v_mfma_f32_16x16x32_bf16 v[100:103], v[152:155], a[132:135], v[100:103]
    v_mfma_f32_16x16x32_bf16 v[100:103], v[148:151], a[128:131], v[100:103]
    v_mfma_f32_16x16x32_bf16 v[104:107], v[148:151], a[144:147], v[104:107]
    s_waitcnt vmcnt(16)
    s_barrier
    v_mfma_f32_16x16x32_bf16 v[104:107], v[152:155], a[148:151], v[104:107]
    s_waitcnt lgkmcnt(0)
    ds_read_b64_tr_b16 v[148:149], v7 offset:49152
    v_mfma_f32_16x16x32_bf16 v[104:107], v[156:159], a[152:155], v[104:107]
    ds_read_b64_tr_b16 v[150:151], v7 offset:51200
    v_mfma_f32_16x16x32_bf16 v[104:107], v[160:163], a[156:159], v[104:107]
    ds_read_b64_tr_b16 v[152:153], v7 offset:53248
    v_mfma_f32_16x16x32_bf16 v[100:103], v[160:163], a[140:143], v[100:103]
    ds_read_b64_tr_b16 v[154:155], v7 offset:55296
    v_mfma_f32_16x16x32_bf16 v[100:103], v[156:159], a[136:139], v[100:103]
    v_mfma_f32_16x16x32_bf16 v[96:99], v[156:159], a[120:123], v[96:99]
    v_mfma_f32_16x16x32_bf16 v[96:99], v[160:163], a[124:127], v[96:99]
    v_mfma_f32_16x16x32_bf16 v[92:95], v[160:163], a[108:111], v[92:95]
    v_mfma_f32_16x16x32_bf16 v[92:95], v[156:159], a[104:107], v[92:95]
    v_mfma_f32_16x16x32_bf16 v[88:91], v[156:159], a[88:91], v[88:91]
    v_mfma_f32_16x16x32_bf16 v[88:91], v[160:163], a[92:95], v[88:91]
    s_waitcnt lgkmcnt(0)
    ds_read_b64_tr_b16 v[156:157], v7 offset:57344
    v_mfma_f32_16x16x32_bf16 v[88:91], v[148:151], a[160:163], v[88:91]
    ds_read_b64_tr_b16 v[158:159], v7 offset:59392
    v_mfma_f32_16x16x32_bf16 v[88:91], v[152:155], a[164:167], v[88:91]
    ds_read_b64_tr_b16 v[160:161], v7 offset:61440
    s_waitcnt vmcnt(10)
    v_mfma_f32_16x16x32_bf16 v[92:95], v[152:155], a[180:183], v[92:95]
    ds_read_b64_tr_b16 v[162:163], v7 offset:63488
    v_or_b32 v82, v82, v83
    v_mfma_f32_16x16x32_bf16 v[92:95], v[148:151], a[176:179], v[92:95]
    v_cmp_ne_u32 vcc, 0, v82
    v_mfma_f32_16x16x32_bf16 v[96:99], v[148:151], a[192:195], v[96:99]
    v_mfma_f32_16x16x32_bf16 v[96:99], v[152:155], a[196:199], v[96:99]
    v_mfma_f32_16x16x32_bf16 v[100:103], v[152:155], a[212:215], v[100:103]
    s_cbranch_vccnz L_retry20
L_back20:
    v_mfma_f32_16x16x32_bf16 v[100:103], v[148:151], a[208:211], v[100:103]
    v_mfma_f32_16x16x32_bf16 v[104:107], v[148:151], a[224:227], v[104:107]
    s_waitcnt vmcnt(6)
    s_barrier
    v_mfma_f32_16x16x32_bf16 v[104:107], v[152:155], a[228:231], v[104:107]
    s_waitcnt lgkmcnt(0)
    ds_read_b64_tr_b16 v[148:149], v11 offset:20480
    v_mfma_f32_16x16x32_bf16 v[104:107], v[156:159], a[232:235], v[104:107]
    buffer_store_dword v188, v189, s[36:39], s100 offen offset:2560 sc1
    ds_read_b64_tr_b16 v[150:151], v11 offset:22528
    v_mfma_f32_16x16x32_bf16 v[104:107], v[160:163], a[236:239], v[104:107]
    buffer_load_dwordx4 v[108:111], v186, s[36:39], s18 offen sc1
    ds_read_b64_tr_b16 v[152:153], v11 offset:24576
    v_mfma_f32_16x16x32_bf16 v[100:103], v[160:163], a[220:223], v[100:103]
    buffer_load_dwordx4 v[112:115], v186, s[36:39], s18 offen offset:1024 sc1
    ds_read_b64_tr_b16 v[154:155], v11 offset:26624
    v_mfma_f32_16x16x32_bf16 v[100:103], v[156:159], a[216:219], v[100:103]
    buffer_load_dwordx2 v[116:117], v187, s[36:39], s18 offen offset:2048 sc1
    v_mfma_f32_16x16x32_bf16 v[96:99], v[156:159], a[200:203], v[96:99]
L_pad9:
    s_cbranch_execz L_pad13
    buffer_load_dwordx4 v[120:123], v86, s[36:39], s19 offen sc1
    v_mfma_f32_16x16x32_bf16 v[96:99], v[160:163], a[204:207], v[96:99]
    v_mfma_f32_16x16x32_bf16 v[92:95], v[160:163], a[188:191], v[92:95]
    v_mfma_f32_16x16x32_bf16 v[92:95], v[156:159], a[184:187], v[92:95]
    v_mfma_f32_16x16x32_bf16 v[88:91], v[156:159], a[168:171], v[88:91]
    v_mfma_f32_16x16x32_bf16 v[88:91], v[160:163], a[172:175], v[88:91]
    s_waitcnt lgkmcnt(0)
    ds_read_b64_tr_b16 v[156:157], v11 offset:28672
    v_mfma_f32_16x16x32_bf16 v[88:91], v[148:151], a[240:243], v[88:91]
    ds_read_b64_tr_b16 v[158:159], v11 offset:30720
    v_mfma_f32_16x16x32_bf16 v[88:91], v[152:155], a[244:247], v[88:91]
    ds_read_b64_tr_b16 v[160:161], v11 offset:32768
    v_mfma_f32_16x16x32_bf16 v[92:95], v[152:155], v[196:199], v[92:95]
    ds_read_b64_tr_b16 v[162:163], v11 offset:34816
    v_mfma_f32_16x16x32_bf16 v[92:95], v[148:151], v[192:195], v[92:95]
    v_mfma_f32_16x16x32_bf16 v[96:99], v[148:151], v[208:211], v[96:99]
    v_mfma_f32_16x16x32_bf16 v[96:99], v[152:155], v[212:215], v[96:99]
    v_mfma_f32_16x16x32_bf16 v[100:103], v[152:155], v[228:231], v[100:103]
    v_mfma_f32_16x16x32_bf16 v[100:103], v[148:151], v[224:227], v[100:103]
    v_mfma_f32_16x16x32_bf16 v[104:107], v[148:151], v[240:243], v[104:107]
    v_mfma_f32_16x16x32_bf16 v[104:107], v[152:155], v[244:247], v[104:107]
    s_waitcnt lgkmcnt(0)
    s_waitcnt vmcnt(5)
    v_or_b32 v85, v85, v87
    v_mfma_f32_16x16x32_bf16 v[104:107], v[156:159], v[248:251], v[104:107]
    v_cmp_ne_u32 vcc, 0, v85
    v_mfma_f32_16x16x32_bf16 v[104:107], v[160:163], v[252:255], v[104:107]
    v_mfma_f32_16x16x32_bf16 v[100:103], v[160:163], v[236:239], v[100:103]
    v_mfma_f32_16x16x32_bf16 v[100:103], v[156:159], v[232:235], v[100:103]
    v_mfma_f32_16x16x32_bf16 v[96:99], v[156:159], v[216:219], v[96:99]
    s_cbranch_vccnz L_retry21
L_back21:
    v_mfma_f32_16x16x32_bf16 v[96:99], v[160:163], v[220:223], v[96:99]
    v_mfma_f32_16x16x32_bf16 v[92:95], v[160:163], v[204:207], v[92:95]
    v_mfma_f32_16x16x32_bf16 v[92:95], v[156:159], v[200:203], v[92:95]
    buffer_load_dword v174, v190, s[36:39], s22 offen offset:2560 sc1
    v_mfma_f32_16x16x32_bf16 v[88:91], v[156:159], a[248:251], v[88:91]
    buffer_load_dword v175, v190, s[36:39], s23 offen offset:2560 sc1
    v_mfma_f32_16x16x32_bf16 v[88:91], v[160:163], a[252:255], v[88:91]
    buffer_load_dwordx4 v[32:35], v186, s[36:39], s20 offen sc1
    buffer_load_dwordx4 v[36:39], v186, s[36:39], s20 offen offset:1024 sc1
    buffer_load_dwordx2 v[40:41], v187, s[36:39], s20 offen offset:2048 sc1
    buffer_load_dwordx4 v[44:47], v86, s[36:39], s21 offen sc1
    s_waitcnt vmcnt(4)
    v_or_b32_e64 v174, v174, v175
    v_cmp_ne_u32 vcc, 0, v174
    s_nop 1
    s_cbranch_vccnz L_retry22
L_back22:
    buffer_load_dwordx4 v[48:51], v186, s[36:39], s22 offen sc1
    buffer_load_dwordx4 v[52:55], v186, s[36:39], s22 offen offset:1024 sc1
    buffer_load_dwordx2 v[56:57], v187, s[36:39], s22 offen offset:2048 sc1
    buffer_load_dwordx4 v[60:63], v86, s[36:39], s23 offen sc1
    v_mfma_f32_16x16x16_bf16 v[24:27], v[80:81], v[76:77], v[24:27]
    v_mfma_f32_16x16x16_bf16 v[88:91], v[80:81], v[64:65], v[88:91]
    v_mfma_f32_16x16x16_bf16 v[92:95], v[80:81], v[66:67], v[92:95]
    v_mfma_f32_16x16x16_bf16 v[96:99], v[80:81], v[68:69], v[96:99]
    v_mfma_f32_16x16x16_bf16 v[100:103], v[80:81], v[70:71], v[100:103]
    v_mfma_f32_16x16x16_bf16 v[104:107], v[80:81], v[72:73], v[104:107]
    v_mfma_f32_16x16x16_bf16 v[28:31], v[80:81], v[78:79], v[28:31]
    v_mfma_f32_16x16x16_bf16 v[24:27], v[80:81], v[120:121], v[24:27]
    v_mfma_f32_16x16x16_bf16 v[88:91], v[80:81], v[108:109], v[88:91]
    v_mfma_f32_16x16x16_bf16 v[92:95], v[80:81], v[110:111], v[92:95]
    v_mfma_f32_16x16x16_bf16 v[96:99], v[80:81], v[112:113], v[96:99]
    v_mfma_f32_16x16x16_bf16 v[100:103], v[80:81], v[114:115], v[100:103]
    v_mfma_f32_16x16x16_bf16 v[104:107], v[80:81], v[116:117], v[104:107]
    v_mfma_f32_16x16x16_bf16 v[28:31], v[80:81], v[122:123], v[28:31]
    s_waitcnt vmcnt(4)
    v_mfma_f32_16x16x16_bf16 v[24:27], v[80:81], v[44:45], v[24:27]
    v_mfma_f32_16x16x16_bf16 v[88:91], v[80:81], v[32:33], v[88:91]
    v_mfma_f32_16x16x16_bf16 v[92:95], v[80:81], v[34:35], v[92:95]
    v_mfma_f32_16x16x16_bf16 v[96:99], v[80:81], v[36:37], v[96:99]
    v_mfma_f32_16x16x16_bf16 v[100:103], v[80:81], v[38:39], v[100:103]
    v_mfma_f32_16x16x16_bf16 v[104:107], v[80:81], v[40:41], v[104:107]
    v_mfma_f32_16x16x16_bf16 v[28:31], v[80:81], v[46:47], v[28:31]
    s_waitcnt vmcnt(0)
    v_mfma_f32_16x16x16_bf16 v[24:27], v[80:81], v[60:61], v[24:27]
    v_mfma_f32_16x16x16_bf16 v[88:91], v[80:81], v[48:49], v[88:91]
    v_mfma_f32_16x16x16_bf16 v[92:95], v[80:81], v[50:51], v[92:95]
    v_mfma_f32_16x16x16_bf16 v[96:99], v[80:81], v[52:53], v[96:99]
    v_mfma_f32_16x16x16_bf16 v[100:103], v[80:81], v[54:55], v[100:103]
    v_mfma_f32_16x16x16_bf16 v[104:107], v[80:81], v[56:57], v[104:107]
    v_mfma_f32_16x16x16_bf16 v[28:31], v[80:81], v[62:63], v[28:31]
    s_nop 2
    v_cvt_pk_bf16_f32 v164, v88, v89
    v_cvt_pk_bf16_f32 v165, v90, v91
    ds_write_b64 v16, v[164:165] offset:0
    v_cvt_pk_bf16_f32 v166, v92, v93
    v_cvt_pk_bf16_f32 v167, v94, v95
    ds_write_b64 v16, v[166:167] offset:2304
    v_cvt_pk_bf16_f32 v168, v96, v97
    v_cvt_pk_bf16_f32 v169, v98, v99
    ds_write_b64 v16, v[168:169] offset:4608
    v_cvt_pk_bf16_f32 v170, v100, v101
    v_cvt_pk_bf16_f32 v171, v102, v103
    ds_write_b64 v16, v[170:171] offset:6912
    v_cvt_pk_bf16_f32 v172, v104, v105
    v_cvt_pk_bf16_f32 v173, v106, v107
    ds_write_b64 v16, v[172:173] offset:9216
    v_cvt_pk_bf16_f32 v148, v24, v25
    v_cvt_pk_bf16_f32 v149, v26, v27
    v_cvt_pk_bf16_f32 v150, v28, v29
    v_cvt_pk_bf16_f32 v151, v30, v31
    ds_write_b64 v20, v[148:149] offset:11520
    ds_write_b64 v21, v[150:151] offset:11520
    s_add_u32 s87, s98, 20480
    s_waitcnt lgkmcnt(0)
    s_barrier
    ds_read_b128 v[64:67], v17 offset:0
    ds_read_b128 v[68:71], v17 offset:1152
    ds_read_b128 v[72:75], v17 offset:2304
    ds_read_b128 v[76:79], v9 offset:11520
    s_waitcnt lgkmcnt(3)
    buffer_store_dwordx4 v[64:67], v18, s[40:43], s98 offen sc1
    s_waitcnt lgkmcnt(2)
    buffer_store_dwordx4 v[68:71], v18, s[40:43], s87 offen sc1
    s_waitcnt lgkmcnt(1)
    buffer_store_dwordx4 v[72:75], v19, s[40:43], s98 offen sc1
    s_waitcnt lgkmcnt(0)
    buffer_store_dwordx4 v[76:79], v10, s[40:43], s99 offen sc1
L_end:
    s_endpgm
L_retry13:
    buffer_load_dword v82, v188, s[48:51], 0 offen sc1
    s_sub_u32 s79, s79, 1
    s_cbranch_scc1 L_giveup13
    s_waitcnt vmcnt(0)
    v_cmp_gt_u32 vcc, 8, v82
    s_nop 4
    s_cbranch_vccnz L_retry13
    s_branch L_back13
L_giveup13:
    s_mov_b32 s79, 0
    s_waitcnt vmcnt(0)
    s_branch L_back13
L_retry14:
    buffer_load_dword v82, v191, s[36:39], s96 offen offset:2560 sc1
    buffer_load_dword v83, v191, s[36:39], s97 offen offset:2560 sc1
    s_sub_u32 s79, s79, 1
    s_cbranch_scc1 L_giveup14
    s_waitcnt vmcnt(0)
    v_or_b32_e64 v82, v82, v83
    v_cmp_ne_u32 vcc, 0, v82
    s_nop 4
    s_cbranch_vccnz L_retry14
    s_branch L_back14
L_giveup14:
    s_mov_b32 s79, 0
    s_waitcnt vmcnt(0)
    s_branch L_back14
L_retry15:
    buffer_load_dword v85, v191, s[36:39], s8 offen offset:2560 sc1
    buffer_load_dword v87, v191, s[36:39], s9 offen offset:2560 sc1
    s_sub_u32 s79, s79, 1
    s_cbranch_scc1 L_giveup15
    s_waitcnt vmcnt(0)
    v_or_b32_e64 v85, v85, v87
    v_cmp_ne_u32 vcc, 0, v85
    s_nop 4
    s_cbranch_vccnz L_retry15
    s_branch L_back15
L_giveup15:
    s_mov_b32 s79, 0
    s_waitcnt vmcnt(0)
    s_branch L_back15
L_retry16:
    buffer_load_dword v174, v191, s[36:39], s10 offen offset:2560 sc1
    buffer_load_dword v175, v191, s[36:39], s11 offen offset:2560 sc1
    s_sub_u32 s79, s79, 1
    s_cbranch_scc1 L_giveup16
    s_waitcnt vmcnt(0)
    v_or_b32_e64 v174, v174, v175
    v_cmp_ne_u32 vcc, 0, v174
    s_nop 4
    s_cbranch_vccnz L_retry16
    s_branch L_back16
L_giveup16:
    s_mov_b32 s79, 0
    s_waitcnt vmcnt(0)
    s_branch L_back16
L_retry17:
    buffer_load_dword v82, v191, s[36:39], s12 offen offset:2560 sc1
    buffer_load_dword v83, v191, s[36:39], s13 offen offset:2560 sc1
    s_sub_u32 s79, s79, 1
    s_cbranch_scc1 L_giveup17
    s_waitcnt vmcnt(0)
    v_or_b32_e64 v82, v82, v83
    v_cmp_ne_u32 vcc, 0, v82
    s_nop 4
    s_cbranch_vccnz L_retry17
    s_branch L_back17
L_giveup17:
    s_mov_b32 s79, 0
    s_waitcnt vmcnt(0)
    s_branch L_back17
L_retry18:
    buffer_load_dword v85, v191, s[36:39], s14 offen offset:2560 sc1
    buffer_load_dword v87, v191, s[36:39], s15 offen offset:2560 sc1
    s_sub_u32 s79, s79, 1
    s_cbranch_scc1 L_giveup18
    s_waitcnt vmcnt(0)
    v_or_b32_e64 v85, v85, v87
    v_cmp_ne_u32 vcc, 0, v85
    s_nop 4
    s_cbranch_vccnz L_retry18
    s_branch L_back18
L_giveup18:
    s_mov_b32 s79, 0
    s_waitcnt vmcnt(0)
    s_branch L_back18
L_retry19:
    buffer_load_dword v174, v191, s[36:39], s16 offen offset:2560 sc1
    buffer_load_dword v175, v191, s[36:39], s17 offen offset:2560 sc1
    s_sub_u32 s79, s79, 1
    s_cbranch_scc1 L_giveup19
    s_waitcnt vmcnt(0)
    v_or_b32_e64 v174, v174, v175
    v_cmp_ne_u32 vcc, 0, v174
    s_nop 4
    s_cbranch_vccnz L_retry19
    s_branch L_back19
L_giveup19:
    s_mov_b32 s79, 0
    s_waitcnt vmcnt(0)
    s_branch L_back19
L_retry20:
    buffer_load_dword v82, v191, s[36:39], s18 offen offset:2560 sc1
    buffer_load_dword v83, v191, s[36:39], s19 offen offset:2560 sc1
    s_sub_u32 s79, s79, 1
    s_cbranch_scc1 L_giveup20
    s_waitcnt vmcnt(0)
    v_or_b32_e64 v82, v82, v83
    v_cmp_ne_u32 vcc, 0, v82
    s_nop 4
    s_cbranch_vccnz L_retry20
    s_branch L_back20
L_giveup20:
    s_mov_b32 s79, 0
    s_waitcnt vmcnt(0)
    s_branch L_back20
L_retry21:
    buffer_load_dword v85, v190, s[36:39], s20 offen offset:2560 sc1
    buffer_load_dword v87, v190, s[36:39], s21 offen offset:2560 sc1
    s_sub_u32 s79, s79, 1
    s_cbranch_scc1 L_giveup21
    s_waitcnt vmcnt(0)
    v_or_b32_e64 v85, v85, v87
    v_cmp_ne_u32 vcc, 0, v85
    s_nop 4
    s_cbranch_vccnz L_retry21
    s_branch L_back21
L_giveup21:
    s_mov_b32 s79, 0
    s_waitcnt vmcnt(0)
    s_branch L_back21
L_retry22:
    buffer_load_dword v174, v190, s[36:39], s22 offen offset:2560 sc1
    buffer_load_dword v175, v190, s[36:39], s23 offen offset:2560 sc1
    s_sub_u32 s79, s79, 1
    s_cbranch_scc1 L_giveup22
    s_waitcnt vmcnt(0)
    v_or_b32_e64 v174, v174, v175
    v_cmp_ne_u32 vcc, 0, v174
    s_nop 4
    s_cbranch_vccnz L_retry22
    s_branch L_back22
L_giveup22:
    s_mov_b32 s79, 0
    s_waitcnt vmcnt(0)
    s_branch L_back22
L_pad10:
    s_cbranch_execz L_pad14
L_ool0:
    s_barrier
    s_add_u32 m0, s86, 0
    s_mov_b32 s92, 0
    buffer_load_dwordx4 v8, s[24:27], s92 offen offset:0 nt lds
    buffer_load_dwordx4 v8, s[24:27], s92 offen offset:1024 nt lds
    s_add_u32 m0, s86, 128
    s_nop 0
    buffer_load_dwordx4 v8, s[24:27], s92 offen offset:2048 nt lds
    buffer_load_dwordx4 v8, s[24:27], s92 offen offset:3072 nt lds
    s_add_u32 m0, s86, 4224
    s_mov_b32 s92, 4096
    buffer_load_dwordx4 v8, s[24:27], s92 offen offset:0 nt lds
    buffer_load_dwordx4 v8, s[24:27], s92 offen offset:1024 nt lds
    s_add_u32 m0, s86, 4352
    s_nop 0
    buffer_load_dwordx4 v8, s[24:27], s92 offen offset:2048 nt lds
    buffer_load_dwordx4 v8, s[24:27], s92 offen offset:3072 nt lds
    s_add_u32 m0, s86, 8448
    s_mov_b32 s92, 8192
    buffer_load_dwordx4 v8, s[24:27], s92 offen offset:0 nt lds
    buffer_load_dwordx4 v8, s[24:27], s92 offen offset:1024 nt lds
    s_add_u32 m0, s86, 8576
    s_nop 0
    buffer_load_dwordx4 v8, s[24:27], s92 offen offset:2048 nt lds
    buffer_load_dwordx4 v8, s[24:27], s92 offen offset:3072 nt lds
    s_branch L_ret0
L_ool1:
    s_barrier
    s_add_u32 m0, s86, 0
    s_mov_b32 s92, 0
    buffer_load_dwordx4 v8, s[24:27], s92 offen offset:0 nt lds
    buffer_load_dwordx4 v8, s[24:27], s92 offen offset:1024 nt lds
    s_add_u32 m0, s86, 128
    s_nop 0
    buffer_load_dwordx4 v8, s[24:27], s92 offen offset:2048 nt lds
    buffer_load_dwordx4 v8, s[24:27], s92 offen offset:3072 nt lds
    s_add_u32 m0, s86, 4224
    s_mov_b32 s92, 4096
    buffer_load_dwordx4 v8, s[24:27], s92 offen offset:0 nt lds
    buffer_load_dwordx4 v8, s[24:27], s92 offen offset:1024 nt lds
    s_add_u32 m0, s86, 4352
    s_nop 0
    buffer_load_dwordx4 v8, s[24:27], s92 offen offset:2048 nt lds
    buffer_load_dwordx4 v8, s[24:27], s92 offen offset:3072 nt lds
    s_add_u32 m0, s86, 8448
    s_mov_b32 s92, 8192
    buffer_load_dwordx4 v8, s[24:27], s92 offen offset:0 nt lds
    buffer_load_dwordx4 v8, s[24:27], s92 offen offset:1024 nt lds
    s_add_u32 m0, s86, 8576
    s_nop 0
    buffer_load_dwordx4 v8, s[24:27], s92 offen offset:2048 nt lds
    buffer_load_dwordx4 v8, s[24:27], s92 offen offset:3072 nt lds
    s_branch L_ret1
L_pad11:
    s_cbranch_execz L_pad15
L_ool2:
    s_barrier
    s_add_u32 m0, s86, 0
    s_mov_b32 s92, 0
    buffer_load_dwordx4 v8, s[24:27], s92 offen offset:0 nt lds
    buffer_load_dwordx4 v8, s[24:27], s92 offen offset:1024 nt lds
    s_add_u32 m0, s86, 128
    s_nop 0
    buffer_load_dwordx4 v8, s[24:27], s92 offen offset:2048 nt lds
    buffer_load_dwordx4 v8, s[24:27], s92 offen offset:3072 nt lds
    s_add_u32 m0, s86, 4224
    s_mov_b32 s92, 4096
    buffer_load_dwordx4 v8, s[24:27], s92 offen offset:0 nt lds
    buffer_load_dwordx4 v8, s[24:27], s92 offen offset:1024 nt lds
    s_add_u32 m0, s86, 4352
    s_nop 0
    buffer_load_dwordx4 v8, s[24:27], s92 offen offset:2048 nt lds
    buffer_load_dwordx4 v8, s[24:27], s92 offen offset:3072 nt lds
    s_add_u32 m0, s86, 8448
    s_mov_b32 s92, 8192
    buffer_load_dwordx4 v8, s[24:27], s92 offen offset:0 nt lds
    buffer_load_dwordx4 v8, s[24:27], s92 offen offset:1024 nt lds
    s_add_u32 m0, s86, 8576
    s_nop 0
    buffer_load_dwordx4 v8, s[24:27], s92 offen offset:2048 nt lds
    buffer_load_dwordx4 v8, s[24:27], s92 offen offset:3072 nt lds
    s_branch L_ret2
L_ool3:
    s_barrier
    s_add_u32 m0, s86, 0
    s_mov_b32 s92, 0
    buffer_load_dwordx4 v8, s[24:27], s92 offen offset:0 nt lds
    buffer_load_dwordx4 v8, s[24:27], s92 offen offset:1024 nt lds
    s_add_u32 m0, s86, 128
    s_nop 0
    buffer_load_dwordx4 v8, s[24:27], s92 offen offset:2048 nt lds
    buffer_load_dwordx4 v8, s[24:27], s92 offen offset:3072 nt lds
    s_add_u32 m0, s86, 4224
    s_mov_b32 s92, 4096
    buffer_load_dwordx4 v8, s[24:27], s92 offen offset:0 nt lds
    buffer_load_dwordx4 v8, s[24:27], s92 offen offset:1024 nt lds
    s_add_u32 m0, s86, 4352
    s_nop 0
    buffer_load_dwordx4 v8, s[24:27], s92 offen offset:2048 nt lds
    buffer_load_dwordx4 v8, s[24:27], s92 offen offset:3072 nt lds
    s_add_u32 m0, s86, 8448
    s_mov_b32 s92, 8192
    buffer_load_dwordx4 v8, s[24:27], s92 offen offset:0 nt lds
    buffer_load_dwordx4 v8, s[24:27], s92 offen offset:1024 nt lds
    s_add_u32 m0, s86, 8576
    s_nop 0
    buffer_load_dwordx4 v8, s[24:27], s92 offen offset:2048 nt lds
    buffer_load_dwordx4 v8, s[24:27], s92 offen offset:3072 nt lds
    s_branch L_ret3
L_pad12:
    s_cbranch_execz L_pad16
L_ool4:
    s_barrier
    s_add_u32 m0, s86, 0
    s_mov_b32 s92, 0
    buffer_load_dwordx4 v8, s[24:27], s92 offen offset:0 nt lds
    buffer_load_dwordx4 v8, s[24:27], s92 offen offset:1024 nt lds
    s_add_u32 m0, s86, 128
    s_nop 0
    buffer_load_dwordx4 v8, s[24:27], s92 offen offset:2048 nt lds
    buffer_load_dwordx4 v8, s[24:27], s92 offen offset:3072 nt lds
    s_add_u32 m0, s86, 4224
    s_mov_b32 s92, 4096
    buffer_load_dwordx4 v8, s[24:27], s92 offen offset:0 nt lds
    buffer_load_dwordx4 v8, s[24:27], s92 offen offset:1024 nt lds
    s_add_u32 m0, s86, 4352
    s_nop 0
    buffer_load_dwordx4 v8, s[24:27], s92 offen offset:2048 nt lds
    buffer_load_dwordx4 v8, s[24:27], s92 offen offset:3072 nt lds
    s_add_u32 m0, s86, 8448
    s_mov_b32 s92, 8192
    buffer_load_dwordx4 v8, s[24:27], s92 offen offset:0 nt lds
    buffer_load_dwordx4 v8, s[24:27], s92 offen offset:1024 nt lds
    s_add_u32 m0, s86, 8576
    s_nop 0
    buffer_load_dwordx4 v8, s[24:27], s92 offen offset:2048 nt lds
    buffer_load_dwordx4 v8, s[24:27], s92 offen offset:3072 nt lds
    s_branch L_ret4
L_ool5:
    s_barrier
    s_add_u32 m0, s86, 0
    s_mov_b32 s92, 0
    buffer_load_dwordx4 v8, s[24:27], s92 offen offset:0 nt lds
    buffer_load_dwordx4 v8, s[24:27], s92 offen offset:1024 nt lds
    s_add_u32 m0, s86, 128
    s_nop 0
    buffer_load_dwordx4 v8, s[24:27], s92 offen offset:2048 nt lds
    buffer_load_dwordx4 v8, s[24:27], s92 offen offset:3072 nt lds
    s_add_u32 m0, s86, 4224
    s_mov_b32 s92, 4096
    buffer_load_dwordx4 v8, s[24:27], s92 offen offset:0 nt lds
    buffer_load_dwordx4 v8, s[24:27], s92 offen offset:1024 nt lds
    s_add_u32 m0, s86, 4352
    s_nop 0
    buffer_load_dwordx4 v8, s[24:27], s92 offen offset:2048 nt lds
    buffer_load_dwordx4 v8, s[24:27], s92 offen offset:3072 nt lds
    s_add_u32 m0, s86, 8448
    s_mov_b32 s92, 8192
    buffer_load_dwordx4 v8, s[24:27], s92 offen offset:0 nt lds
    buffer_load_dwordx4 v8, s[24:27], s92 offen offset:1024 nt lds
    s_add_u32 m0, s86, 8576
    s_nop 0
    buffer_load_dwordx4 v8, s[24:27], s92 offen offset:2048 nt lds
    buffer_load_dwordx4 v8, s[24:27], s92 offen offset:3072 nt lds
    s_branch L_ret5
L_pad13:
    s_cbranch_execz L_padback
L_ool6:
    s_barrier
    s_add_u32 m0, s86, 0
    s_mov_b32 s92, 0
    buffer_load_dwordx4 v8, s[24:27], s92 offen offset:0 nt lds
    buffer_load_dwordx4 v8, s[24:27], s92 offen offset:1024 nt lds
    s_add_u32 m0, s86, 128
    s_nop 0
    buffer_load_dwordx4 v8, s[24:27], s92 offen offset:2048 nt lds
    buffer_load_dwordx4 v8, s[24:27], s92 offen offset:3072 nt lds
    s_add_u32 m0, s86, 4224
    s_mov_b32 s92, 4096
    buffer_load_dwordx4 v8, s[24:27], s92 offen offset:0 nt lds
    buffer_load_dwordx4 v8, s[24:27], s92 offen offset:1024 nt lds
    s_add_u32 m0, s86, 4352
    s_nop 0
    buffer_load_dwordx4 v8, s[24:27], s92 offen offset:2048 nt lds
    buffer_load_dwordx4 v8, s[24:27], s92 offen offset:3072 nt lds
    s_add_u32 m0, s86, 8448
    s_mov_b32 s92, 8192
    buffer_load_dwordx4 v8, s[24:27], s92 offen offset:0 nt lds
    buffer_load_dwordx4 v8, s[24:27], s92 offen offset:1024 nt lds
    s_add_u32 m0, s86, 8576
    s_nop 0
    buffer_load_dwordx4 v8, s[24:27], s92 offen offset:2048 nt lds
    buffer_load_dwordx4 v8, s[24:27], s92 offen offset:3072 nt lds
    s_branch L_ret6
L_ool7:
    s_barrier
    s_add_u32 m0, s86, 0
    s_mov_b32 s92, 12288
    buffer_load_dwordx4 v8, s[24:27], s92 offen offset:0 nt lds
    buffer_load_dwordx4 v8, s[24:27], s92 offen offset:1024 nt lds
    s_add_u32 m0, s86, 128
    s_nop 0
    buffer_load_dwordx4 v8, s[24:27], s92 offen offset:2048 nt lds
    buffer_load_dwordx4 v8, s[24:27], s92 offen offset:3072 nt lds
    s_add_u32 m0, s86, 4224
    s_mov_b32 s92, 16384
    buffer_load_dwordx4 v8, s[24:27], s92 offen offset:0 nt lds
    buffer_load_dwordx4 v8, s[24:27], s92 offen offset:1024 nt lds
    s_add_u32 m0, s86, 4352
    s_nop 0
    buffer_load_dwordx4 v8, s[24:27], s92 offen offset:2048 nt lds
    buffer_load_dwordx4 v8, s[24:27], s92 offen offset:3072 nt lds
    s_add_u32 m0, s86, 8448
    s_mov_b32 s92, 0
    buffer_load_dwordx4 v9, s[28:31], s92 offen offset:0 nt lds
    buffer_load_dwordx4 v9, s[28:31], s92 offen offset:1024 nt lds
    s_add_u32 m0, s86, 8576
    s_nop 0
    buffer_load_dwordx4 v9, s[28:31], s92 offen offset:2048 nt lds
    buffer_load_dwordx4 v9, s[28:31], s92 offen offset:3072 nt lds
    s_branch L_ret7
L_pad14:
    s_cbranch_execz L_padback
L_ool8:
    s_barrier
    s_add_u32 m0, s86, 0
    s_mov_b32 s92, 12288
    buffer_load_dwordx4 v8, s[24:27], s92 offen offset:0 nt lds
    buffer_load_dwordx4 v8, s[24:27], s92 offen offset:1024 nt lds
    s_add_u32 m0, s86, 128
    s_nop 0
    buffer_load_dwordx4 v8, s[24:27], s92 offen offset:2048 nt lds
    buffer_load_dwordx4 v8, s[24:27], s92 offen offset:3072 nt lds
    s_add_u32 m0, s86, 4224
    s_mov_b32 s92, 16384
    buffer_load_dwordx4 v8, s[24:27], s92 offen offset:0 nt lds
    buffer_load_dwordx4 v8, s[24:27], s92 offen offset:1024 nt lds
    s_add_u32 m0, s86, 4352
    s_nop 0
    buffer_load_dwordx4 v8, s[24:27], s92 offen offset:2048 nt lds
    buffer_load_dwordx4 v8, s[24:27], s92 offen offset:3072 nt lds
    s_add_u32 m0, s86, 8448
    s_mov_b32 s92, 0
    buffer_load_dwordx4 v9, s[28:31], s92 offen offset:0 nt lds
    buffer_load_dwordx4 v9, s[28:31], s92 offen offset:1024 nt lds
    s_add_u32 m0, s86, 8576
    s_nop 0
    buffer_load_dwordx4 v9, s[28:31], s92 offen offset:2048 nt lds
    buffer_load_dwordx4 v9, s[28:31], s92 offen offset:3072 nt lds
    s_branch L_ret8
L_ool9:
    s_barrier
    s_add_u32 m0, s86, 0
    s_mov_b32 s92, 12288
    buffer_load_dwordx4 v8, s[24:27], s92 offen offset:0 nt lds
    buffer_load_dwordx4 v8, s[24:27], s92 offen offset:1024 nt lds
    s_add_u32 m0, s86, 128
    s_nop 0
    buffer_load_dwordx4 v8, s[24:27], s92 offen offset:2048 nt lds
    buffer_load_dwordx4 v8, s[24:27], s92 offen offset:3072 nt lds
    s_add_u32 m0, s86, 4224
    s_mov_b32 s92, 16384
    buffer_load_dwordx4 v8, s[24:27], s92 offen offset:0 nt lds
    buffer_load_dwordx4 v8, s[24:27], s92 offen offset:1024 nt lds
    s_add_u32 m0, s86, 4352
    s_nop 0
    buffer_load_dwordx4 v8, s[24:27], s92 offen offset:2048 nt lds
    buffer_load_dwordx4 v8, s[24:27], s92 offen offset:3072 nt lds
    s_add_u32 m0, s86, 8448
    s_mov_b32 s92, 0
    buffer_load_dwordx4 v9, s[28:31], s92 offen offset:0 nt lds
    buffer_load_dwordx4 v9, s[28:31], s92 offen offset:1024 nt lds
    s_add_u32 m0, s86, 8576
    s_nop 0
    buffer_load_dwordx4 v9, s[28:31], s92 offen offset:2048 nt lds
    buffer_load_dwordx4 v9, s[28:31], s92 offen offset:3072 nt lds
    s_branch L_ret9
L_pad15:
    s_cbranch_execz L_padback
L_ool10:
    s_barrier
    s_add_u32 m0, s86, 0
    s_mov_b32 s92, 12288
    buffer_load_dwordx4 v8, s[24:27], s92 offen offset:0 nt lds
    buffer_load_dwordx4 v8, s[24:27], s92 offen offset:1024 nt lds
    s_add_u32 m0, s86, 128
    s_nop 0
    buffer_load_dwordx4 v8, s[24:27], s92 offen offset:2048 nt lds
    buffer_load_dwordx4 v8, s[24:27], s92 offen offset:3072 nt lds
    s_add_u32 m0, s86, 4224
    s_mov_b32 s92, 16384
    buffer_load_dwordx4 v8, s[24:27], s92 offen offset:0 nt lds
    buffer_load_dwordx4 v8, s[24:27], s92 offen offset:1024 nt lds
    s_add_u32 m0, s86, 4352
    s_nop 0
    buffer_load_dwordx4 v8, s[24:27], s92 offen offset:2048 nt lds
    buffer_load_dwordx4 v8, s[24:27], s92 offen offset:3072 nt lds
    s_add_u32 m0, s86, 8448
    s_mov_b32 s92, 0
    buffer_load_dwordx4 v9, s[28:31], s92 offen offset:0 nt lds
    buffer_load_dwordx4 v9, s[28:31], s92 offen offset:1024 nt lds
    s_add_u32 m0, s86, 8576
    s_nop 0
    buffer_load_dwordx4 v9, s[28:31], s92 offen offset:2048 nt lds
    buffer_load_dwordx4 v9, s[28:31], s92 offen offset:3072 nt lds
    s_branch L_ret10
L_ool11:
    s_barrier
    s_add_u32 m0, s86, 0
    s_mov_b32 s92, 12288
    buffer_load_dwordx4 v8, s[24:27], s92 offen offset:0 nt lds
    buffer_load_dwordx4 v8, s[24:27], s92 offen offset:1024 nt lds
    s_add_u32 m0, s86, 128
    s_nop 0
    buffer_load_dwordx4 v8, s[24:27], s92 offen offset:2048 nt lds
    buffer_load_dwordx4 v8, s[24:27], s92 offen offset:3072 nt lds
    s_add_u32 m0, s86, 4224
    s_mov_b32 s92, 16384
    buffer_load_dwordx4 v8, s[24:27], s92 offen offset:0 nt lds
    buffer_load_dwordx4 v8, s[24:27], s92 offen offset:1024 nt lds
    s_add_u32 m0, s86, 4352
    s_nop 0
    buffer_load_dwordx4 v8, s[24:27], s92 offen offset:2048 nt lds
    buffer_load_dwordx4 v8, s[24:27], s92 offen offset:3072 nt lds
    s_add_u32 m0, s86, 8448
    s_mov_b32 s92, 0
    buffer_load_dwordx4 v9, s[28:31], s92 offen offset:0 nt lds
    buffer_load_dwordx4 v9, s[28:31], s92 offen offset:1024 nt lds
    s_add_u32 m0, s86, 8576
    s_nop 0
    buffer_load_dwordx4 v9, s[28:31], s92 offen offset:2048 nt lds
    buffer_load_dwordx4 v9, s[28:31], s92 offen offset:3072 nt lds
    s_branch L_ret11
L_pad16:
    s_cbranch_execz L_padback
L_ool12:
    s_barrier
    s_add_u32 m0, s86, 0
    s_mov_b32 s92, 12288
    buffer_load_dwordx4 v8, s[24:27], s92 offen offset:0 nt lds
    buffer_load_dwordx4 v8, s[24:27], s92 offen offset:1024 nt lds
    s_add_u32 m0, s86, 128
    s_nop 0
    buffer_load_dwordx4 v8, s[24:27], s92 offen offset:2048 nt lds
    buffer_load_dwordx4 v8, s[24:27], s92 offen offset:3072 nt lds
    s_add_u32 m0, s86, 4224
    s_mov_b32 s92, 16384
    buffer_load_dwordx4 v8, s[24:27], s92 offen offset:0 nt lds
    buffer_load_dwordx4 v8, s[24:27], s92 offen offset:1024 nt lds
    s_add_u32 m0, s86, 4352
    s_nop 0
    buffer_load_dwordx4 v8, s[24:27], s92 offen offset:2048 nt lds
    buffer_load_dwordx4 v8, s[24:27], s92 offen offset:3072 nt lds
    s_add_u32 m0, s86, 8448
    s_mov_b32 s92, 0
    buffer_load_dwordx4 v9, s[28:31], s92 offen offset:0 nt lds
    buffer_load_dwordx4 v9, s[28:31], s92 offen offset:1024 nt lds
    s_add_u32 m0, s86, 8576
    s_nop 0
    buffer_load_dwordx4 v9, s[28:31], s92 offen offset:2048 nt lds
    buffer_load_dwordx4 v9, s[28:31], s92 offen offset:3072 nt lds
    s_branch L_ret12
L_codeend:
.section .rodata,"a"
.p2align 6
.amdhsa_kernel concat_heads__gqa_block_cached__gqa_block_cached__near_ridge_kernel
  .amdhsa_next_free_vgpr 512
  .amdhsa_next_free_sgpr 102
  .amdhsa_accum_offset 256
  .amdhsa_group_segment_fixed_size 0
  .amdhsa_kernarg_size 104
  .amdhsa_user_sgpr_count 2
  .amdhsa_user_sgpr_kernarg_segment_ptr 1
  .amdhsa_system_sgpr_workgroup_id_x 1
  .amdhsa_float_denorm_mode_32 3
.end_amdhsa_kernel
```
